```python
import torch

def _softmax(x, axis=-1):
    return torch.softmax(x, dim=axis)
def _gelu(x):
    return torch.nn.functional.gelu(x, approximate="tanh")
def _silu(x):
    return torch.nn.functional.silu(x)
def _sigmoid(x):
    return torch.sigmoid(x)
def _layernorm(x, axis=-1, eps=1e-5):
    m = x.mean(dim=axis, keepdim=True)
    v = x.var(dim=axis, keepdim=True, unbiased=False)
    return (x - m) / torch.sqrt(v + eps)
def _scatter_add(tgt, idx, src, axis=0):
    return tgt.clone().index_add_(axis, idx, src)
def _segment_sum(src, seg, n):
    out = torch.zeros((n,) + src.shape[1:], dtype=src.dtype)
    return out.index_add_(0, seg, src)
def _pad(x, pw):
    flat = tuple(v for pair in reversed(pw) for v in pair)
    return torch.nn.functional.pad(x, flat)

kernel_name = 'interleave_layers__sliding_local_dilated__dense_activation_relu__prompt'

def setup_inputs():

    _w = (lambda a: (lambda t: t.to(torch.bfloat16) if t.is_floating_point() else t)(torch.as_tensor(a)))
    def _A_setup():
        B, S, D = 1, 2048, 512
        return {
            "x": _w((lambda *s: torch.randn(*s, dtype=torch.bfloat16) * 0.05)(B, S, D)),
            "wqkv": _w((lambda *s: torch.randn(*s, dtype=torch.bfloat16) * 0.05)(D, 3 * D)),
            "wo": _w((lambda *s: torch.randn(*s, dtype=torch.bfloat16) * 0.05)(D, D)),
        }
    _A_in = _A_setup()

    def _B_setup():
        B, S, D, Dff = 1, 2048, 512, 1792
        return {
            "x": _w((lambda *s: torch.randn(*s, dtype=torch.bfloat16) * 0.05)(B, S, D)),
            "w1": _w((lambda *s: torch.randn(*s, dtype=torch.bfloat16) * 0.05)(D, Dff)),
            "w2": _w((lambda *s: torch.randn(*s, dtype=torch.bfloat16) * 0.05)(Dff, D)),
        }
    _B_in = _B_setup()

    return {
        "A_x": _A_in["x"],
        "A_wqkv": _A_in["wqkv"],
        "A_wo": _A_in["wo"],
        "B_x": _B_in["x"],
        "B_w1": _B_in["w1"],
        "B_w2": _B_in["w2"],
    }

def reference(A_x, A_wqkv, A_wo, B_x, B_w1, B_w2):
    def _A_ref(x, wqkv, wo):
        B, S, D = x.shape
        H = 32; Dh = D // H
        W, dil = 8, 2
        qkv = (lambda x, *d: x.permute(*d))((x @ wqkv).reshape(B, S, 3, H, Dh), 2, 0, 3, 1, 4)
        q, k, v = qkv[0], qkv[1], qkv[2]
        scale = Dh ** -0.5
        pos = torch.arange(S)
        off = torch.arange(W) * dil
        idx = pos[:, None] - off[None, :]
        mask = idx >= 0
        idx_c = torch.where(mask, idx, 0).reshape(-1)
        kg = k[:, :, idx_c, :].reshape(B, H, S, W, Dh)
        vg = v[:, :, idx_c, :].reshape(B, H, S, W, Dh)
        logits = torch.einsum("bhsd,bhswd->bhsw", q, kg) * scale
        logits = torch.where(mask[None, None, :, :], logits, -1e9)
        attn = _softmax(logits, axis=-1)
        o = torch.einsum("bhsw,bhswd->bhsd", attn, vg)
        return (lambda x, *d: x.permute(*d))(o, 0, 2, 1, 3).reshape(B, S, D) @ wo

    def _B_ref(x, w1, w2):
        h = torch.einsum("bsd,df->bsf", x, w1)
        zero = torch.zeros_like(h)
        h = torch.maximum(h, zero)
        return torch.einsum("bsf,fd->bsd", h, w2)

    x = A_x
    x = x + _A_ref(_layernorm(x, axis=-1), A_wqkv, A_wo)
    x = x + _B_ref(_layernorm(x, axis=-1), B_w1, B_w2)
    x = x + _A_ref(_layernorm(x, axis=-1), A_wqkv, A_wo)
    x = x + _B_ref(_layernorm(x, axis=-1), B_w1, B_w2)
    return x
```

```asm
; @launch grid=(256,1,1) block=(256,1,1) lds=163840
.amdgcn_target "amdgcn-amd-amdhsa--gfx950"
.text
.globl interleave_layers__sliding_local_dilated__dense_activation_relu__prompt_kernel
.p2align 8
.type interleave_layers__sliding_local_dilated__dense_activation_relu__prompt_kernel,@function
interleave_layers__sliding_local_dilated__dense_activation_relu__prompt_kernel:
    s_cmp_ge_u32 s2, 256
    s_cbranch_scc1 L_END
    s_load_dwordx4 s[4:7], s[0:1], 0
    s_load_dwordx2 s[28:29], s[0:1], 64
    s_getpc_b64 s[78:79]
    v_lshlrev_b32 v2, 6, v0
    global_load_dword v19, v2, s[78:79]
    s_load_dwordx2 s[12:13], s[0:1], 16
    s_load_dwordx4 s[16:19], s[0:1], 32
    s_load_dwordx2 s[24:25], s[0:1], 48
    v_lshrrev_b32 v2, 6, v0
    v_and_b32 v0, 63, v0
    v_readfirstlane_b32 s36, v2
    s_and_b32 s68, s2, 7
    s_lshr_b32 s69, s2, 3
    s_lshr_b32 s70, s2, 7
    s_lshl_b32 s32, s68, 1
    s_add_u32 s32, s32, s70
    s_and_b32 s33, s69, 15
    s_and_b32 s34, s69, 7
    s_lshr_b32 s35, s33, 3
    v_and_b32 v184, 15, v0
    v_lshrrev_b32 v185, 4, v0
    s_lshl_b32 s68, s32, 17
    s_lshl_b32 s69, s35, 16
    s_add_u32 s68, s68, s69
    s_lshl_b32 s69, s34, 7
    s_add_u32 s68, s68, s69
    s_and_b32 s69, s36, 1
    s_lshl_b32 s69, s69, 10
    s_add_u32 s68, s68, s69
    v_and_b32 v188, 1, v185
    v_lshlrev_b32 v189, 5, v188
    v_lshrrev_b32 v190, 1, v185
    v_lshl_add_u32 v189, v190, 4, v189
    v_lshl_add_u32 v190, v184, 11, v189
    v_add_u32 v191, s68, v190
    s_lshl_b32 s72, s36, 14
    s_and_b32 s72, s72, 0x8000
    v_add_u32 v66, s72, v191
    s_waitcnt lgkmcnt(0)
    s_mov_b32 s8, s6
    s_mov_b32 s9, s7
    s_and_b32 s5, s5, 0xffff
    s_mov_b32 s6, 2097152
    s_mov_b32 s7, 0x20000
    s_mov_b32 s20, s18
    s_mov_b32 s21, s19
    s_add_u32 s28, s28, 201326592
    s_addc_u32 s29, s29, 0
    s_and_b32 s29, s29, 0xffff
    s_mov_b32 s30, 67108864
    s_mov_b32 s31, 0x20000
    s_and_b32 s9, s9, 0xffff
    s_mov_b32 s10, 1572864
    s_mov_b32 s11, 0x20000
    v_lshlrev_b32 v1, 4, v0
    v_lshlrev_b32 v86, 7, v0
    v_mov_b32 v237, v86
    s_lshr_b32 s77, s2, 3
    s_lshl_b32 s77, s77, 2
    s_add_u32 s75, s77, s36
    s_lshl_b32 s77, s75, 11
    v_add_u32 v86, s77, v86
    v_mov_b32 v239, 0x7f000000
    v_cmp_gt_u32 vcc, 256, v1
    s_nop 1
    v_cndmask_b32 v86, v239, v86, vcc
    s_lshl_b32 s74, s2, 2
    s_add_u32 s74, s74, s36
    s_mul_i32 s77, s74, 1536
    s_bfm_b64 exec, 12, 0
    buffer_load_dword v19, v237, s[8:11], s77 offen
    s_mov_b64 exec, -1
    s_lshr_b32 s77, s32, 1
    s_lshl_b32 s77, s77, 18
    buffer_load_dword v19, v86, s[4:7], s77 offen
    s_mov_b32 s77, 0
    buffer_load_dword v19, v86, s[8:11], s77 offen
    s_mov_b32 s77, 262144
    buffer_load_dword v19, v86, s[8:11], s77 offen
    s_mov_b32 s77, 524288
    buffer_load_dword v19, v86, s[8:11], s77 offen
    v_lshlrev_b32 v192, 3, v184
    s_lshl_b32 s68, s32, 8
    s_add_u32 s68, s68, 50331648
    s_add_u32 s69, s68, 4096
    s_lshl_b32 s41, s32, 9
    s_add_u32 s41, s41, 50339840
    v_lshrrev_b32 v22, 1, v1
    v_add_u32 v22, s41, v22
    s_add_u32 s70, s32, 15
    s_and_b32 s70, s70, 15
    s_lshl_b32 s71, s70, 8
    s_add_u32 s71, s71, 50335744
    v_add_u32 v25, s71, v192
    buffer_load_dwordx2 v[20:21], v192, s[28:31], s68 offen sc1
    buffer_load_dwordx2 v[196:197], v25, s[28:31], 0 offen sc1
    buffer_load_dwordx2 v[198:199], v192, s[28:31], s69 offen sc1
    buffer_load_dword v19, v22, s[28:31], 0 offen sc1
    s_lshl_b32 s71, s33, 3
    s_add_u32 s41, s41, s71
    s_lshl_b32 s71, s36, 7
    s_add_u32 s41, s41, s71
    s_and_b32 s72, s36, 1
    s_lshl_b32 s81, s34, 1
    s_add_u32 s81, s81, s72
    s_lshl_b32 s71, s81, 3
    s_add_u32 s65, s69, s71
    s_add_u32 s65, s65, 128
    s_lshl_b32 s46, s32, 13
    s_add_u32 s46, s46, 51445760
    s_lshl_b32 s77, s75, 9
    s_min_u32 s77, s77, L_END-L_PC-384
    s_getpc_b64 s[78:79]
L_PC:
    s_add_u32 s78, s78, s77
    s_addc_u32 s79, s79, 0
    s_mov_b64 exec, 0xf
    global_load_dword v19, v237, s[78:79]
    s_mov_b64 exec, -1
    v_lshrrev_b32 v193, 1, v185
    v_xor_b32 v193, v193, v184
    v_lshlrev_b32 v193, 4, v193
    v_lshl_add_u32 v240, v185, 10, v193
    s_lshl_b32 s90, s32, 17
    s_lshl_b32 s91, s36, 15
    s_add_u32 s90, s90, s91
    s_lshl_b32 s91, s36, 13
    v_xor_b32 v241, 32, v240
    v_add_u32 v241, 3072, v241
    v_xor_b32 v242, 64, v240
    v_add_u32 v242, 6144, v242
    v_xor_b32 v243, 96, v240
    v_add_u32 v243, 9216, v243
    v_xor_b32 v244, 128, v240
    v_add_u32 v244, 16384, v244
    v_xor_b32 v245, 160, v240
    v_add_u32 v245, 19456, v245
    v_xor_b32 v246, 192, v240
    v_add_u32 v246, 22528, v246
    v_xor_b32 v247, 224, v240
    v_add_u32 v247, 25600, v247
    v_lshrrev_b32 v186, 2, v0
    v_and_b32 v187, 3, v0
    v_lshrrev_b32 v200, 1, v187
    v_xor_b32 v200, v200, v188
    v_lshlrev_b32 v200, 5, v200
    v_and_b32 v201, 1, v0
    v_lshl_add_u32 v200, v201, 4, v200
    v_mul_u32_u24 v14, 3072, v186
    v_add_u32 v14, v14, v200
    s_mul_i32 s49, s36, 49152
    s_lshl_b32 s73, s33, 6
    s_add_u32 s49, s49, s73
    s_mul_i32 s50, s36, 3072
    s_getreg_b32 s37, hwreg(HW_REG_XCC_ID, 0, 3)
    s_lshl_b32 s62, s35, 2
    s_add_u32 s62, s62, s36
    s_lshl_b32 s59, s32, 15
    s_add_u32 s59, s59, 50397184
    s_lshl_b32 s44, s32, 17
    s_add_u32 s44, s44, 52428800
    s_lshr_b32 s68, s36, 1
    s_and_b32 s69, s36, 1
    s_cmp_eq_u32 s36, 0
    s_cselect_b32 s42, 1, 0
    s_mov_b32 s43, 0
    s_and_b32 s66, s68, s35
    s_mov_b32 s67, 0
    s_cmp_eq_u32 s66, 1
    s_cselect_b32 s84, 0xff00ff00, 0
    s_mov_b32 s85, s84
    s_mov_b32 s88, 0x3727c5ac
    s_mov_b32 s89, 0x3b000000
    s_lshl_b32 s98, s62, 14
    s_lshl_b32 s73, s34, 11
    s_add_u32 s98, s98, s73
    s_add_u32 s59, s59, s73
    s_lshr_b32 s73, s34, 1
    s_lshl_b32 s73, s73, 8
    s_and_b32 s74, s34, 1
    s_lshl_b32 s74, s74, 3
    s_add_u32 s73, s73, s74
    s_lshl_b32 s99, s62, 10
    s_add_u32 s99, s99, s73
    v_lshlrev_b32 v60, 4, v184
    v_lshl_add_u32 v60, v188, 2, v60
    s_lshl_b32 s74, s69, 7
    v_subrev_u32 v67, s74, v1
    s_lshl_b32 s75, s34, 11
    s_sub_u32 s73, s73, s75
    s_add_u32 s73, s73, 16384
    s_sub_u32 s73, s73, s74
    v_add_u32 v87, s73, v60
    v_lshlrev_b32 v193, 4, v184
    v_lshrrev_b32 v194, 1, v185
    v_lshlrev_b32 v194, 4, v194
    v_xor_b32 v193, v193, v194
    v_lshl_add_u32 v193, v184, 9, v193
    v_lshl_add_u32 v193, v188, 3, v193
    s_add_u32 s68, s91, 49152
    v_xor_b32 v248, 0, v193
    v_add_u32 v248, s68, v248
    v_xor_b32 v249, 32, v193
    v_add_u32 v249, s68, v249
    v_xor_b32 v250, 64, v193
    v_add_u32 v250, s68, v250
    v_xor_b32 v251, 96, v193
    v_add_u32 v251, s68, v251
    v_xor_b32 v252, 128, v193
    v_add_u32 v252, s68, v252
    v_xor_b32 v253, 160, v193
    v_add_u32 v253, s68, v253
    v_xor_b32 v254, 192, v193
    v_add_u32 v254, s68, v254
    v_xor_b32 v255, 224, v193
    v_add_u32 v255, s68, v255
    s_sub_u32 s12, s12, 4096
    s_subb_u32 s13, s13, 0
    s_and_b32 s13, s13, 0xffff
    s_mov_b32 s14, 528384
    s_mov_b32 s15, 0x20000
    s_sub_u32 s16, s16, 4096
    s_subb_u32 s17, s17, 0
    s_and_b32 s17, s17, 0xffff
    s_mov_b32 s18, 1839104
    s_mov_b32 s19, 0x20000
    s_sub_u32 s20, s20, 4096
    s_subb_u32 s21, s21, 0
    s_and_b32 s21, s21, 0xffff
    s_mov_b32 s22, 1839104
    s_mov_b32 s23, 0x20000
    s_and_b32 s25, s25, 0xffff
    s_mov_b32 s26, 2097152
    s_mov_b32 s27, 0x20000
    s_lshl_b32 s48, s32, 17
    s_add_u32 s48, s48, 54525952
    s_mul_i32 s45, s32, 0x70000
    s_add_u32 s45, s45, 56623104
    s_add_u32 s70, s32, 15
    s_and_b32 s70, s70, 15
    s_lshl_b32 s58, s70, 15
    s_add_u32 s58, s58, 50397184
    s_cmp_eq_u32 s32, 0
    s_cselect_b32 s58, 0x40000000, s58
    v_add_u32 v95, 16384, v1
    v_lshlrev_b32 v202, 6, v186
    v_lshl_add_u32 v202, v187, 3, v202
    v_lshl_add_u32 v2, v188, 5, v202
    v_xor_b32 v4, 32, v2
    v_add_u32 v3, 0x10000, v2
    v_add_u32 v5, 0x10000, v4
    v_lshlrev_b32 v6, 3, v0
    v_add_u32 v7, 0x10000, v6
    s_lshl_b32 s57, s36, 12
    s_and_b32 s68, s57, 4096
    v_add_u32 v8, s68, v2
    v_add_u32 v11, s68, v4
    v_add_u32 v9, s68, v3
    v_add_u32 v12, s68, v5
    v_add_u32 v10, 0x10000, v9
    v_add_u32 v13, 0x10000, v12
    s_lshl_b32 s68, s36, 10
    s_add_u32 s68, s68, 98304
    v_add_u32 v73, s68, v1
    v_mul_u32_u24 v16, 3584, v186
    v_add_u32 v16, v16, v200
    v_lshl_add_u32 v80, v186, 10, v200
    v_lshrrev_b32 v202, 1, v0
    v_mul_u32_u24 v15, 3584, v202
    v_lshl_add_u32 v15, v201, 4, v15
    v_add_u32 v15, 4096, v15
    v_add_u32 v18, 2176, v16
    v_add_u32 v17, 3136, v16
    v_add_u32 v16, 4096, v16
    v_add_u32 v83, 33856, v80
    v_add_u32 v82, 34816, v80
    v_add_u32 v81, 3136, v80
    v_add_u32 v80, 4096, v80
    s_lshr_b32 s68, s36, 1
    s_and_b32 s69, s36, 1
    s_mul_i32 s70, s69, 3072
    s_mul_i32 s52, s68, 7168
    s_add_u32 s52, s52, s70
    s_mul_i32 s54, s36, 7168
    s_lshr_b32 s71, s33, 1
    s_and_b32 s72, s33, 1
    s_mul_i32 s73, s71, 448
    s_lshl_b32 s74, s72, 8
    s_add_u32 s74, s74, s73
    s_mul_i32 s51, s36, 57344
    s_add_u32 s51, s51, s74
    s_lshl_b32 s74, s72, 5
    s_add_u32 s74, s74, s73
    s_add_u32 s74, s74, 192
    s_mul_i32 s53, s36, 114688
    s_add_u32 s53, s53, s74
    s_mul_i32 s73, s71, 7168
    s_mul_i32 s75, s36, 114688
    s_add_u32 s73, s73, s75
    s_lshl_b32 s74, s72, 12
    s_add_u32 s60, s73, s74
    s_lshl_b32 s74, s72, 3
    s_add_u32 s61, s73, s74
    s_add_u32 s61, s61, 3072
    s_lshl_b32 s73, s34, 7
    s_lshl_b32 s74, s68, 14
    s_add_u32 s73, s73, s74
    s_mul_i32 s55, s69, 917504
    s_add_u32 s55, s55, s73
    s_mul_i32 s56, s69, 262144
    s_add_u32 s56, s56, s73
    s_add_u32 s73, s36, 0
    s_and_b32 s73, s73, 3
    s_mul_i32 s94, s73, 24576
    s_add_u32 s73, s36, 1
    s_and_b32 s73, s73, 3
    s_mul_i32 s95, s73, 24576
    s_add_u32 s73, s36, 2
    s_and_b32 s73, s73, 3
    s_mul_i32 s96, s73, 24576
    s_add_u32 s73, s36, 3
    s_and_b32 s73, s73, 3
    s_mul_i32 s97, s73, 24576
    v_add_u32 v26, s57, v1
    v_add_u32 v61, 98304, v26
    v_add_u32 v26, 65536, v26
    v_xor_b32 v27, 4096, v26
    s_add_u32 s73, s57, 71680
    v_add_u32 v30, s73, v1
    v_add_u32 v34, 4096, v30
    v_add_u32 v32, 8, v30
    v_add_u32 v31, 2048, v30
    v_add_u32 v33, 2048, v32
    v_xor_b32 v200, 128, v1
    v_add_u32 v200, 71680, v200
    v_xor_b32 v201, 512, v1
    v_add_u32 v201, 71688, v201
    s_cmp_eq_u32 s36, 0
    s_cselect_b64 vcc, -1, 0
    v_cndmask_b32 v31, v31, v200, vcc
    v_cndmask_b32 v33, v33, v201, vcc
    s_lshl_b32 s73, s69, 10
    s_lshl_b32 s74, s68, 3
    s_add_u32 s73, s73, s74
    s_add_u32 s73, s73, 71680
    v_add_u32 v35, s73, v1
    s_or_b32 s73, s32, s36
    s_cmp_eq_u32 s73, 0
    s_cselect_b32 s73, 100, 9
    v_lshlrev_b32 v200, 2, v185
    v_sub_u32 v200, v184, v200
    v_mov_b32 v202, 0xf149f2ca
    v_subrev_u32 v201, 0, v200
    v_cmp_gt_u32 vcc, 8, v201
    s_nop 1
    v_cndmask_b32 v36, v202, 0, vcc
    v_add_u32 v201, s73, v201
    v_cmp_ge_i32 vcc, 0, v201
    s_nop 1
    v_cndmask_b32 v40, v202, 0, vcc
    v_subrev_u32 v201, 1, v200
    v_cmp_gt_u32 vcc, 8, v201
    s_nop 1
    v_cndmask_b32 v37, v202, 0, vcc
    v_add_u32 v201, s73, v201
    v_cmp_ge_i32 vcc, 0, v201
    s_nop 1
    v_cndmask_b32 v41, v202, 0, vcc
    v_subrev_u32 v201, 2, v200
    v_cmp_gt_u32 vcc, 8, v201
    s_nop 1
    v_cndmask_b32 v38, v202, 0, vcc
    v_add_u32 v201, s73, v201
    v_cmp_ge_i32 vcc, 0, v201
    s_nop 1
    v_cndmask_b32 v42, v202, 0, vcc
    v_subrev_u32 v201, 3, v200
    v_cmp_gt_u32 vcc, 8, v201
    s_nop 1
    v_cndmask_b32 v39, v202, 0, vcc
    v_add_u32 v201, s73, v201
    v_cmp_ge_i32 vcc, 0, v201
    s_nop 1
    v_cndmask_b32 v43, v202, 0, vcc
    s_lshl_b32 s73, s36, 8
    s_add_u32 s73, s73, 162816
    v_lshlrev_b32 v200, 2, v184
    v_lshlrev_b32 v201, 4, v185
    v_add_u32 v62, s73, v200
    v_add_u32 v63, s73, v201
    v_add_u32 v65, 159744, v200
    v_add_u32 v64, 159744, v201
    s_lshl_b32 s73, s36, 9
    s_add_u32 s73, s73, 114688
    v_add_u32 v75, s73, v200
    v_lshlrev_b32 v202, 4, v184
    v_add_u32 v202, s73, v202
    v_add_u32 v0, 128, v202
    v_add_u32 v203, s73, v201
    s_add_u32 s74, s36, 2
    s_lshl_b32 s74, s74, 6
    v_add_u32 v204, s74, v64
    v_add_u32 v205, s74, v65
    v_add_u32 v206, 64, v203
    s_cmp_lt_u32 s36, 2
    s_cselect_b64 vcc, -1, 0
    v_cndmask_b32 v92, v203, v204, vcc
    v_cndmask_b32 v93, v205, v75, vcc
    v_cndmask_b32 v94, v206, v0, vcc
    v_mov_b32 v68, 0x3f803f80
    v_mov_b32 v69, 0x3f803f80
    v_mov_b32 v70, 0x3f803f80
    v_mov_b32 v71, 0x3f803f80
    s_add_u32 s76, s90, 0
    s_add_u32 m0, s91, 94208
    s_nop 0
    buffer_load_dwordx4 v240, s[4:7], s76 offen offset:0 lds
    buffer_load_dwordx4 v241, s[4:7], s76 offen offset:1024 lds
    buffer_load_dwordx4 v242, s[4:7], s76 offen offset:2048 lds
    buffer_load_dwordx4 v243, s[4:7], s76 offen offset:3072 lds
    s_add_u32 m0, s91, 98304
    s_nop 0
    buffer_load_dwordx4 v244, s[4:7], s76 offen offset:0 lds
    buffer_load_dwordx4 v245, s[4:7], s76 offen offset:1024 lds
    buffer_load_dwordx4 v246, s[4:7], s76 offen offset:2048 lds
    buffer_load_dwordx4 v247, s[4:7], s76 offen offset:3072 lds
    s_add_u32 m0, s50, 0
    s_add_u32 s76, s49, 0
    buffer_load_dwordx4 v14, s[8:11], s76 offen lds
    buffer_load_dwordx4 v14, s[8:11], s76 offen offset:1024 lds
    buffer_load_dwordx4 v14, s[8:11], s76 offen offset:2048 lds
    s_add_u32 m0, s50, 12288
    s_add_u32 s76, s49, 196608
    buffer_load_dwordx4 v14, s[8:11], s76 offen lds
    buffer_load_dwordx4 v14, s[8:11], s76 offen offset:1024 lds
    buffer_load_dwordx4 v14, s[8:11], s76 offen offset:2048 lds
    buffer_load_dwordx4 v[96:99], v66, s[4:7], 0 offen offset:0
    buffer_load_dwordx4 v[100:103], v66, s[4:7], 0 offen offset:64
    s_and_b32 s68, s36, 1
    s_lshl_b32 s68, s68, 5
    s_lshr_b32 s69, s36, 1
    s_lshl_b32 s69, s69, 10
    v_xor_b32 v76, s68, v2
    v_add_u32 v78, 2048, v76
    v_add_u32 v76, s69, v76
    v_add_u32 v77, 49152, v76
    v_add_u32 v79, 49152, v78
    s_and_b32 s68, s36, 1
    s_lshr_b32 s69, s36, 1
    s_mul_i32 s69, s69, 6144
    s_lshl_b32 s68, s68, 5
    v_xor_b32 v84, s68, v2
    v_add_u32 v84, s69, v84
    v_add_u32 v85, 49152, v84
    s_waitcnt vmcnt(20)
    v_add_u32 v20, 1540483477, v20
    v_add_u32 v21, 625341585, v21
    s_waitcnt vmcnt(19)
    v_add_u32 v23, 1540483477, v196
    v_add_u32 v24, 625341585, v197
    v_add_u32 v25, 128, v25
    v_readlane_b32 s39, v20, s33
    v_readlane_b32 s40, v21, s33
    s_waitcnt vmcnt(18)
    v_readlane_b32 s63, v198, s81
    v_readlane_b32 s64, v199, s81
    s_add_u32 s39, s39, s37
    s_add_u32 s63, s63, 1540483477
    s_add_u32 s64, s64, 625341585
    s_add_u32 s68, s39, 0
    v_mov_b32 v216, s68
    v_mov_b32 v217, s40
    s_waitcnt vmcnt(8)
    ds_read_b64 a[0:1], v248 offset:45056
    ds_read_b64 a[2:3], v249 offset:45056
    ds_read_b64 a[4:5], v248 offset:45312
    ds_read_b64 a[6:7], v249 offset:45312
    ds_read_b64 a[8:9], v250 offset:45056
    ds_read_b64 a[10:11], v251 offset:45056
    ds_read_b64 a[12:13], v250 offset:45312
    ds_read_b64 a[14:15], v251 offset:45312
    ds_read_b64 a[16:17], v252 offset:45056
    ds_read_b64 a[18:19], v253 offset:45056
    ds_read_b64 a[20:21], v252 offset:45312
    ds_read_b64 a[22:23], v253 offset:45312
    ds_read_b64 a[24:25], v254 offset:45056
    ds_read_b64 a[26:27], v255 offset:45056
    ds_read_b64 a[28:29], v254 offset:45312
    ds_read_b64 a[30:31], v255 offset:45312
    s_add_u32 s76, s90, 256
    s_add_u32 m0, s91, 49152
    s_nop 0
    buffer_load_dwordx4 v240, s[4:7], s76 offen offset:0 lds
    buffer_load_dwordx4 v241, s[4:7], s76 offen offset:1024 lds
    buffer_load_dwordx4 v242, s[4:7], s76 offen offset:2048 lds
    buffer_load_dwordx4 v243, s[4:7], s76 offen offset:3072 lds
    s_waitcnt vmcnt(5)
    v_permlane16_swap_b32 v96, v98
    v_permlane16_swap_b32 v97, v99
    s_waitcnt vmcnt(4)
    v_permlane16_swap_b32 v100, v102
    v_permlane16_swap_b32 v101, v103
    v_lshlrev_b32 v44, 16, v96
    v_and_b32 v45, 0xffff0000, v96
    v_lshlrev_b32 v46, 16, v97
    v_and_b32 v47, 0xffff0000, v97
    v_lshlrev_b32 v48, 16, v98
    v_and_b32 v49, 0xffff0000, v98
    v_lshlrev_b32 v50, 16, v99
    v_and_b32 v51, 0xffff0000, v99
    v_lshlrev_b32 v52, 16, v100
    v_and_b32 v53, 0xffff0000, v100
    v_lshlrev_b32 v54, 16, v101
    v_and_b32 v55, 0xffff0000, v101
    v_lshlrev_b32 v56, 16, v102
    v_and_b32 v57, 0xffff0000, v102
    v_lshlrev_b32 v58, 16, v103
    v_and_b32 v59, 0xffff0000, v103
    s_add_u32 s101, s46, s99
    v_pk_add_f32 v[232:233], v[44:45], v[46:47]
    v_pk_mul_f32 v[234:235], v[44:45], v[44:45]
    v_pk_add_f32 v[236:237], v[48:49], v[50:51]
    v_pk_mul_f32 v[238:239], v[46:47], v[46:47]
    v_pk_fma_f32 v[234:235], v[48:49], v[48:49], v[234:235]
    v_pk_fma_f32 v[238:239], v[50:51], v[50:51], v[238:239]
    v_pk_add_f32 v[232:233], v[232:233], v[52:53]
    v_pk_fma_f32 v[234:235], v[52:53], v[52:53], v[234:235]
    v_pk_add_f32 v[236:237], v[236:237], v[54:55]
    v_pk_fma_f32 v[238:239], v[54:55], v[54:55], v[238:239]
    v_pk_add_f32 v[232:233], v[232:233], v[56:57]
    v_pk_fma_f32 v[234:235], v[56:57], v[56:57], v[234:235]
    v_pk_add_f32 v[236:237], v[236:237], v[58:59]
    v_pk_fma_f32 v[238:239], v[58:59], v[58:59], v[238:239]
    v_pk_add_f32 v[232:233], v[232:233], v[236:237]
    v_pk_add_f32 v[234:235], v[234:235], v[238:239]
    v_add_f32 v232, v232, v233
    v_add_f32 v233, v234, v235
    s_nop 1
    v_permlane16_swap_b32 v232, v233
    v_add_f32 v232, v232, v233
    v_mov_b32 v233, v232
    s_nop 1
    v_permlane32_swap_b32 v232, v233
    v_add_f32 v232, v232, v233
    buffer_store_dword v232, v60, s[28:31], s101 offen sc1
    s_add_u32 s68, s59, 0
    s_mov_b64 exec, s[84:85]
    buffer_store_dwordx4 v[96:99], v67, s[28:31], s68 offen sc1
    buffer_store_dwordx4 v[100:103], v67, s[28:31], s68 offen offset:1024 sc1
    buffer_store_dword v232, v87, s[28:31], s68 offen sc1
    s_mov_b64 exec, -1
    s_lshl_b32 s100, s36, 11
    s_add_u32 s100, s100, s46
    s_add_u32 s69, s36, 0
    s_and_b32 s69, s69, 3
    s_lshl_b32 s69, s69, 12
    s_add_u32 s101, s58, 0
    s_add_u32 s81, s101, 16384
    s_add_u32 s101, s101, s69
    v_add_u32 v88, 0, v2
    v_add_u32 v89, 0, v4
    s_barrier
    ds_read_b64_tr_b16 v[160:161], v88 offset:0
    ds_read_b64_tr_b16 v[162:163], v88 offset:3072
    ds_read_b64_tr_b16 v[164:165], v89 offset:0
    ds_read_b64_tr_b16 v[166:167], v89 offset:3072
    ds_read_b64_tr_b16 v[168:169], v88 offset:1024
    ds_read_b64_tr_b16 v[170:171], v88 offset:4096
    ds_read_b64_tr_b16 v[172:173], v89 offset:1024
    ds_read_b64_tr_b16 v[174:175], v89 offset:4096
    ds_read_b64_tr_b16 v[176:177], v88 offset:2048
    ds_read_b64_tr_b16 v[178:179], v88 offset:5120
    ds_read_b64_tr_b16 v[180:181], v89 offset:2048
    ds_read_b64_tr_b16 v[182:183], v89 offset:5120
    ds_read_b64_tr_b16 v[144:145], v76 offset:0
    ds_read_b64_tr_b16 v[146:147], v76 offset:3072
    ds_read_b64_tr_b16 v[148:149], v78 offset:0
    ds_read_b64_tr_b16 v[150:151], v78 offset:3072
    s_waitcnt lgkmcnt(10)
    v_mfma_f32_16x16x32_bf16 v[96:99], v[160:163], a[0:3], 0
    ds_read_b64_tr_b16 v[188:189], v88 offset:6144
    s_add_u32 m0, s91, 53248
    v_mfma_f32_16x16x32_bf16 v[104:107], v[160:163], a[4:7], 0
    ds_read_b64_tr_b16 v[190:191], v88 offset:9216
    buffer_load_dwordx4 v244, s[4:7], s76 offen offset:0 lds
    v_mfma_f32_16x16x32_bf16 v[100:103], v[164:167], a[0:3], 0
    ds_read_b64_tr_b16 v[192:193], v89 offset:6144
    v_add_u32 v90, 24576, v2
    v_mfma_f32_16x16x32_bf16 v[108:111], v[164:167], a[4:7], 0
    ds_read_b64_tr_b16 v[156:157], v78 offset:6144
    ds_read_b64_tr_b16 v[194:195], v89 offset:9216
    v_mfma_f32_16x16x32_bf16 v[112:115], v[168:171], a[0:3], 0
    ds_read_b64_tr_b16 v[196:197], v88 offset:7168
    buffer_load_dwordx4 v245, s[4:7], s76 offen offset:1024 lds
    v_mfma_f32_16x16x32_bf16 v[120:123], v[168:171], a[4:7], 0
    ds_read_b64_tr_b16 v[198:199], v88 offset:10240
    s_waitcnt lgkmcnt(14)
    v_mfma_f32_16x16x32_bf16 v[116:119], v[172:175], a[0:3], 0
    ds_read_b64_tr_b16 v[200:201], v89 offset:7168
    v_add_u32 v91, 24576, v4
    v_mfma_f32_16x16x32_bf16 v[124:127], v[172:175], a[4:7], 0
    ds_read_b64_tr_b16 v[202:203], v89 offset:10240
    buffer_load_dwordx4 v246, s[4:7], s76 offen offset:2048 lds
    s_waitcnt lgkmcnt(14)
    v_mfma_f32_16x16x32_bf16 v[128:131], a[0:3], v[176:179], 0
    ds_read_b64_tr_b16 v[204:205], v88 offset:8192
    v_add_u32 v222, 0, v23
    v_mfma_f32_16x16x32_bf16 v[136:139], a[4:7], v[176:179], 0
    ds_read_b64_tr_b16 v[158:159], v78 offset:9216
    ds_read_b64_tr_b16 v[206:207], v88 offset:11264
    s_waitcnt lgkmcnt(14)
    v_mfma_f32_16x16x32_bf16 v[132:135], a[0:3], v[180:183], 0
    ds_read_b64_tr_b16 v[208:209], v89 offset:8192
    buffer_load_dwordx4 v247, s[4:7], s76 offen offset:3072 lds
    v_mfma_f32_16x16x32_bf16 v[140:143], a[4:7], v[180:183], 0
    ds_read_b64_tr_b16 v[210:211], v89 offset:11264
    s_waitcnt lgkmcnt(14)
    v_mfma_f32_16x16x32_bf16 v[224:227], v[144:147], v[68:71], 0
    ds_read_b64_tr_b16 v[152:153], v76 offset:6144
    s_add_u32 m0, s50, 24576
    v_mfma_f32_16x16x32_bf16 v[228:231], v[68:71], v[148:151], 0
    ds_read_b64_tr_b16 v[154:155], v76 offset:9216
    s_add_u32 s76, s49, 393216
    buffer_load_dwordx4 v14, s[8:11], s76 offen lds
    s_waitcnt lgkmcnt(9)
    v_mfma_f32_16x16x32_bf16 v[96:99], v[188:191], a[8:11], v[96:99]
    ds_read_b64_tr_b16 v[160:161], v88 offset:12288
    s_mov_b32 s80, 0
    v_mfma_f32_16x16x32_bf16 v[104:107], v[188:191], a[12:15], v[104:107]
    ds_read_b64_tr_b16 v[162:163], v88 offset:15360
    buffer_load_dwordx4 v14, s[8:11], s76 offen offset:1024 lds
    v_mfma_f32_16x16x32_bf16 v[100:103], v[192:195], a[8:11], v[100:103]
    ds_read_b64_tr_b16 v[164:165], v89 offset:12288
    v_mfma_f32_16x16x32_bf16 v[108:111], v[192:195], a[12:15], v[108:111]
    ds_read_b64_tr_b16 v[148:149], v78 offset:12288
    ds_read_b64_tr_b16 v[166:167], v89 offset:15360
    v_mfma_f32_16x16x32_bf16 v[112:115], v[196:199], a[8:11], v[112:115]
    ds_read_b64_tr_b16 v[168:169], v88 offset:13312
    buffer_load_dwordx4 v14, s[8:11], s76 offen offset:2048 lds
    v_mfma_f32_16x16x32_bf16 v[120:123], v[196:199], a[12:15], v[120:123]
    ds_read_b64_tr_b16 v[170:171], v88 offset:16384
    s_waitcnt lgkmcnt(9)
    v_mfma_f32_16x16x32_bf16 v[116:119], v[200:203], a[8:11], v[116:119]
    ds_read_b64_tr_b16 v[172:173], v89 offset:13312
    s_add_u32 m0, s50, 36864
    v_mfma_f32_16x16x32_bf16 v[124:127], v[200:203], a[12:15], v[124:127]
    ds_read_b64_tr_b16 v[174:175], v89 offset:16384
    s_add_u32 s76, s49, 589824
    buffer_load_dwordx4 v14, s[8:11], s76 offen lds
    v_mfma_f32_16x16x32_bf16 v[128:131], a[8:11], v[204:207], v[128:131]
    ds_read_b64_tr_b16 v[176:177], v88 offset:14336
    v_mfma_f32_16x16x32_bf16 v[136:139], a[12:15], v[204:207], v[136:139]
    ds_read_b64_tr_b16 v[150:151], v78 offset:15360
    ds_read_b64_tr_b16 v[178:179], v88 offset:17408
    v_mfma_f32_16x16x32_bf16 v[132:135], a[8:11], v[208:211], v[132:135]
    ds_read_b64_tr_b16 v[180:181], v89 offset:14336
    buffer_load_dwordx4 v14, s[8:11], s76 offen offset:1024 lds
    v_mfma_f32_16x16x32_bf16 v[140:143], a[12:15], v[208:211], v[140:143]
    ds_read_b64_tr_b16 v[182:183], v89 offset:17408
    s_waitcnt lgkmcnt(14)
    v_mfma_f32_16x16x32_bf16 v[224:227], v[152:155], v[68:71], v[224:227]
    ds_read_b64_tr_b16 v[144:145], v76 offset:12288
    v_mfma_f32_16x16x32_bf16 v[228:231], v[68:71], v[156:159], v[228:231]
    ds_read_b64_tr_b16 v[146:147], v76 offset:15360
    buffer_load_dwordx4 v14, s[8:11], s76 offen offset:2048 lds
    s_waitcnt lgkmcnt(9)
    v_mfma_f32_16x16x32_bf16 v[96:99], v[160:163], a[16:19], v[96:99]
    ds_read_b64_tr_b16 v[188:189], v88 offset:18432
    s_waitcnt vmcnt(6)
    v_mfma_f32_16x16x32_bf16 v[104:107], v[160:163], a[20:23], v[104:107]
    ds_read_b64 a[32:33], v248 offset:0
    ds_read_b64_tr_b16 v[190:191], v88 offset:21504
    s_mov_b32 s77, 786432
    buffer_load_dword v19, v86, s[8:11], s77 offen
    v_mfma_f32_16x16x32_bf16 v[100:103], v[164:167], a[16:19], v[100:103]
    ds_read_b64 a[34:35], v249 offset:0
    ds_read_b64_tr_b16 v[192:193], v89 offset:18432
    v_mfma_f32_16x16x32_bf16 v[108:111], v[164:167], a[20:23], v[108:111]
    ds_read_b64 a[36:37], v248 offset:256
    ds_read_b64_tr_b16 v[156:157], v78 offset:18432
    ds_read_b64_tr_b16 v[194:195], v89 offset:21504
    v_mfma_f32_16x16x32_bf16 v[112:115], v[168:171], a[16:19], v[112:115]
    ds_read_b64 a[38:39], v249 offset:256
    ds_read_b64_tr_b16 v[196:197], v88 offset:19456
    s_mov_b32 s77, 1048576
    buffer_load_dword v19, v86, s[8:11], s77 offen
    v_mfma_f32_16x16x32_bf16 v[120:123], v[168:171], a[20:23], v[120:123]
    ds_read_b64 a[40:41], v250 offset:0
    ds_read_b64_tr_b16 v[198:199], v88 offset:22528
    s_waitcnt lgkmcnt(14)
    v_mfma_f32_16x16x32_bf16 v[116:119], v[172:175], a[16:19], v[116:119]
    ds_read_b64 a[42:43], v251 offset:0
    ds_read_b64_tr_b16 v[200:201], v89 offset:19456
    v_mfma_f32_16x16x32_bf16 v[124:127], v[172:175], a[20:23], v[124:127]
    ds_read_b64 a[44:45], v250 offset:256
    ds_read_b64_tr_b16 v[202:203], v89 offset:22528
    s_mov_b32 s77, 1310720
    buffer_load_dword v19, v86, s[8:11], s77 offen
    v_mfma_f32_16x16x32_bf16 v[128:131], a[16:19], v[176:179], v[128:131]
    ds_read_b64 a[46:47], v251 offset:256
    ds_read_b64_tr_b16 v[204:205], v88 offset:20480
    v_mfma_f32_16x16x32_bf16 v[136:139], a[20:23], v[176:179], v[136:139]
    ds_read_b64 a[48:49], v252 offset:0
    ds_read_b64_tr_b16 v[158:159], v78 offset:21504
    ds_read_b64_tr_b16 v[206:207], v88 offset:23552
    v_mfma_f32_16x16x32_bf16 v[132:135], a[16:19], v[180:183], v[132:135]
    ds_read_b64 a[50:51], v253 offset:0
    ds_read_b64_tr_b16 v[208:209], v89 offset:20480
    s_add_u32 s76, s90, 512
    s_add_u32 m0, s91, 126976
    s_nop 0
    buffer_load_dwordx4 v240, s[4:7], s76 offen offset:0 lds
    v_mfma_f32_16x16x32_bf16 v[140:143], a[20:23], v[180:183], v[140:143]
    ds_read_b64 a[52:53], v252 offset:256
    ds_read_b64_tr_b16 v[210:211], v89 offset:23552
    s_waitcnt lgkmcnt(14)
    v_mfma_f32_16x16x32_bf16 v[224:227], v[144:147], v[68:71], v[224:227]
    ds_read_b64 a[54:55], v253 offset:256
    ds_read_b64_tr_b16 v[152:153], v76 offset:18432
    v_mfma_f32_16x16x32_bf16 v[228:231], v[68:71], v[148:151], v[228:231]
    ds_read_b64 a[56:57], v254 offset:0
    ds_read_b64 a[58:59], v255 offset:0
    ds_read_b64 a[60:61], v254 offset:256
    ds_read_b64 a[62:63], v255 offset:256
    ds_read_b64_tr_b16 v[154:155], v76 offset:21504
    buffer_load_dwordx4 v241, s[4:7], s76 offen offset:1024 lds
    s_waitcnt lgkmcnt(1)
    s_waitcnt vmcnt(5)
    s_barrier
    v_mfma_f32_16x16x32_bf16 v[96:99], v[188:191], a[24:27], v[96:99]
    ds_read_b64_tr_b16 v[160:161], v90 offset:0
    ds_read_b64_tr_b16 a[128:129], v84 offset:0
    v_mfma_f32_16x16x32_bf16 v[104:107], v[188:191], a[28:31], v[104:107]
    ds_read_b64_tr_b16 v[162:163], v90 offset:3072
    buffer_load_dwordx4 v242, s[4:7], s76 offen offset:2048 lds
    v_mfma_f32_16x16x32_bf16 v[100:103], v[192:195], a[24:27], v[100:103]
    ds_read_b64_tr_b16 v[164:165], v91 offset:0
    ds_read_b64_tr_b16 a[130:131], v84 offset:3072
    v_mfma_f32_16x16x32_bf16 v[108:111], v[192:195], a[28:31], v[108:111]
    ds_read_b64_tr_b16 v[148:149], v78 offset:24576
    ds_read_b64_tr_b16 v[166:167], v91 offset:3072
    v_mfma_f32_16x16x32_bf16 v[112:115], v[196:199], a[24:27], v[112:115]
    ds_read_b64_tr_b16 v[168:169], v90 offset:1024
    buffer_load_dwordx4 v243, s[4:7], s76 offen offset:3072 lds
    v_mfma_f32_16x16x32_bf16 v[120:123], v[196:199], a[28:31], v[120:123]
    ds_read_b64_tr_b16 v[170:171], v90 offset:4096
    v_mfma_f32_16x16x32_bf16 v[116:119], v[200:203], a[24:27], v[116:119]
    ds_read_b64_tr_b16 v[172:173], v91 offset:1024
    s_add_u32 m0, s91, 131072
    v_mfma_f32_16x16x32_bf16 v[124:127], v[200:203], a[28:31], v[124:127]
    ds_read_b64_tr_b16 v[174:175], v91 offset:4096
    buffer_load_dwordx4 v244, s[4:7], s76 offen offset:0 lds
    v_mfma_f32_16x16x32_bf16 v[128:131], a[24:27], v[204:207], v[128:131]
    ds_read_b64_tr_b16 v[176:177], v90 offset:2048
    ds_read_b64_tr_b16 a[132:133], v84 offset:1024
    v_mfma_f32_16x16x32_bf16 v[136:139], a[28:31], v[204:207], v[136:139]
    ds_read_b64_tr_b16 v[150:151], v78 offset:27648
    ds_read_b64_tr_b16 v[178:179], v90 offset:5120
    v_mfma_f32_16x16x32_bf16 v[132:135], a[24:27], v[208:211], v[132:135]
    ds_read_b64_tr_b16 v[180:181], v91 offset:2048
    buffer_load_dwordx4 v245, s[4:7], s76 offen offset:1024 lds
    v_mfma_f32_16x16x32_bf16 v[140:143], a[28:31], v[208:211], v[140:143]
    ds_read_b64_tr_b16 v[182:183], v91 offset:5120
    s_waitcnt lgkmcnt(14)
    v_mfma_f32_16x16x32_bf16 v[224:227], v[152:155], v[68:71], v[224:227]
    ds_read_b64_tr_b16 v[144:145], v76 offset:24576
    ds_read_b64_tr_b16 a[134:135], v84 offset:4096
    v_mfma_f32_16x16x32_bf16 v[228:231], v[68:71], v[156:159], v[228:231]
    ds_read_b64_tr_b16 v[146:147], v76 offset:27648
    buffer_load_dwordx4 v246, s[4:7], s76 offen offset:2048 lds
    s_waitcnt lgkmcnt(11)
    v_mfma_f32_16x16x32_bf16 v[96:99], v[160:163], a[32:35], v[96:99]
    ds_read_b64_tr_b16 v[188:189], v90 offset:6144
    v_add_u32 v88, 49152, v2
    v_mfma_f32_16x16x32_bf16 v[104:107], v[160:163], a[36:39], v[104:107]
    ds_read_b64_tr_b16 v[190:191], v90 offset:9216
    buffer_load_dwordx4 v247, s[4:7], s76 offen offset:3072 lds
    v_mfma_f32_16x16x32_bf16 v[100:103], v[164:167], a[32:35], v[100:103]
    ds_read_b64_tr_b16 v[192:193], v91 offset:6144
    v_add_u32 v89, 49152, v4
    v_mfma_f32_16x16x32_bf16 v[108:111], v[164:167], a[36:39], v[108:111]
    ds_read_b64_tr_b16 v[156:157], v78 offset:30720
    ds_read_b64_tr_b16 v[194:195], v91 offset:9216
    v_mfma_f32_16x16x32_bf16 v[112:115], v[168:171], a[32:35], v[112:115]
    ds_read_b64_tr_b16 v[196:197], v90 offset:7168
    s_mov_b64 exec, s[42:43]
    buffer_store_dwordx2 v[216:217], off, s[28:31], s41
    s_mov_b64 exec, -1
    v_mfma_f32_16x16x32_bf16 v[120:123], v[168:171], a[36:39], v[120:123]
    ds_read_b64_tr_b16 v[198:199], v90 offset:10240
    s_waitcnt lgkmcnt(10)
    v_mfma_f32_16x16x32_bf16 v[116:119], v[172:175], a[32:35], v[116:119]
    ds_read_b64_tr_b16 v[200:201], v91 offset:7168
    ds_read_b64_tr_b16 a[136:137], v84 offset:2048
    v_mfma_f32_16x16x32_bf16 v[124:127], v[172:175], a[36:39], v[124:127]
    ds_read_b64_tr_b16 v[202:203], v91 offset:10240
    v_mov_b32 v218, s63
    v_mov_b32 v219, s64
    s_mov_b64 exec, s[66:67]
    buffer_store_dwordx2 v[218:219], off, s[28:31], s65 sc1
    s_mov_b64 exec, -1
    v_mfma_f32_16x16x32_bf16 v[128:131], a[32:35], v[176:179], v[128:131]
    ds_read_b64_tr_b16 v[204:205], v90 offset:8192
    s_add_u32 m0, s50, 49152
    v_mfma_f32_16x16x32_bf16 v[136:139], a[36:39], v[176:179], v[136:139]
    ds_read_b64_tr_b16 v[158:159], v78 offset:33792
    ds_read_b64_tr_b16 v[206:207], v90 offset:11264
    v_mfma_f32_16x16x32_bf16 v[132:135], a[32:35], v[180:183], v[132:135]
    ds_read_b64_tr_b16 v[208:209], v91 offset:8192
    s_add_u32 s76, s49, 786432
    buffer_load_dwordx4 v14, s[8:11], s76 offen lds
    v_mfma_f32_16x16x32_bf16 v[140:143], a[36:39], v[180:183], v[140:143]
    ds_read_b64_tr_b16 v[210:211], v91 offset:11264
    s_waitcnt lgkmcnt(14)
    v_mfma_f32_16x16x32_bf16 v[224:227], v[144:147], v[68:71], v[224:227]
    ds_read_b64_tr_b16 v[152:153], v76 offset:30720
    ds_read_b64_tr_b16 a[138:139], v84 offset:5120
    v_mfma_f32_16x16x32_bf16 v[228:231], v[68:71], v[148:151], v[228:231]
    ds_read_b64_tr_b16 v[154:155], v76 offset:33792
    buffer_load_dwordx4 v14, s[8:11], s76 offen offset:1024 lds
    s_waitcnt lgkmcnt(11)
    v_mfma_f32_16x16x32_bf16 v[96:99], v[188:191], a[40:43], v[96:99]
    ds_read_b64_tr_b16 v[160:161], v90 offset:12288
    v_add_u32 v248, 0x10000, v248
    v_add_u32 v249, 0x10000, v249
    v_add_u32 v250, 0x10000, v250
    v_add_u32 v251, 0x10000, v251
    v_add_u32 v252, 0x10000, v252
    v_add_u32 v253, 0x10000, v253
    v_add_u32 v254, 0x10000, v254
    v_add_u32 v255, 0x10000, v255
    s_waitcnt vmcnt(4)
    v_mfma_f32_16x16x32_bf16 v[104:107], v[188:191], a[44:47], v[104:107]
    ds_read_b64 a[64:65], v248 offset:12288
    ds_read_b64_tr_b16 v[162:163], v90 offset:15360
    buffer_load_dwordx4 v14, s[8:11], s76 offen offset:2048 lds
    v_mfma_f32_16x16x32_bf16 v[100:103], v[192:195], a[40:43], v[100:103]
    ds_read_b64 a[66:67], v249 offset:12288
    ds_read_b64_tr_b16 v[164:165], v91 offset:12288
    v_mfma_f32_16x16x32_bf16 v[108:111], v[192:195], a[44:47], v[108:111]
    ds_read_b64 a[68:69], v248 offset:12544
    ds_read_b64_tr_b16 v[148:149], v78 offset:36864
    ds_read_b64_tr_b16 v[166:167], v91 offset:15360
    v_mfma_f32_16x16x32_bf16 v[112:115], v[196:199], a[40:43], v[112:115]
    ds_read_b64 a[70:71], v249 offset:12544
    ds_read_b64_tr_b16 v[168:169], v90 offset:13312
    s_add_u32 m0, s50, 61440
    s_add_u32 s76, s49, 983040
    buffer_load_dwordx4 v14, s[8:11], s76 offen lds
    v_mfma_f32_16x16x32_bf16 v[120:123], v[196:199], a[44:47], v[120:123]
    ds_read_b64 a[72:73], v250 offset:12288
    ds_read_b64_tr_b16 v[170:171], v90 offset:16384
    s_waitcnt lgkmcnt(14)
    v_mfma_f32_16x16x32_bf16 v[116:119], v[200:203], a[40:43], v[116:119]
    ds_read_b64 a[74:75], v251 offset:12288
    ds_read_b64_tr_b16 v[172:173], v91 offset:13312
    v_mfma_f32_16x16x32_bf16 v[124:127], v[200:203], a[44:47], v[124:127]
    ds_read_b64 a[76:77], v250 offset:12544
    ds_read_b64_tr_b16 v[174:175], v91 offset:16384
    buffer_load_dwordx4 v14, s[8:11], s76 offen offset:1024 lds
    v_mfma_f32_16x16x32_bf16 v[128:131], a[40:43], v[204:207], v[128:131]
    ds_read_b64 a[78:79], v251 offset:12544
    ds_read_b64_tr_b16 v[176:177], v90 offset:14336
    v_mfma_f32_16x16x32_bf16 v[136:139], a[44:47], v[204:207], v[136:139]
    ds_read_b64 a[80:81], v252 offset:12288
    ds_read_b64_tr_b16 v[150:151], v78 offset:39936
    ds_read_b64_tr_b16 v[178:179], v90 offset:17408
    v_mfma_f32_16x16x32_bf16 v[132:135], a[40:43], v[208:211], v[132:135]
    ds_read_b64 a[82:83], v253 offset:12288
    ds_read_b64_tr_b16 v[180:181], v91 offset:14336
    buffer_load_dwordx4 v14, s[8:11], s76 offen offset:2048 lds
    v_mfma_f32_16x16x32_bf16 v[140:143], a[44:47], v[208:211], v[140:143]
    ds_read_b64 a[84:85], v252 offset:12544
    ds_read_b64_tr_b16 v[182:183], v91 offset:17408
    s_waitcnt lgkmcnt(14)
    v_mfma_f32_16x16x32_bf16 v[224:227], v[152:155], v[68:71], v[224:227]
    ds_read_b64 a[86:87], v253 offset:12544
    ds_read_b64_tr_b16 v[144:145], v76 offset:36864
    v_mfma_f32_16x16x32_bf16 v[228:231], v[68:71], v[156:159], v[228:231]
    ds_read_b64 a[88:89], v254 offset:12288
    ds_read_b64 a[90:91], v255 offset:12288
    ds_read_b64 a[92:93], v254 offset:12544
    ds_read_b64 a[94:95], v255 offset:12544
    ds_read_b64_tr_b16 v[146:147], v76 offset:39936
    s_waitcnt lgkmcnt(1)
    v_mfma_f32_16x16x32_bf16 v[96:99], v[160:163], a[48:51], v[96:99]
    ds_read_b64_tr_b16 v[188:189], v90 offset:18432
    s_add_u32 s76, s90, 768
    v_mfma_f32_16x16x32_bf16 v[104:107], v[160:163], a[52:55], v[104:107]
    ds_read_b64_tr_b16 v[190:191], v90 offset:21504
    s_add_u32 m0, s91, 126976
    s_nop 0
    buffer_load_dwordx4 v240, s[4:7], s76 offen offset:0 lds
    v_mfma_f32_16x16x32_bf16 v[100:103], v[164:167], a[48:51], v[100:103]
    ds_read_b64_tr_b16 v[192:193], v91 offset:18432
    ds_read_b64_tr_b16 a[140:141], v84 offset:12288
    v_mfma_f32_16x16x32_bf16 v[108:111], v[164:167], a[52:55], v[108:111]
    ds_read_b64_tr_b16 v[156:157], v78 offset:43008
    ds_read_b64_tr_b16 v[194:195], v91 offset:21504
    v_mfma_f32_16x16x32_bf16 v[112:115], v[168:171], a[48:51], v[112:115]
    ds_read_b64_tr_b16 v[196:197], v90 offset:19456
    buffer_load_dwordx4 v241, s[4:7], s76 offen offset:1024 lds
    v_mfma_f32_16x16x32_bf16 v[120:123], v[168:171], a[52:55], v[120:123]
    ds_read_b64_tr_b16 v[198:199], v90 offset:22528
    v_mfma_f32_16x16x32_bf16 v[116:119], v[172:175], a[48:51], v[116:119]
    ds_read_b64_tr_b16 v[200:201], v91 offset:19456
    ds_read_b64_tr_b16 a[142:143], v84 offset:15360
    v_mfma_f32_16x16x32_bf16 v[124:127], v[172:175], a[52:55], v[124:127]
    ds_read_b64_tr_b16 v[202:203], v91 offset:22528
    buffer_load_dwordx4 v242, s[4:7], s76 offen offset:2048 lds
    v_mfma_f32_16x16x32_bf16 v[128:131], a[48:51], v[176:179], v[128:131]
    ds_read_b64_tr_b16 v[204:205], v90 offset:20480
    ds_read_b64_tr_b16 a[144:145], v84 offset:13312
    v_mfma_f32_16x16x32_bf16 v[136:139], a[52:55], v[176:179], v[136:139]
    ds_read_b64_tr_b16 v[158:159], v78 offset:46080
    ds_read_b64_tr_b16 v[206:207], v90 offset:23552
    v_mfma_f32_16x16x32_bf16 v[132:135], a[48:51], v[180:183], v[132:135]
    ds_read_b64_tr_b16 v[208:209], v91 offset:20480
    buffer_load_dwordx4 v243, s[4:7], s76 offen offset:3072 lds
    v_mfma_f32_16x16x32_bf16 v[140:143], a[52:55], v[180:183], v[140:143]
    ds_read_b64_tr_b16 v[210:211], v91 offset:23552
    s_waitcnt lgkmcnt(14)
    v_mfma_f32_16x16x32_bf16 v[224:227], v[144:147], v[68:71], v[224:227]
    ds_read_b64_tr_b16 v[152:153], v76 offset:43008
    s_add_u32 m0, s91, 131072
    v_mfma_f32_16x16x32_bf16 v[228:231], v[68:71], v[148:151], v[228:231]
    ds_read_b64_tr_b16 v[154:155], v76 offset:46080
    buffer_load_dwordx4 v244, s[4:7], s76 offen offset:0 lds
    s_waitcnt lgkmcnt(11)
    s_waitcnt vmcnt(5)
    s_barrier
    v_mfma_f32_16x16x32_bf16 v[96:99], v[188:191], a[56:59], v[96:99]
    ds_read_b64_tr_b16 v[160:161], v88 offset:0
    ds_read_b64_tr_b16 a[146:147], v84 offset:16384
    v_mfma_f32_16x16x32_bf16 v[104:107], v[188:191], a[60:63], v[104:107]
    ds_read_b64_tr_b16 v[162:163], v88 offset:3072
    buffer_load_dwordx4 v245, s[4:7], s76 offen offset:1024 lds
    v_mfma_f32_16x16x32_bf16 v[100:103], v[192:195], a[56:59], v[100:103]
    ds_read_b64_tr_b16 v[164:165], v89 offset:0
    ds_read_b64_tr_b16 a[148:149], v84 offset:14336
    v_mfma_f32_16x16x32_bf16 v[108:111], v[192:195], a[60:63], v[108:111]
    ds_read_b64_tr_b16 v[148:149], v79 offset:0
    ds_read_b64_tr_b16 v[166:167], v89 offset:3072
    v_mfma_f32_16x16x32_bf16 v[112:115], v[196:199], a[56:59], v[112:115]
    ds_read_b64_tr_b16 v[168:169], v88 offset:1024
    buffer_load_dwordx4 v246, s[4:7], s76 offen offset:2048 lds
    v_mfma_f32_16x16x32_bf16 v[120:123], v[196:199], a[60:63], v[120:123]
    ds_read_b64_tr_b16 v[170:171], v88 offset:4096
    s_waitcnt lgkmcnt(11)
    v_mfma_f32_16x16x32_bf16 v[116:119], v[200:203], a[56:59], v[116:119]
    ds_read_b64_tr_b16 v[172:173], v89 offset:1024
    ds_read_b64_tr_b16 a[150:151], v84 offset:17408
    v_mfma_f32_16x16x32_bf16 v[124:127], v[200:203], a[60:63], v[124:127]
    ds_read_b64_tr_b16 v[174:175], v89 offset:4096
    buffer_load_dwordx4 v247, s[4:7], s76 offen offset:3072 lds
    v_mfma_f32_16x16x32_bf16 v[128:131], a[56:59], v[204:207], v[128:131]
    ds_read_b64_tr_b16 v[176:177], v88 offset:2048
    s_add_u32 m0, s50, 73728
    v_mfma_f32_16x16x32_bf16 v[136:139], a[60:63], v[204:207], v[136:139]
    ds_read_b64_tr_b16 v[150:151], v79 offset:3072
    ds_read_b64_tr_b16 v[178:179], v88 offset:5120
    v_mfma_f32_16x16x32_bf16 v[132:135], a[56:59], v[208:211], v[132:135]
    ds_read_b64_tr_b16 v[180:181], v89 offset:2048
    s_add_u32 s76, s49, 1179648
    buffer_load_dwordx4 v14, s[8:11], s76 offen lds
    v_mfma_f32_16x16x32_bf16 v[140:143], a[60:63], v[208:211], v[140:143]
    ds_read_b64_tr_b16 v[182:183], v89 offset:5120
    s_waitcnt lgkmcnt(14)
    v_mfma_f32_16x16x32_bf16 v[224:227], v[152:155], v[68:71], v[224:227]
    ds_read_b64_tr_b16 v[144:145], v77 offset:0
    ds_read_b64_tr_b16 a[152:153], v84 offset:24576
    v_mfma_f32_16x16x32_bf16 v[228:231], v[68:71], v[156:159], v[228:231]
    ds_read_b64_tr_b16 v[146:147], v77 offset:3072
    buffer_load_dwordx4 v14, s[8:11], s76 offen offset:1024 lds
    s_waitcnt lgkmcnt(11)
    v_mfma_f32_16x16x32_bf16 v[96:99], v[160:163], a[64:67], v[96:99]
    ds_read_b64_tr_b16 v[188:189], v88 offset:6144
    v_add_u32 v90, 73728, v2
    v_mfma_f32_16x16x32_bf16 v[104:107], v[160:163], a[68:71], v[104:107]
    ds_read_b64_tr_b16 v[190:191], v88 offset:9216
    buffer_load_dwordx4 v14, s[8:11], s76 offen offset:2048 lds
    v_mfma_f32_16x16x32_bf16 v[100:103], v[164:167], a[64:67], v[100:103]
    ds_read_b64_tr_b16 v[192:193], v89 offset:6144
    s_add_u32 m0, s50, 86016
    v_mfma_f32_16x16x32_bf16 v[108:111], v[164:167], a[68:71], v[108:111]
    ds_read_b64_tr_b16 v[156:157], v79 offset:6144
    ds_read_b64_tr_b16 v[194:195], v89 offset:9216
    v_mfma_f32_16x16x32_bf16 v[112:115], v[168:171], a[64:67], v[112:115]
    ds_read_b64_tr_b16 v[196:197], v88 offset:7168
    s_add_u32 s76, s49, 1376256
    buffer_load_dwordx4 v14, s[8:11], s76 offen lds
    v_mfma_f32_16x16x32_bf16 v[120:123], v[168:171], a[68:71], v[120:123]
    ds_read_b64_tr_b16 v[198:199], v88 offset:10240
    s_waitcnt lgkmcnt(10)
    v_mfma_f32_16x16x32_bf16 v[116:119], v[172:175], a[64:67], v[116:119]
    ds_read_b64_tr_b16 v[200:201], v89 offset:7168
    v_add_u32 v91, 73728, v4
    v_mfma_f32_16x16x32_bf16 v[124:127], v[172:175], a[68:71], v[124:127]
    ds_read_b64_tr_b16 v[202:203], v89 offset:10240
    buffer_load_dwordx4 v14, s[8:11], s76 offen offset:1024 lds
    v_mfma_f32_16x16x32_bf16 v[128:131], a[64:67], v[176:179], v[128:131]
    ds_read_b64_tr_b16 v[204:205], v88 offset:8192
    ds_read_b64_tr_b16 a[154:155], v84 offset:27648
    v_mfma_f32_16x16x32_bf16 v[136:139], a[68:71], v[176:179], v[136:139]
    ds_read_b64_tr_b16 v[158:159], v79 offset:9216
    ds_read_b64_tr_b16 v[206:207], v88 offset:11264
    v_mfma_f32_16x16x32_bf16 v[132:135], a[64:67], v[180:183], v[132:135]
    ds_read_b64_tr_b16 v[208:209], v89 offset:8192
    buffer_load_dwordx4 v14, s[8:11], s76 offen offset:2048 lds
    v_mfma_f32_16x16x32_bf16 v[140:143], a[68:71], v[180:183], v[140:143]
    ds_read_b64_tr_b16 v[210:211], v89 offset:11264
    s_waitcnt lgkmcnt(14)
    v_mfma_f32_16x16x32_bf16 v[224:227], v[144:147], v[68:71], v[224:227]
    ds_read_b64_tr_b16 v[152:153], v77 offset:6144
    ds_read_b64_tr_b16 a[156:157], v84 offset:25600
    v_mfma_f32_16x16x32_bf16 v[228:231], v[68:71], v[148:151], v[228:231]
    ds_read_b64_tr_b16 v[154:155], v77 offset:9216
    buffer_load_dwordx2 v[220:221], v25, s[28:31], 0 offen sc1
    s_waitcnt lgkmcnt(11)
    v_mfma_f32_16x16x32_bf16 v[96:99], v[188:191], a[72:75], v[96:99]
    ds_read_b64_tr_b16 v[160:161], v88 offset:12288
    ds_read_b64_tr_b16 a[158:159], v84 offset:28672
    v_mfma_f32_16x16x32_bf16 v[104:107], v[188:191], a[76:79], v[104:107]
    ds_read_b64_tr_b16 v[162:163], v88 offset:15360
    buffer_load_dwordx2 v[238:239], v22, s[28:31], 0 offen sc1
    v_mfma_f32_16x16x32_bf16 v[100:103], v[192:195], a[72:75], v[100:103]
    ds_read_b64_tr_b16 v[164:165], v89 offset:12288
    ds_read_b64_tr_b16 a[160:161], v84 offset:26624
    v_mfma_f32_16x16x32_bf16 v[108:111], v[192:195], a[76:79], v[108:111]
    ds_read_b64_tr_b16 v[148:149], v79 offset:12288
    ds_read_b64_tr_b16 v[166:167], v89 offset:15360
    v_mfma_f32_16x16x32_bf16 v[112:115], v[196:199], a[72:75], v[112:115]
    ds_read_b64_tr_b16 v[168:169], v88 offset:13312
    ds_read_b64_tr_b16 a[162:163], v84 offset:29696
    v_mfma_f32_16x16x32_bf16 v[120:123], v[196:199], a[76:79], v[120:123]
    ds_read_b64_tr_b16 v[170:171], v88 offset:16384
    s_waitcnt lgkmcnt(13)
    v_mfma_f32_16x16x32_bf16 v[116:119], v[200:203], a[72:75], v[116:119]
    ds_read_b64_tr_b16 v[172:173], v89 offset:13312
    ds_read_b64_tr_b16 a[164:165], v84 offset:36864
    v_mfma_f32_16x16x32_bf16 v[124:127], v[200:203], a[76:79], v[124:127]
    ds_read_b64_tr_b16 v[174:175], v89 offset:16384
    ds_read_b64_tr_b16 a[166:167], v84 offset:39936
    v_mfma_f32_16x16x32_bf16 v[128:131], a[72:75], v[204:207], v[128:131]
    ds_read_b64_tr_b16 v[176:177], v88 offset:14336
    ds_read_b64_tr_b16 a[168:169], v84 offset:37888
    v_mfma_f32_16x16x32_bf16 v[136:139], a[76:79], v[204:207], v[136:139]
    ds_read_b64_tr_b16 v[150:151], v79 offset:15360
    ds_read_b64_tr_b16 v[178:179], v88 offset:17408
    v_mfma_f32_16x16x32_bf16 v[132:135], a[72:75], v[208:211], v[132:135]
    ds_read_b64_tr_b16 v[180:181], v89 offset:14336
    ds_read_b64_tr_b16 a[170:171], v84 offset:40960
    v_mfma_f32_16x16x32_bf16 v[140:143], a[76:79], v[208:211], v[140:143]
    ds_read_b64_tr_b16 v[182:183], v89 offset:17408
    s_waitcnt lgkmcnt(14)
    v_mfma_f32_16x16x32_bf16 v[224:227], v[152:155], v[68:71], v[224:227]
    ds_read_b64_tr_b16 v[144:145], v77 offset:12288
    ds_read_b64_tr_b16 a[172:173], v84 offset:38912
    v_mfma_f32_16x16x32_bf16 v[228:231], v[68:71], v[156:159], v[228:231]
    ds_read_b64_tr_b16 v[146:147], v77 offset:15360
    s_waitcnt lgkmcnt(14)
    v_mfma_f32_16x16x32_bf16 v[96:99], v[160:163], a[80:83], v[96:99]
    ds_read_b64_tr_b16 v[188:189], v88 offset:18432
    s_waitcnt vmcnt(8)
    v_mfma_f32_16x16x32_bf16 v[104:107], v[160:163], a[84:87], v[104:107]
    ds_read_b64 a[96:97], v248 offset:12288
    ds_read_b64_tr_b16 v[190:191], v88 offset:21504
    v_mfma_f32_16x16x32_bf16 v[100:103], v[164:167], a[80:83], v[100:103]
    ds_read_b64 a[98:99], v249 offset:12288
    ds_read_b64_tr_b16 v[192:193], v89 offset:18432
    v_mfma_f32_16x16x32_bf16 v[108:111], v[164:167], a[84:87], v[108:111]
    ds_read_b64 a[100:101], v248 offset:12544
    ds_read_b64_tr_b16 v[156:157], v79 offset:18432
    ds_read_b64_tr_b16 v[194:195], v89 offset:21504
    v_mfma_f32_16x16x32_bf16 v[112:115], v[168:171], a[80:83], v[112:115]
    ds_read_b64 a[102:103], v249 offset:12544
    ds_read_b64_tr_b16 v[196:197], v88 offset:19456
    v_mfma_f32_16x16x32_bf16 v[120:123], v[168:171], a[84:87], v[120:123]
    ds_read_b64 a[104:105], v250 offset:12288
    ds_read_b64_tr_b16 v[198:199], v88 offset:22528
    s_waitcnt lgkmcnt(14)
    v_mfma_f32_16x16x32_bf16 v[116:119], v[172:175], a[80:83], v[116:119]
    ds_read_b64 a[106:107], v251 offset:12288
    ds_read_b64_tr_b16 v[200:201], v89 offset:19456
    v_mfma_f32_16x16x32_bf16 v[124:127], v[172:175], a[84:87], v[124:127]
    ds_read_b64 a[108:109], v250 offset:12544
    ds_read_b64_tr_b16 v[202:203], v89 offset:22528
    v_mfma_f32_16x16x32_bf16 v[128:131], a[80:83], v[176:179], v[128:131]
    ds_read_b64 a[110:111], v251 offset:12544
    ds_read_b64_tr_b16 v[204:205], v88 offset:20480
    v_mfma_f32_16x16x32_bf16 v[136:139], a[84:87], v[176:179], v[136:139]
    ds_read_b64 a[112:113], v252 offset:12288
    ds_read_b64_tr_b16 v[158:159], v79 offset:21504
    ds_read_b64_tr_b16 v[206:207], v88 offset:23552
    v_mfma_f32_16x16x32_bf16 v[132:135], a[80:83], v[180:183], v[132:135]
    ds_read_b64 a[114:115], v253 offset:12288
    ds_read_b64_tr_b16 v[208:209], v89 offset:20480
    v_mfma_f32_16x16x32_bf16 v[140:143], a[84:87], v[180:183], v[140:143]
    ds_read_b64 a[116:117], v252 offset:12544
    ds_read_b64_tr_b16 v[210:211], v89 offset:23552
    s_waitcnt lgkmcnt(14)
    v_mfma_f32_16x16x32_bf16 v[224:227], v[144:147], v[68:71], v[224:227]
    ds_read_b64 a[118:119], v253 offset:12544
    ds_read_b64_tr_b16 v[152:153], v77 offset:18432
    v_mfma_f32_16x16x32_bf16 v[228:231], v[68:71], v[148:151], v[228:231]
    ds_read_b64 a[120:121], v254 offset:12288
    ds_read_b64 a[122:123], v255 offset:12288
    ds_read_b64 a[124:125], v254 offset:12544
    ds_read_b64 a[126:127], v255 offset:12544
    ds_read_b64_tr_b16 v[154:155], v77 offset:21504
    s_waitcnt lgkmcnt(1)
    s_waitcnt vmcnt(2)
    s_barrier
    v_mfma_f32_16x16x32_bf16 v[96:99], v[188:191], a[88:91], v[96:99]
    ds_read_b64_tr_b16 v[160:161], v90 offset:0
    s_waitcnt vmcnt(1)
    s_cmp_eq_u32 s32, 0
    s_cbranch_scc1 HDONE_2001
    s_branch PCHK_2003
POLL_2002:
    buffer_load_dwordx2 v[220:221], v25, s[28:31], 0 offen sc1
    s_waitcnt vmcnt(0)
PCHK_2003:
    v_sub_u32 v220, v220, v222
    v_cmp_eq_u32_e64 s[82:83], v221, v24
    v_cmp_gt_u32 vcc, 128, v220
    s_nop 1
    s_and_b64 vcc, vcc, s[82:83]
    s_cmp_eq_u64 vcc, -1
    s_cbranch_scc1 HDONE_2001
    s_add_u32 s80, s80, 1
    s_cmp_lt_u32 s80, 0x40000
    s_cbranch_scc1 POLL_2002
    s_branch L_END
HDONE_2001:
    s_mov_b32 s80, 0
    s_waitcnt vmcnt(0)
    s_nop 2
    s_mov_b64 exec, 0xffff
    s_branch PCHK_3007
POLL_3006:
    buffer_load_dwordx2 v[238:239], v22, s[28:31], 0 offen sc1
    s_waitcnt vmcnt(0)
PCHK_3007:
    v_sub_u32 v238, v238, v20
    v_cmp_eq_u32_e64 s[82:83], v239, v21
    v_cmp_gt_u32 vcc, 128, v238
    s_nop 1
    s_and_b64 vcc, vcc, s[82:83]
    s_cmp_eq_u64 vcc, exec
    s_cbranch_scc1 PDONE_3004
    s_and_b32 s68, s80, 7
    s_cmp_eq_u32 s68, 7
    s_cbranch_scc0 PNOREP_3005
    s_mov_b64 exec, s[42:43]
    buffer_store_dwordx2 v[216:217], off, s[28:31], s41 sc1
    s_mov_b64 exec, 0xffff
PNOREP_3005:
    s_add_u32 s80, s80, 1
    s_cmp_lt_u32 s80, 0x40000
    s_cbranch_scc1 POLL_3006
    s_branch L_END
PDONE_3004:
    v_and_b32 v238, 7, v238
    v_cmp_ne_u32 vcc, s37, v238
    s_nop 0
    s_cmp_lg_u64 vcc, 0
    s_cselect_b32 s38, 1, 0
    s_mov_b64 exec, -1
    s_mul_i32 s47, s38, 4278190080
    v_mfma_f32_16x16x32_bf16 v[104:107], v[188:191], a[92:95], v[104:107]
    ds_read_b64_tr_b16 v[162:163], v90 offset:3072
    buffer_load_dwordx4 v[240:243], v1, s[28:31], s100 offen sc1
    v_mfma_f32_16x16x32_bf16 v[100:103], v[192:195], a[88:91], v[100:103]
    ds_read_b64_tr_b16 v[164:165], v91 offset:0
    ds_read_b64_tr_b16 a[174:175], v84 offset:41984
    v_mfma_f32_16x16x32_bf16 v[108:111], v[192:195], a[92:95], v[108:111]
    ds_read_b64_tr_b16 v[148:149], v79 offset:24576
    ds_read_b64_tr_b16 v[166:167], v91 offset:3072
    v_mfma_f32_16x16x32_bf16 v[112:115], v[196:199], a[88:91], v[112:115]
    ds_read_b64_tr_b16 v[168:169], v90 offset:1024
    buffer_load_dwordx4 v[244:247], v1, s[28:31], s100 offen offset:1024 sc1
    v_mfma_f32_16x16x32_bf16 v[120:123], v[196:199], a[92:95], v[120:123]
    ds_read_b64_tr_b16 v[170:171], v90 offset:4096
    v_mfma_f32_16x16x32_bf16 v[116:119], v[200:203], a[88:91], v[116:119]
    ds_read_b64_tr_b16 v[172:173], v91 offset:1024
    ds_read_b64_tr_b16 a[176:177], v85 offset:0
    v_mfma_f32_16x16x32_bf16 v[124:127], v[200:203], a[92:95], v[124:127]
    ds_read_b64_tr_b16 v[174:175], v91 offset:4096
    buffer_load_dwordx4 v[232:235], v1, s[28:31], s81 offen sc1
    v_mfma_f32_16x16x32_bf16 v[128:131], a[88:91], v[204:207], v[128:131]
    ds_read_b64_tr_b16 v[176:177], v90 offset:2048
    ds_read_b64_tr_b16 a[178:179], v85 offset:3072
    v_mfma_f32_16x16x32_bf16 v[136:139], a[92:95], v[204:207], v[136:139]
    ds_read_b64_tr_b16 v[150:151], v79 offset:27648
    ds_read_b64_tr_b16 v[178:179], v90 offset:5120
    v_mfma_f32_16x16x32_bf16 v[132:135], a[88:91], v[208:211], v[132:135]
    ds_read_b64_tr_b16 v[180:181], v91 offset:2048
    buffer_load_dwordx4 a[224:227], v1, s[28:31], s101 offen offset:0 sc1
    v_mfma_f32_16x16x32_bf16 v[140:143], a[92:95], v[208:211], v[140:143]
    ds_read_b64_tr_b16 v[182:183], v91 offset:5120
    s_waitcnt lgkmcnt(14)
    v_mfma_f32_16x16x32_bf16 v[224:227], v[152:155], v[68:71], v[224:227]
    ds_read_b64_tr_b16 v[144:145], v77 offset:24576
    ds_read_b64_tr_b16 a[180:181], v85 offset:1024
    v_mfma_f32_16x16x32_bf16 v[228:231], v[68:71], v[156:159], v[228:231]
    ds_read_b64_tr_b16 v[146:147], v77 offset:27648
    buffer_load_dwordx4 a[228:231], v1, s[28:31], s101 offen offset:1024 sc1
    s_waitcnt lgkmcnt(12)
    v_mfma_f32_16x16x32_bf16 v[96:99], v[160:163], a[96:99], v[96:99]
    ds_read_b64_tr_b16 v[188:189], v90 offset:6144
    v_add_u32 v88, s94, v2
    v_mfma_f32_16x16x32_bf16 v[104:107], v[160:163], a[100:103], v[104:107]
    ds_read_b64_tr_b16 v[190:191], v90 offset:9216
    buffer_load_dwordx4 a[232:235], v1, s[28:31], s101 offen offset:2048 sc1
    v_mfma_f32_16x16x32_bf16 v[100:103], v[164:167], a[96:99], v[100:103]
    ds_read_b64_tr_b16 v[192:193], v91 offset:6144
    v_add_u32 v89, s94, v4
    v_mfma_f32_16x16x32_bf16 v[108:111], v[164:167], a[100:103], v[108:111]
    ds_read_b64_tr_b16 v[156:157], v79 offset:30720
    ds_read_b64_tr_b16 v[194:195], v91 offset:9216
    v_mfma_f32_16x16x32_bf16 v[112:115], v[168:171], a[96:99], v[112:115]
    ds_read_b64_tr_b16 v[196:197], v90 offset:7168
    buffer_load_dwordx4 a[236:239], v1, s[28:31], s101 offen offset:3072 sc1
    v_mfma_f32_16x16x32_bf16 v[120:123], v[168:171], a[100:103], v[120:123]
    ds_read_b64_tr_b16 v[198:199], v90 offset:10240
    s_waitcnt lgkmcnt(10)
    v_mfma_f32_16x16x32_bf16 v[116:119], v[172:175], a[96:99], v[116:119]
    ds_read_b64_tr_b16 v[200:201], v91 offset:7168
    s_mov_b32 s77, 4096
    v_mfma_f32_16x16x32_bf16 v[124:127], v[172:175], a[100:103], v[124:127]
    ds_read_b64_tr_b16 v[202:203], v91 offset:10240
    buffer_load_dword v19, v86, s[12:15], s77 offen
    v_mfma_f32_16x16x32_bf16 v[128:131], a[96:99], v[176:179], v[128:131]
    ds_read_b64_tr_b16 v[204:205], v90 offset:8192
    s_mov_b32 s77, 266240
    v_mfma_f32_16x16x32_bf16 v[136:139], a[100:103], v[176:179], v[136:139]
    ds_read_b64_tr_b16 v[158:159], v79 offset:33792
    ds_read_b64_tr_b16 v[206:207], v90 offset:11264
    v_mfma_f32_16x16x32_bf16 v[132:135], a[96:99], v[180:183], v[132:135]
    ds_read_b64_tr_b16 v[208:209], v91 offset:8192
    buffer_load_dword v19, v86, s[12:15], s77 offen
    v_mfma_f32_16x16x32_bf16 v[140:143], a[100:103], v[180:183], v[140:143]
    ds_read_b64_tr_b16 v[210:211], v91 offset:11264
    s_waitcnt lgkmcnt(14)
    v_mfma_f32_16x16x32_bf16 v[224:227], v[144:147], v[68:71], v[224:227]
    ds_read_b64_tr_b16 v[152:153], v77 offset:30720
    ds_read_b64_tr_b16 a[182:183], v85 offset:4096
    v_mfma_f32_16x16x32_bf16 v[228:231], v[68:71], v[148:151], v[228:231]
    ds_read_b64_tr_b16 v[154:155], v77 offset:33792
    v_lshrrev_b32 v218, 6, v1
    v_lshlrev_b32 v218, 17, v218
    v_and_b32 v219, 0x30, v1
    v_lshl_add_u32 v218, v219, 3, v218
    s_lshl_b32 s77, s33, 9
    s_add_u32 s77, s77, s46
    s_add_u32 s77, s77, 0x20000
    s_bfm_b64 exec, 12, 0
    buffer_load_dword v19, v218, s[28:31], s77 offen sc1
    s_mov_b64 exec, -1
    s_waitcnt lgkmcnt(10)
    v_mfma_f32_16x16x32_bf16 v[96:99], v[188:191], a[104:107], v[96:99]
    ds_read_b64_tr_b16 v[160:161], v90 offset:12288
    s_mov_b32 s77, 4096
    v_mfma_f32_16x16x32_bf16 v[104:107], v[188:191], a[108:111], v[104:107]
    ds_read_b64_tr_b16 v[162:163], v90 offset:15360
    buffer_load_dword v19, v86, s[16:19], s77 offen
    v_mfma_f32_16x16x32_bf16 v[100:103], v[192:195], a[104:107], v[100:103]
    ds_read_b64_tr_b16 v[164:165], v91 offset:12288
    s_mov_b32 s77, 266240
    v_mfma_f32_16x16x32_bf16 v[108:111], v[192:195], a[108:111], v[108:111]
    ds_read_b64_tr_b16 v[148:149], v79 offset:36864
    ds_read_b64_tr_b16 v[166:167], v91 offset:15360
    v_mfma_f32_16x16x32_bf16 v[112:115], v[196:199], a[104:107], v[112:115]
    ds_read_b64_tr_b16 v[168:169], v90 offset:13312
    buffer_load_dword v19, v86, s[16:19], s77 offen
    v_mfma_f32_16x16x32_bf16 v[120:123], v[196:199], a[108:111], v[120:123]
    ds_read_b64_tr_b16 v[170:171], v90 offset:16384
    s_waitcnt lgkmcnt(10)
    v_mfma_f32_16x16x32_bf16 v[116:119], v[200:203], a[104:107], v[116:119]
    ds_read_b64_tr_b16 v[172:173], v91 offset:13312
    s_mov_b32 s77, 528384
    v_mfma_f32_16x16x32_bf16 v[124:127], v[200:203], a[108:111], v[124:127]
    ds_read_b64_tr_b16 v[174:175], v91 offset:16384
    buffer_load_dword v19, v86, s[16:19], s77 offen
    v_mfma_f32_16x16x32_bf16 v[128:131], a[104:107], v[204:207], v[128:131]
    ds_read_b64_tr_b16 v[176:177], v90 offset:14336
    ds_read_b64_tr_b16 a[184:185], v85 offset:2048
    v_mfma_f32_16x16x32_bf16 v[136:139], a[108:111], v[204:207], v[136:139]
    ds_read_b64_tr_b16 v[150:151], v79 offset:39936
    ds_read_b64_tr_b16 v[178:179], v90 offset:17408
    v_mfma_f32_16x16x32_bf16 v[132:135], a[104:107], v[208:211], v[132:135]
    ds_read_b64_tr_b16 v[180:181], v91 offset:14336
    v_lshlrev_b32 v218, 3, v1
    s_lshl_b32 s77, s2, 2
    s_add_u32 s77, s77, s36
    s_mul_i32 s77, s77, 1792
    s_add_u32 s77, s77, 4096
    s_bfm_b64 exec, 14, 0
    buffer_load_dword v19, v218, s[20:23], s77 offen sc1
    s_mov_b64 exec, -1
    v_mfma_f32_16x16x32_bf16 v[140:143], a[108:111], v[208:211], v[140:143]
    ds_read_b64_tr_b16 v[182:183], v91 offset:17408
    s_waitcnt lgkmcnt(14)
    v_mfma_f32_16x16x32_bf16 v[224:227], v[152:155], v[68:71], v[224:227]
    ds_read_b64_tr_b16 v[144:145], v77 offset:36864
    ds_read_b64_tr_b16 a[186:187], v85 offset:5120
    v_mfma_f32_16x16x32_bf16 v[228:231], v[68:71], v[156:159], v[228:231]
    ds_read_b64_tr_b16 v[146:147], v77 offset:39936
    s_waitcnt lgkmcnt(11)
    v_mfma_f32_16x16x32_bf16 v[96:99], v[160:163], a[112:115], v[96:99]
    ds_read_b64_tr_b16 v[188:189], v90 offset:18432
    ds_read_b64_tr_b16 a[188:189], v85 offset:12288
    v_mfma_f32_16x16x32_bf16 v[104:107], v[160:163], a[116:119], v[104:107]
    ds_read_b64_tr_b16 v[190:191], v90 offset:21504
    ds_read_b64_tr_b16 a[190:191], v85 offset:15360
    v_mfma_f32_16x16x32_bf16 v[100:103], v[164:167], a[112:115], v[100:103]
    ds_read_b64_tr_b16 v[192:193], v91 offset:18432
    ds_read_b64_tr_b16 a[192:193], v85 offset:13312
    v_mfma_f32_16x16x32_bf16 v[108:111], v[164:167], a[116:119], v[108:111]
    ds_read_b64_tr_b16 v[156:157], v79 offset:43008
    ds_read_b64_tr_b16 v[194:195], v91 offset:21504
    v_mfma_f32_16x16x32_bf16 v[112:115], v[168:171], a[112:115], v[112:115]
    ds_read_b64_tr_b16 v[196:197], v90 offset:19456
    ds_read_b64_tr_b16 a[194:195], v85 offset:16384
    v_mfma_f32_16x16x32_bf16 v[120:123], v[168:171], a[116:119], v[120:123]
    ds_read_b64_tr_b16 v[198:199], v90 offset:22528
    s_waitcnt lgkmcnt(14)
    v_mfma_f32_16x16x32_bf16 v[116:119], v[172:175], a[112:115], v[116:119]
    ds_read_b64_tr_b16 v[200:201], v91 offset:19456
    ds_read_b64_tr_b16 a[196:197], v85 offset:14336
    v_mfma_f32_16x16x32_bf16 v[124:127], v[172:175], a[116:119], v[124:127]
    ds_read_b64_tr_b16 v[202:203], v91 offset:22528
    ds_read_b64_tr_b16 a[198:199], v85 offset:17408
    v_mfma_f32_16x16x32_bf16 v[128:131], a[112:115], v[176:179], v[128:131]
    ds_read_b64_tr_b16 v[204:205], v90 offset:20480
    ds_read_b64_tr_b16 a[200:201], v85 offset:24576
    v_mfma_f32_16x16x32_bf16 v[136:139], a[116:119], v[176:179], v[136:139]
    ds_read_b64_tr_b16 v[158:159], v79 offset:46080
    ds_read_b64_tr_b16 v[206:207], v90 offset:23552
    v_mfma_f32_16x16x32_bf16 v[132:135], a[112:115], v[180:183], v[132:135]
    ds_read_b64_tr_b16 v[208:209], v91 offset:20480
    ds_read_b64_tr_b16 a[202:203], v85 offset:27648
    v_mfma_f32_16x16x32_bf16 v[140:143], a[116:119], v[180:183], v[140:143]
    ds_read_b64_tr_b16 v[210:211], v91 offset:23552
    s_waitcnt lgkmcnt(14)
    v_mfma_f32_16x16x32_bf16 v[224:227], v[144:147], v[68:71], v[224:227]
    ds_read_b64_tr_b16 v[152:153], v77 offset:43008
    ds_read_b64_tr_b16 a[204:205], v85 offset:25600
    v_mfma_f32_16x16x32_bf16 v[228:231], v[68:71], v[148:151], v[228:231]
    ds_read_b64_tr_b16 v[154:155], v77 offset:46080
    s_waitcnt lgkmcnt(14)
    v_mfma_f32_16x16x32_bf16 v[96:99], v[188:191], a[120:123], v[96:99]
    ds_read_b64_tr_b16 v[168:169], v88 offset:1024
    ds_read_b64_tr_b16 a[206:207], v85 offset:28672
    v_mfma_f32_16x16x32_bf16 v[104:107], v[188:191], a[124:127], v[104:107]
    ds_read_b64_tr_b16 v[170:171], v88 offset:4096
    ds_read_b64_tr_b16 a[208:209], v85 offset:26624
    v_mfma_f32_16x16x32_bf16 v[100:103], v[192:195], a[120:123], v[100:103]
    ds_read_b64_tr_b16 v[172:173], v89 offset:1024
    ds_read_b64_tr_b16 a[210:211], v85 offset:29696
    v_mfma_f32_16x16x32_bf16 v[108:111], v[192:195], a[124:127], v[108:111]
    ds_read_b64_tr_b16 v[174:175], v89 offset:4096
    ds_read_b64_tr_b16 a[212:213], v85 offset:36864
    v_mfma_f32_16x16x32_bf16 v[112:115], v[196:199], a[120:123], v[112:115]
    ds_read_b64_tr_b16 v[176:177], v88 offset:2048
    ds_read_b64_tr_b16 a[214:215], v85 offset:39936
    v_mfma_f32_16x16x32_bf16 v[120:123], v[196:199], a[124:127], v[120:123]
    ds_read_b64_tr_b16 v[178:179], v88 offset:5120
    s_waitcnt lgkmcnt(14)
    v_mfma_f32_16x16x32_bf16 v[116:119], v[200:203], a[120:123], v[116:119]
    ds_read_b64_tr_b16 v[180:181], v89 offset:2048
    ds_read_b64_tr_b16 a[216:217], v85 offset:37888
    v_mfma_f32_16x16x32_bf16 v[124:127], v[200:203], a[124:127], v[124:127]
    ds_read_b64_tr_b16 v[182:183], v89 offset:5120
    ds_read_b64_tr_b16 a[218:219], v85 offset:40960
    v_mfma_f32_16x16x32_bf16 v[128:131], a[120:123], v[204:207], v[128:131]
    ds_read_b64_tr_b16 a[220:221], v85 offset:38912
    ds_read_b64_tr_b16 a[222:223], v85 offset:41984
    v_mfma_f32_16x16x32_bf16 v[136:139], a[124:127], v[204:207], v[136:139]
    v_mfma_f32_16x16x32_bf16 v[132:135], a[120:123], v[208:211], v[132:135]
    v_mfma_f32_16x16x32_bf16 v[140:143], a[124:127], v[208:211], v[140:143]
    s_waitcnt lgkmcnt(14)
    v_mfma_f32_16x16x32_bf16 v[224:227], v[152:155], v[68:71], v[224:227]
    v_mfma_f32_16x16x32_bf16 v[228:231], v[68:71], v[156:159], v[228:231]
    s_lshl_b32 s68, s36, 6
    s_and_b32 s69, s68, 64
    v_add_u32 v218, s68, v64
    v_add_u32 v219, s69, v65
    s_mov_b32 s82, 0x00010001
    s_mov_b32 s83, 0x00010001
    s_mov_b64 exec, s[82:83]
    ds_write_b128 v218, v[224:227] offset:0
    s_mov_b64 exec, 0xffff
    ds_write_b32 v219, v228 offset:256
    s_mov_b64 exec, -1
    s_waitcnt vmcnt(13)
    v_add_f32 v240, v240, v242
    s_waitcnt vmcnt(12)
    v_add_f32 v244, v244, v246
    v_add_f32 v241, v241, v243
    s_waitcnt lgkmcnt(5)
    ds_read_b64_tr_b16 v[196:197], v88 offset:7168
    ds_read_b64_tr_b16 v[198:199], v88 offset:10240
    ds_read_b64_tr_b16 v[200:201], v89 offset:7168
    ds_read_b64_tr_b16 v[202:203], v89 offset:10240
    ds_read_b64_tr_b16 v[204:205], v88 offset:8192
    ds_read_b64_tr_b16 v[206:207], v88 offset:11264
    ds_read_b64_tr_b16 v[208:209], v89 offset:8192
    ds_read_b64_tr_b16 v[210:211], v89 offset:11264
    s_waitcnt vmcnt(10)
    v_mfma_f32_16x16x32_bf16 v[144:147], v[168:171], a[224:227], 0
    v_add_f32 v245, v245, v247
    v_permlane16_swap_b32 v240, v241
    s_nop 0
    v_permlane16_swap_b32 v244, v245
    v_mfma_f32_16x16x32_bf16 v[148:151], v[172:175], a[224:227], 0
    v_add_f32 v240, v240, v241
    v_add_f32 v244, v244, v245
    v_mov_b32 v241, v240
    v_mfma_f32_16x16x32_bf16 v[152:155], a[224:227], v[176:179], 0
    v_mov_b32 v245, v244
    v_permlane32_swap_b32 v240, v241
    s_nop 0
    v_permlane32_swap_b32 v244, v245
    v_mfma_f32_16x16x32_bf16 v[156:159], a[224:227], v[180:183], 0
    v_add_f32 v240, v240, v241
    v_add_f32 v244, v244, v245
    v_mov_b32 v241, v240
    s_waitcnt lgkmcnt(0)
    ds_read_b64_tr_b16 v[168:169], v88 offset:13312
    ds_read_b64_tr_b16 v[170:171], v88 offset:16384
    ds_read_b64_tr_b16 v[172:173], v89 offset:13312
    ds_read_b64_tr_b16 v[174:175], v89 offset:16384
    ds_read_b64_tr_b16 v[176:177], v88 offset:14336
    ds_read_b64_tr_b16 v[178:179], v88 offset:17408
    ds_read_b64_tr_b16 v[180:181], v89 offset:14336
    ds_read_b64_tr_b16 v[182:183], v89 offset:17408
    s_waitcnt vmcnt(9)
    v_mfma_f32_16x16x32_bf16 v[144:147], v[196:199], a[228:231], v[144:147]
    v_mov_b32 v245, v244
    v_permlane16_swap_b32 v240, v241
    s_nop 0
    v_permlane16_swap_b32 v244, v245
    v_mfma_f32_16x16x32_bf16 v[148:151], v[200:203], a[228:231], v[148:151]
    v_mul_f32 v76, 0xbb000000, v240
    v_mul_f32 v77, 0xbb000000, v244
    v_mul_f32 v241, s89, v241
    v_mfma_f32_16x16x32_bf16 v[152:155], a[228:231], v[204:207], v[152:155]
    v_mul_f32 v245, s89, v245
    v_fma_f32 v241, -v76, v76, v241
    v_fma_f32 v245, -v77, v77, v245
    v_mfma_f32_16x16x32_bf16 v[156:159], a[228:231], v[208:211], v[156:159]
    v_max_f32 v241, 0, v241
    v_max_f32 v245, 0, v245
    v_add_f32 v241, s88, v241
    s_waitcnt lgkmcnt(0)
    ds_read_b64_tr_b16 v[196:197], v88 offset:19456
    ds_read_b64_tr_b16 v[198:199], v88 offset:22528
    ds_read_b64_tr_b16 v[200:201], v89 offset:19456
    ds_read_b64_tr_b16 v[202:203], v89 offset:22528
    ds_read_b64_tr_b16 v[204:205], v88 offset:20480
    ds_read_b64_tr_b16 v[206:207], v88 offset:23552
    ds_read_b64_tr_b16 v[208:209], v89 offset:20480
    ds_read_b64_tr_b16 v[210:211], v89 offset:23552
    s_waitcnt vmcnt(8)
    v_mfma_f32_16x16x32_bf16 v[144:147], v[168:171], a[232:235], v[144:147]
    v_add_f32 v245, s88, v245
    v_rsq_f32 v78, v241
    v_rsq_f32 v79, v245
    v_mfma_f32_16x16x32_bf16 v[148:151], v[172:175], a[232:235], v[148:151]
    v_mfma_f32_16x16x32_bf16 v[152:155], a[232:235], v[176:179], v[152:155]
    v_mfma_f32_16x16x32_bf16 v[156:159], a[232:235], v[180:183], v[156:159]
    s_waitcnt lgkmcnt(0)
    s_waitcnt vmcnt(7)
    v_mfma_f32_16x16x32_bf16 v[144:147], v[196:199], a[236:239], v[144:147]
    v_mfma_f32_16x16x32_bf16 v[148:151], v[200:203], a[236:239], v[148:151]
    v_mfma_f32_16x16x32_bf16 v[152:155], a[236:239], v[204:207], v[152:155]
    v_mfma_f32_16x16x32_bf16 v[156:159], a[236:239], v[208:211], v[156:159]
    ds_write_b32 v62, v76 offset:0
    ds_write_b32 v62, v78 offset:64
    s_nop 2
    ds_write_b128 v61, v[144:147] offset:0
    ds_write_b32 v62, v77 offset:128
    ds_write_b32 v62, v79 offset:192
    ds_read_b128 v[224:227], v63 offset:0
    ds_read_b128 v[228:231], v63 offset:128
    v_add_f32 v232, v232, v234
    v_add_f32 v233, v233, v235
    s_nop 1
    v_permlane16_swap_b32 v232, v233
    v_add_f32 v232, v232, v233
    ds_write_b128 v61, v[148:151] offset:1024
    v_mov_b32 v233, v232
    s_nop 1
    v_permlane32_swap_b32 v232, v233
    v_add_f32 v232, v232, v233
    v_mov_b32 v233, v232
    s_nop 1
    v_permlane16_swap_b32 v232, v233
    v_mul_f32 v236, 0xbb000000, v232
    v_mul_f32 v233, s89, v233
    v_fma_f32 v233, -v236, v236, v233
    ds_write_b128 v61, v[152:155] offset:2048
    v_max_f32 v233, 0, v233
    v_add_f32 v233, s88, v233
    v_rsq_f32 v237, v233
    ds_write_b32 v75, v236
    ds_write_b32 v75, v237 offset:64
    v_mov_b32 v232, v237
    v_mov_b32 v233, v237
    v_mov_b32 v234, v237
    ds_write_b128 v61, v[156:159] offset:3072
    v_mov_b32 v235, v237
    ds_write_b128 v0, v[232:235]
    s_waitcnt lgkmcnt(0)
    s_barrier
    s_sub_u32 s68, s39, s37
    s_add_u32 s68, s68, 2754487915
    s_add_u32 s69, s40, 3669625727
    v_mov_b32 v216, s68
    v_mov_b32 v217, s69
    s_lshl_b32 s71, s32, 8
    s_lshl_b32 s70, s33, 3
    s_add_u32 s71, s71, s70
    s_add_u32 s71, s71, 50331648
    s_mov_b64 exec, s[42:43]
    buffer_store_dwordx2 v[216:217], off, s[28:31], s71 sc1
    s_mov_b64 exec, -1
    s_mov_b32 s77, 790528
    buffer_load_dword v19, v86, s[16:19], s77 offen
    ds_read_b128 v[144:147], v73 offset:0
    ds_read_b128 v[148:151], v73 offset:4096
    s_add_u32 m0, s57, 126976
    s_add_u32 s76, s56, 0
    buffer_load_dwordx4 v80, s[12:15], s76 offen lds
    ds_read_b128 v[152:155], v73 offset:8192
    ds_read_b128 v[156:159], v73 offset:12288
    ds_read_b128 v[200:203], v63 offset:64
    ds_read_b128 v[204:207], v63 offset:192
    ds_read_b128 v[238:241], v64 offset:0
    ds_read_b128 v[242:245], v64 offset:64
    ds_read_b128 v[246:249], v64 offset:128
    ds_read_b128 v[250:253], v64 offset:192
    ds_read_b32 v254, v65 offset:256
    ds_read_b32 v255, v65 offset:320
    ds_read_b128 v[208:211], v92
    ds_read_b32 v232, v93
    ds_read_b128 v[212:215], v94
    buffer_load_dwordx4 v81, s[12:15], s76 offen offset:1024 lds
    s_waitcnt lgkmcnt(6)
    v_pk_fma_f32 v[112:113], v[246:247], v[76:77], v[112:113] op_sel_hi:[1,0,1]
    s_waitcnt lgkmcnt(3)
    v_pk_fma_f32 v[128:129], v[224:225], v[254:255], v[128:129] op_sel_hi:[1,0,1]
    v_pk_fma_f32 v[114:115], v[248:249], v[76:77], v[114:115] op_sel_hi:[1,0,1]
    v_pk_fma_f32 v[130:131], v[226:227], v[254:255], v[130:131] op_sel_hi:[1,0,1]
    v_pk_fma_f32 v[116:117], v[250:251], v[76:77], v[116:117] op_sel_hi:[1,0,1]
    v_pk_fma_f32 v[132:133], v[224:225], v[254:255], v[132:133] op_sel:[0,1,0]
    v_pk_fma_f32 v[118:119], v[252:253], v[76:77], v[118:119] op_sel_hi:[1,0,1]
    v_pk_fma_f32 v[134:135], v[226:227], v[254:255], v[134:135] op_sel:[0,1,0]
    v_pk_fma_f32 v[120:121], v[246:247], v[76:77], v[120:121] op_sel:[0,1,0]
    v_pk_fma_f32 v[136:137], v[228:229], v[254:255], v[136:137] op_sel_hi:[1,0,1]
    v_pk_fma_f32 v[122:123], v[248:249], v[76:77], v[122:123] op_sel:[0,1,0]
    v_pk_fma_f32 v[138:139], v[230:231], v[254:255], v[138:139] op_sel_hi:[1,0,1]
    v_pk_fma_f32 v[124:125], v[250:251], v[76:77], v[124:125] op_sel:[0,1,0]
    v_pk_fma_f32 v[140:141], v[228:229], v[254:255], v[140:141] op_sel:[0,1,0]
    v_pk_fma_f32 v[126:127], v[252:253], v[76:77], v[126:127] op_sel:[0,1,0]
    buffer_load_dwordx4 v82, s[12:15], s76 offen offset:2048 lds
    v_pk_fma_f32 v[142:143], v[230:231], v[254:255], v[142:143] op_sel:[0,1,0]
    v_pk_mul_f32 v[112:113], v[112:113], v[78:79] op_sel_hi:[1,0]
    v_pk_mul_f32 v[128:129], v[128:129], v[200:201]
    v_pk_mul_f32 v[114:115], v[114:115], v[78:79] op_sel_hi:[1,0]
    v_pk_mul_f32 v[130:131], v[130:131], v[202:203]
    v_cvt_pk_bf16_f32 v168, v112, v113
    v_cvt_pk_bf16_f32 v178, v128, v129
    v_cvt_pk_bf16_f32 v169, v114, v115
    v_cvt_pk_bf16_f32 v179, v130, v131
    ds_write2_b64 v34, v[168:169], v[178:179] offset0:0 offset1:1
    v_pk_mul_f32 v[116:117], v[116:117], v[78:79] op_sel_hi:[1,0]
    v_pk_mul_f32 v[132:133], v[132:133], v[200:201]
    v_pk_mul_f32 v[118:119], v[118:119], v[78:79] op_sel_hi:[1,0]
    v_pk_mul_f32 v[134:135], v[134:135], v[202:203]
    v_cvt_pk_bf16_f32 v170, v116, v117
    buffer_load_dwordx4 v83, s[12:15], s76 offen offset:3072 lds
    v_cvt_pk_bf16_f32 v182, v132, v133
    v_cvt_pk_bf16_f32 v171, v118, v119
    v_cvt_pk_bf16_f32 v183, v134, v135
    ds_write2_b64 v34, v[170:171], v[182:183] offset0:128 offset1:129
    v_pk_add_f32 v[144:145], v[144:145], v[148:149]
    v_pk_add_f32 v[152:153], v[152:153], v[156:157]
    v_pk_add_f32 v[146:147], v[146:147], v[150:151]
    v_pk_add_f32 v[154:155], v[154:155], v[158:159]
    v_pk_add_f32 v[144:145], v[144:145], v[152:153]
    v_pk_add_f32 v[146:147], v[146:147], v[154:155]
    s_waitcnt lgkmcnt(3)
    v_pk_fma_f32 v[144:145], v[208:209], v[232:233], v[144:145] op_sel_hi:[1,0,1]
    v_pk_fma_f32 v[146:147], v[210:211], v[232:233], v[146:147] op_sel_hi:[1,0,1]
    s_waitcnt lgkmcnt(2)
    v_pk_mul_f32 v[144:145], v[144:145], v[212:213]
    v_pk_mul_f32 v[146:147], v[146:147], v[214:215]
    v_cvt_pk_bf16_f32 v144, v144, v145
    s_add_u32 m0, s57, 143360
    s_add_u32 s76, s56, 65536
    buffer_load_dwordx4 v80, s[12:15], s76 offen lds
    v_cvt_pk_bf16_f32 v145, v146, v147
    ds_write_b64 v35, v[144:145]
    v_pk_mul_f32 v[120:121], v[120:121], v[78:79] op_sel:[0,1]
    v_pk_mul_f32 v[136:137], v[136:137], v[204:205]
    v_pk_mul_f32 v[122:123], v[122:123], v[78:79] op_sel:[0,1]
    v_pk_mul_f32 v[138:139], v[138:139], v[206:207]
    v_cvt_pk_bf16_f32 v172, v120, v121
    v_cvt_pk_bf16_f32 v186, v136, v137
    v_cvt_pk_bf16_f32 v173, v122, v123
    v_cvt_pk_bf16_f32 v187, v138, v139
    ds_write_b64 v34, v[172:173] offset:2048
    ds_write_b64 v34, v[186:187] offset:2056
    v_pk_mul_f32 v[124:125], v[124:125], v[78:79] op_sel:[0,1]
    buffer_load_dwordx4 v81, s[12:15], s76 offen offset:1024 lds
    v_pk_mul_f32 v[140:141], v[140:141], v[204:205]
    v_pk_mul_f32 v[126:127], v[126:127], v[78:79] op_sel:[0,1]
    v_pk_mul_f32 v[142:143], v[142:143], v[206:207]
    v_cvt_pk_bf16_f32 v174, v124, v125
    v_cvt_pk_bf16_f32 v190, v140, v141
    v_cvt_pk_bf16_f32 v175, v126, v127
    v_cvt_pk_bf16_f32 v191, v142, v143
    ds_write_b64 v34, v[174:175] offset:3072
    ds_write_b64 v34, v[190:191] offset:3080
    v_pk_fma_f32 v[96:97], v[238:239], v[76:77], v[96:97] op_sel_hi:[1,0,1]
    v_pk_fma_f32 v[98:99], v[240:241], v[76:77], v[98:99] op_sel_hi:[1,0,1]
    v_cvt_pk_bf16_f32 v160, v96, v97
    v_cvt_pk_bf16_f32 v161, v98, v99
    v_pk_fma_f32 v[100:101], v[242:243], v[76:77], v[100:101] op_sel_hi:[1,0,1]
    v_pk_fma_f32 v[102:103], v[244:245], v[76:77], v[102:103] op_sel_hi:[1,0,1]
    buffer_load_dwordx4 v82, s[12:15], s76 offen offset:2048 lds
    v_cvt_pk_bf16_f32 v162, v100, v101
    v_cvt_pk_bf16_f32 v163, v102, v103
    v_pk_fma_f32 v[104:105], v[238:239], v[76:77], v[104:105] op_sel:[0,1,0]
    v_pk_fma_f32 v[106:107], v[240:241], v[76:77], v[106:107] op_sel:[0,1,0]
    v_cvt_pk_bf16_f32 v164, v104, v105
    v_cvt_pk_bf16_f32 v165, v106, v107
    v_pk_fma_f32 v[108:109], v[242:243], v[76:77], v[108:109] op_sel:[0,1,0]
    v_pk_fma_f32 v[110:111], v[244:245], v[76:77], v[110:111] op_sel:[0,1,0]
    v_cvt_pk_bf16_f32 v166, v108, v109
    v_cvt_pk_bf16_f32 v167, v110, v111
    v_mfma_f32_16x16x16_bf16 v[116:119], v[168:169], v[160:161], v[36:39]
    v_mfma_f32_16x16x16_bf16 v[124:127], v[170:171], v[162:163], v[36:39]
    v_mfma_f32_16x16x16_bf16 v[132:135], v[172:173], v[164:165], v[36:39]
    buffer_load_dwordx4 v83, s[12:15], s76 offen offset:3072 lds
    v_mfma_f32_16x16x16_bf16 v[140:143], v[174:175], v[166:167], v[36:39]
    v_mul_f32 v218, 0x3eb8aa3b, v78
    v_mul_f32 v219, 0x3eb8aa3b, v79
    s_waitcnt lgkmcnt(0)
    s_barrier
    s_add_u32 m0, s57, 94208
    s_add_u32 s76, s56, 131072
    buffer_load_dwordx4 v80, s[12:15], s76 offen lds
    ds_read_b64 v[192:193], v30 offset:0
    ds_read_b64 v[194:195], v30 offset:1024
    ds_read_b64 v[196:197], v31 offset:0
    ds_read_b64 v[198:199], v31 offset:1024
    ds_read_b64 v[176:177], v32 offset:0
    ds_read_b64 v[180:181], v32 offset:1024
    ds_read_b64 v[184:185], v33 offset:0
    ds_read_b64 v[188:189], v33 offset:1024
    v_max3_f32 v228, v116, v117, v118
    v_max3_f32 v229, v124, v125, v126
    v_max3_f32 v230, v132, v133, v134
    v_max3_f32 v231, v140, v141, v142
    s_waitcnt lgkmcnt(7)
    v_mfma_f32_16x16x16_bf16 v[112:115], v[192:193], v[160:161], v[40:43]
    buffer_load_dwordx4 v81, s[12:15], s76 offen offset:1024 lds
    s_waitcnt lgkmcnt(6)
    v_mfma_f32_16x16x16_bf16 v[120:123], v[194:195], v[162:163], v[40:43]
    s_waitcnt lgkmcnt(5)
    v_mfma_f32_16x16x16_bf16 v[128:131], v[196:197], v[164:165], v[40:43]
    s_waitcnt lgkmcnt(4)
    v_mfma_f32_16x16x16_bf16 v[136:139], v[198:199], v[166:167], v[40:43]
    v_max_f32 v228, v228, v119
    v_max_f32 v229, v229, v127
    v_max_f32 v230, v230, v135
    v_max_f32 v231, v231, v143
    s_lshl_b32 s100, s36, 15
    s_lshl_b32 s69, s33, 10
    s_add_u32 s100, s100, s69
    s_add_u32 s100, s100, s48
    v_max3_f32 v224, v112, v113, v114
    buffer_load_dwordx4 v82, s[12:15], s76 offen offset:2048 lds
    v_max3_f32 v225, v120, v121, v122
    v_max3_f32 v226, v128, v129, v130
    v_max3_f32 v227, v136, v137, v138
    v_max3_f32 v224, v224, v115, v228
    v_max3_f32 v225, v225, v123, v229
    v_max3_f32 v226, v226, v131, v230
    v_max3_f32 v227, v227, v139, v231
    v_permlane16_swap_b32 v224, v225
    s_nop 0
    v_permlane16_swap_b32 v226, v227
    v_max_f32 v224, v224, v225
    v_max_f32 v226, v226, v227
    s_nop 1
    v_permlane32_swap_b32 v224, v226
    v_max_f32 v224, v224, v226
    v_mov_b32 v226, v224
    s_nop 1
    v_permlane32_swap_b32 v224, v226
    buffer_load_dwordx4 v83, s[12:15], s76 offen offset:3072 lds
    v_mov_b32 v225, v224
    v_mov_b32 v227, v226
    s_nop 0
    v_permlane16_swap_b32 v224, v225
    v_permlane16_swap_b32 v226, v227
    v_mul_f32 v224, v224, v218
    v_mul_f32 v225, v225, v218
    v_mul_f32 v226, v226, v219
    v_mul_f32 v227, v227, v219
    v_pk_fma_f32 v[112:113], v[112:113], v[218:219], v[224:225] op_sel_hi:[1,0,0] neg_lo:[0,0,1] neg_hi:[0,0,1]
    v_pk_fma_f32 v[114:115], v[114:115], v[218:219], v[224:225] op_sel_hi:[1,0,0] neg_lo:[0,0,1] neg_hi:[0,0,1]
    v_pk_fma_f32 v[116:117], v[116:117], v[218:219], v[224:225] op_sel_hi:[1,0,0] neg_lo:[0,0,1] neg_hi:[0,0,1]
    v_pk_fma_f32 v[118:119], v[118:119], v[218:219], v[224:225] op_sel_hi:[1,0,0] neg_lo:[0,0,1] neg_hi:[0,0,1]
    v_pk_fma_f32 v[120:121], v[120:121], v[218:219], v[224:225] op_sel:[0,0,1] op_sel_hi:[1,0,1] neg_lo:[0,0,1] neg_hi:[0,0,1]
    v_pk_fma_f32 v[122:123], v[122:123], v[218:219], v[224:225] op_sel:[0,0,1] op_sel_hi:[1,0,1] neg_lo:[0,0,1] neg_hi:[0,0,1]
    v_pk_fma_f32 v[124:125], v[124:125], v[218:219], v[224:225] op_sel:[0,0,1] op_sel_hi:[1,0,1] neg_lo:[0,0,1] neg_hi:[0,0,1]
    s_add_u32 m0, s57, 110592
    s_add_u32 s76, s56, 196608
    buffer_load_dwordx4 v80, s[12:15], s76 offen lds
    v_pk_fma_f32 v[126:127], v[126:127], v[218:219], v[224:225] op_sel:[0,0,1] op_sel_hi:[1,0,1] neg_lo:[0,0,1] neg_hi:[0,0,1]
    v_pk_fma_f32 v[128:129], v[128:129], v[218:219], v[226:227] op_sel:[0,1,0] op_sel_hi:[1,1,0] neg_lo:[0,0,1] neg_hi:[0,0,1]
    v_pk_fma_f32 v[130:131], v[130:131], v[218:219], v[226:227] op_sel:[0,1,0] op_sel_hi:[1,1,0] neg_lo:[0,0,1] neg_hi:[0,0,1]
    v_pk_fma_f32 v[132:133], v[132:133], v[218:219], v[226:227] op_sel:[0,1,0] op_sel_hi:[1,1,0] neg_lo:[0,0,1] neg_hi:[0,0,1]
    v_pk_fma_f32 v[134:135], v[134:135], v[218:219], v[226:227] op_sel:[0,1,0] op_sel_hi:[1,1,0] neg_lo:[0,0,1] neg_hi:[0,0,1]
    v_pk_fma_f32 v[136:137], v[136:137], v[218:219], v[226:227] op_sel:[0,1,1] neg_lo:[0,0,1] neg_hi:[0,0,1]
    v_pk_fma_f32 v[138:139], v[138:139], v[218:219], v[226:227] op_sel:[0,1,1] neg_lo:[0,0,1] neg_hi:[0,0,1]
    s_mov_b32 s77, 1052672
    buffer_load_dword v19, v86, s[16:19], s77 offen
    v_pk_fma_f32 v[140:141], v[140:141], v[218:219], v[226:227] op_sel:[0,1,1] neg_lo:[0,0,1] neg_hi:[0,0,1]
    v_pk_fma_f32 v[142:143], v[142:143], v[218:219], v[226:227] op_sel:[0,1,1] neg_lo:[0,0,1] neg_hi:[0,0,1]
    v_exp_f32 v112, v112
    buffer_load_dwordx4 v81, s[12:15], s76 offen offset:1024 lds
    v_exp_f32 v113, v113
    v_exp_f32 v114, v114
    v_exp_f32 v115, v115
    v_exp_f32 v116, v116
    v_exp_f32 v117, v117
    v_exp_f32 v118, v118
    v_exp_f32 v119, v119
    v_cvt_pk_bf16_f32 v96, v112, v113
    v_cvt_pk_bf16_f32 v97, v114, v115
    v_cvt_pk_bf16_f32 v98, v116, v117
    v_cvt_pk_bf16_f32 v99, v118, v119
    v_exp_f32 v120, v120
    v_exp_f32 v121, v121
    v_mfma_f32_16x16x32_bf16 v[144:147], v[68:71], v[96:99], 0
    v_exp_f32 v122, v122
    v_exp_f32 v123, v123
    buffer_load_dwordx4 v82, s[12:15], s76 offen offset:2048 lds
    s_waitcnt lgkmcnt(3)
    v_mfma_f32_16x16x32_bf16 v[232:235], v[176:179], v[96:99], 0
    v_exp_f32 v124, v124
    v_exp_f32 v125, v125
    v_exp_f32 v126, v126
    v_exp_f32 v127, v127
    v_cvt_pk_bf16_f32 v100, v120, v121
    v_cvt_pk_bf16_f32 v101, v122, v123
    v_cvt_pk_bf16_f32 v102, v124, v125
    v_cvt_pk_bf16_f32 v103, v126, v127
    v_exp_f32 v128, v128
    buffer_load_dwordx4 v83, s[12:15], s76 offen offset:3072 lds
    v_exp_f32 v129, v129
    v_mfma_f32_16x16x32_bf16 v[148:151], v[68:71], v[100:103], 0
    v_exp_f32 v130, v130
    v_exp_f32 v131, v131
    s_waitcnt lgkmcnt(2)
    v_mfma_f32_16x16x32_bf16 v[236:239], v[180:183], v[100:103], 0
    v_exp_f32 v132, v132
    v_exp_f32 v133, v133
    v_exp_f32 v134, v134
    s_add_u32 m0, s52, 0
    s_add_u32 s76, s51, 0
    buffer_load_dwordx4 v16, s[16:19], s76 offen lds
    v_exp_f32 v135, v135
    v_cvt_pk_bf16_f32 v104, v128, v129
    v_cvt_pk_bf16_f32 v105, v130, v131
    v_cvt_pk_bf16_f32 v106, v132, v133
    v_cvt_pk_bf16_f32 v107, v134, v135
    v_exp_f32 v136, v136
    v_exp_f32 v137, v137
    v_mfma_f32_16x16x32_bf16 v[152:155], v[68:71], v[104:107], 0
    v_exp_f32 v138, v138
    buffer_load_dwordx4 v17, s[16:19], s76 offen offset:1024 lds
    v_exp_f32 v139, v139
    s_waitcnt lgkmcnt(1)
    v_mfma_f32_16x16x32_bf16 v[240:243], v[184:187], v[104:107], 0
    v_exp_f32 v140, v140
    v_exp_f32 v141, v141
    v_exp_f32 v142, v142
    v_exp_f32 v143, v143
    v_cvt_pk_bf16_f32 v108, v136, v137
    v_cvt_pk_bf16_f32 v109, v138, v139
    v_cvt_pk_bf16_f32 v110, v140, v141
    buffer_load_dwordx4 v18, s[16:19], s76 offen offset:2048 lds
    v_cvt_pk_bf16_f32 v111, v142, v143
    v_rcp_f32 v144, v144
    v_rcp_f32 v148, v148
    v_mfma_f32_16x16x32_bf16 v[156:159], v[68:71], v[108:111], 0
    s_waitcnt lgkmcnt(0)
    v_mfma_f32_16x16x32_bf16 v[244:247], v[188:191], v[108:111], 0
    v_pk_mul_f32 v[232:233], v[232:233], v[144:145] op_sel_hi:[1,0]
    v_pk_mul_f32 v[234:235], v[234:235], v[144:145] op_sel_hi:[1,0]
    v_cvt_pk_bf16_f32 v248, v232, v233
    v_cvt_pk_bf16_f32 v249, v234, v235
    v_rcp_f32 v152, v152
    s_add_u32 m0, s52, 14336
    s_add_u32 s76, s51, 229376
    buffer_load_dwordx4 v16, s[16:19], s76 offen lds
    v_pk_mul_f32 v[236:237], v[236:237], v[148:149] op_sel_hi:[1,0]
    v_pk_mul_f32 v[238:239], v[238:239], v[148:149] op_sel_hi:[1,0]
    v_cvt_pk_bf16_f32 v250, v236, v237
    v_cvt_pk_bf16_f32 v251, v238, v239
    buffer_store_dwordx4 v[248:251], v1, s[28:31], s100 offen sc1
    v_pk_mul_f32 v[240:241], v[240:241], v[152:153] op_sel_hi:[1,0]
    v_pk_mul_f32 v[242:243], v[242:243], v[152:153] op_sel_hi:[1,0]
    v_cvt_pk_bf16_f32 v252, v240, v241
    v_cvt_pk_bf16_f32 v253, v242, v243
    v_rcp_f32 v156, v156
    s_nop 0
    v_pk_mul_f32 v[244:245], v[244:245], v[156:157] op_sel_hi:[1,0]
    v_pk_mul_f32 v[246:247], v[246:247], v[156:157] op_sel_hi:[1,0]
    v_cvt_pk_bf16_f32 v254, v244, v245
    v_cvt_pk_bf16_f32 v255, v246, v247
    buffer_store_dwordx4 v[252:255], v95, s[28:31], s100 offen sc1
    buffer_load_dwordx4 v17, s[16:19], s76 offen offset:1024 lds
    buffer_load_dwordx4 v18, s[16:19], s76 offen offset:2048 lds
    s_add_u32 m0, s52, 28672
    s_add_u32 s76, s51, 458752
    buffer_load_dwordx4 v16, s[16:19], s76 offen lds
    buffer_load_dwordx4 v17, s[16:19], s76 offen offset:1024 lds
    buffer_load_dwordx4 v18, s[16:19], s76 offen offset:2048 lds
    s_add_u32 s68, s39, 8
    v_mov_b32 v216, s68
    v_mov_b32 v217, s40
    s_lshr_b32 s68, s2, 7
    s_mul_i32 s68, s68, 786432
    v_add_u32 v14, s68, v86
    s_lshl_b32 s68, s35, 5
    s_lshl_b32 s69, s36, 3
    s_add_u32 s68, s68, s69
    s_bfm_b64 s[0:1], 8, s68
    s_and_b32 s68, s36, 1
    s_lshl_b32 s68, s68, 5
    s_lshr_b32 s69, s36, 1
    s_lshl_b32 s69, s69, 3
    s_add_u32 s68, s68, s69
    s_mov_b32 s2, 0x00ff00ff
    s_mov_b32 s3, 0
    s_lshl_b64 s[2:3], s[2:3], s68
    s_waitcnt vmcnt(5)
    s_mov_b64 exec, 1
    s_cmp_lg_u32 s38, 0
    s_cbranch_scc1 ELSE_8004
    buffer_store_dwordx2 v[216:217], off, s[28:31], s41
    s_branch ENDIF_8005
ELSE_8004:
    buffer_store_dwordx2 v[216:217], off, s[28:31], s41 sc1
ENDIF_8005:
    s_mov_b64 exec, -1
    s_barrier
    s_add_u32 m0, s54, 6144
    s_add_u32 s76, s53, 0
    buffer_load_dwordx4 v15, s[16:19], s76 offen lds
    s_add_u32 m0, s52, 43008
    s_add_u32 s76, s51, 688128
    buffer_load_dwordx4 v16, s[16:19], s76 offen lds
    buffer_load_dwordx4 v17, s[16:19], s76 offen offset:1024 lds
    buffer_load_dwordx4 v18, s[16:19], s76 offen offset:2048 lds
    s_add_u32 m0, s52, 57344
    s_add_u32 s76, s51, 917504
    buffer_load_dwordx4 v16, s[16:19], s76 offen lds
    buffer_load_dwordx4 v17, s[16:19], s76 offen offset:1024 lds
    buffer_load_dwordx4 v18, s[16:19], s76 offen offset:2048 lds
    s_add_u32 m0, s54, 34816
    s_add_u32 s76, s53, 458752
    buffer_load_dwordx4 v15, s[16:19], s76 offen lds
    s_and_b32 s72, s36, 1
    s_mul_i32 s72, s72, 8192
    s_add_u32 s72, s72, s48
    s_mul_i32 s90, s62, 16384
    s_add_u32 s90, s90, s72
    s_xor_b32 s73, s62, 1
    s_mul_i32 s91, s73, 16384
    s_add_u32 s91, s91, s72
    s_add_u32 s48, s48, s47
    s_add_u32 s44, s44, s47
    s_add_u32 s46, s46, 0x20000
    s_add_u32 s100, s44, s98
    s_add_u32 s101, s46, s99
    v_add_u32 v222, 8, v20
    s_mov_b32 s80, 0
    s_mov_b64 exec, s[0:1]
    buffer_load_dwordx2 v[152:153], v22, s[28:31], 0 offen sc1
    s_waitcnt vmcnt(0)
    s_nop 0
POLL_8007:
    buffer_load_dwordx2 v[154:155], v22, s[28:31], 0 offen sc1
    s_waitcnt vmcnt(1)
    v_sub_u32 v152, v152, v222
    v_cmp_eq_u32_e64 s[82:83], v153, v21
    v_cmp_gt_u32 vcc, 120, v152
    s_nop 1
    s_and_b64 vcc, vcc, s[82:83]
    s_cmp_eq_u64 vcc, exec
    s_cbranch_scc1 PDONE_8006
    buffer_load_dwordx2 v[152:153], v22, s[28:31], 0 offen sc1
    s_waitcnt vmcnt(1)
    v_sub_u32 v154, v154, v222
    v_cmp_eq_u32_e64 s[82:83], v155, v21
    v_cmp_gt_u32 vcc, 120, v154
    s_nop 1
    s_and_b64 vcc, vcc, s[82:83]
    s_cmp_eq_u64 vcc, exec
    s_cbranch_scc1 PDONE_8006
    s_add_u32 s80, s80, 1
    s_cmp_lt_u32 s80, 0x20000
    s_cbranch_scc1 POLL_8007
    s_branch L_END
PDONE_8006:
    s_mov_b64 exec, -1
    buffer_load_dwordx4 a[4:7], v1, s[28:31], s91 offen offset:0 sc1
    buffer_load_dwordx4 a[0:3], v1, s[28:31], s90 offen offset:0 sc1
    buffer_load_dwordx4 a[12:15], v1, s[28:31], s91 offen offset:1024 sc1
    buffer_load_dwordx4 a[8:11], v1, s[28:31], s90 offen offset:1024 sc1
    s_barrier
    ds_read_b64_tr_b16 v[160:161], v9 offset:61440
    ds_read_b64_tr_b16 v[162:163], v10 offset:4096
    ds_read_b64_tr_b16 v[164:165], v12 offset:61440
    ds_read_b64_tr_b16 v[166:167], v13 offset:4096
    ds_read_b64_tr_b16 v[168:169], v9 offset:62464
    ds_read_b64_tr_b16 v[170:171], v10 offset:5120
    ds_read_b64_tr_b16 v[172:173], v12 offset:62464
    ds_read_b64_tr_b16 v[174:175], v13 offset:5120
    buffer_load_dwordx4 a[20:23], v1, s[28:31], s91 offen offset:2048 sc1
    buffer_load_dwordx4 a[16:19], v1, s[28:31], s90 offen offset:2048 sc1
    ds_read_b64_tr_b16 v[176:177], v9 offset:63488
    ds_read_b64_tr_b16 v[178:179], v10 offset:6144
    ds_read_b64_tr_b16 v[180:181], v12 offset:63488
    ds_read_b64_tr_b16 v[182:183], v13 offset:6144
    ds_read_b64_tr_b16 v[184:185], v9 offset:64512
    ds_read_b64_tr_b16 v[186:187], v10 offset:7168
    ds_read_b64_tr_b16 v[188:189], v12 offset:64512
    ds_read_b64_tr_b16 v[190:191], v13 offset:7168
    buffer_load_dwordx4 a[28:31], v1, s[28:31], s91 offen offset:3072 sc1
    buffer_load_dwordx4 a[24:27], v1, s[28:31], s90 offen offset:3072 sc1
    s_waitcnt vmcnt(6) lgkmcnt(8)
    v_mfma_f32_16x16x32_bf16 v[112:115], v[160:163], a[4:7], 0
    ds_read_b64_tr_b16 v[192:193], v10 offset:12288
    s_add_u32 s91, s91, 4096
    buffer_load_dwordx4 a[36:39], v1, s[28:31], s91 offen offset:0 sc1
    v_mfma_f32_16x16x32_bf16 v[116:119], v[164:167], a[4:7], 0
    ds_read_b64_tr_b16 v[194:195], v10 offset:20480
    s_add_u32 s90, s90, 4096
    v_mfma_f32_16x16x32_bf16 v[120:123], v[168:171], a[4:7], 0
    ds_read_b64_tr_b16 v[196:197], v13 offset:12288
    buffer_load_dwordx4 a[32:35], v1, s[28:31], s90 offen offset:0 sc1
    v_mfma_f32_16x16x32_bf16 v[124:127], v[172:175], a[4:7], 0
    ds_read_b64_tr_b16 v[198:199], v13 offset:20480
    v_mfma_f32_16x16x32_bf16 v[96:99], v[160:163], a[0:3], 0
    ds_read_b64_tr_b16 v[200:201], v10 offset:13312
    buffer_load_dwordx4 a[44:47], v1, s[28:31], s91 offen offset:1024 sc1
    v_mfma_f32_16x16x32_bf16 v[100:103], v[164:167], a[0:3], 0
    ds_read_b64_tr_b16 v[202:203], v10 offset:21504
    v_mfma_f32_16x16x32_bf16 v[104:107], v[168:171], a[0:3], 0
    ds_read_b64_tr_b16 v[204:205], v13 offset:13312
    buffer_load_dwordx4 a[52:55], v1, s[28:31], s91 offen offset:2048 sc1
    v_mfma_f32_16x16x32_bf16 v[108:111], v[172:175], a[0:3], 0
    ds_read_b64_tr_b16 v[206:207], v13 offset:21504
    s_waitcnt vmcnt(8) lgkmcnt(8)
    v_mfma_f32_16x16x32_bf16 v[112:115], v[176:179], a[12:15], v[112:115]
    ds_read_b64_tr_b16 v[224:225], v10 offset:14336
    buffer_load_dwordx4 a[60:63], v1, s[28:31], s91 offen offset:3072 sc1
    v_mfma_f32_16x16x32_bf16 v[116:119], v[180:183], a[12:15], v[116:119]
    ds_read_b64_tr_b16 v[226:227], v10 offset:22528
    v_mfma_f32_16x16x32_bf16 v[120:123], v[184:187], a[12:15], v[120:123]
    ds_read_b64_tr_b16 v[228:229], v13 offset:14336
    buffer_load_dwordx4 a[40:43], v1, s[28:31], s90 offen offset:1024 sc1
    v_mfma_f32_16x16x32_bf16 v[124:127], v[188:191], a[12:15], v[124:127]
    ds_read_b64_tr_b16 v[230:231], v13 offset:22528
    v_mfma_f32_16x16x32_bf16 v[96:99], v[176:179], a[8:11], v[96:99]
    ds_read_b64_tr_b16 v[232:233], v10 offset:15360
    buffer_load_dwordx4 a[48:51], v1, s[28:31], s90 offen offset:2048 sc1
    v_mfma_f32_16x16x32_bf16 v[100:103], v[180:183], a[8:11], v[100:103]
    ds_read_b64_tr_b16 v[234:235], v10 offset:23552
    v_mfma_f32_16x16x32_bf16 v[104:107], v[184:187], a[8:11], v[104:107]
    ds_read_b64_tr_b16 v[236:237], v13 offset:15360
    buffer_load_dwordx4 a[56:59], v1, s[28:31], s90 offen offset:3072 sc1
    v_mfma_f32_16x16x32_bf16 v[108:111], v[188:191], a[8:11], v[108:111]
    ds_read_b64_tr_b16 v[238:239], v13 offset:23552
    s_waitcnt vmcnt(10) lgkmcnt(8)
    v_mfma_f32_16x16x32_bf16 v[112:115], v[192:195], a[20:23], v[112:115]
    ds_read_b64_tr_b16 v[160:161], v9 offset:28672
    s_mov_b32 s77, 1314816
    buffer_load_dword v19, v86, s[16:19], s77 offen
    v_mfma_f32_16x16x32_bf16 v[116:119], v[196:199], a[20:23], v[116:119]
    ds_read_b64_tr_b16 v[162:163], v9 offset:36864
    v_mfma_f32_16x16x32_bf16 v[120:123], v[200:203], a[20:23], v[120:123]
    ds_read_b64_tr_b16 v[164:165], v12 offset:28672
    v_mfma_f32_16x16x32_bf16 v[124:127], v[204:207], a[20:23], v[124:127]
    ds_read_b64_tr_b16 v[166:167], v12 offset:36864
    v_mfma_f32_16x16x32_bf16 v[96:99], v[192:195], a[16:19], v[96:99]
    ds_read_b64_tr_b16 v[168:169], v9 offset:29696
    s_and_b32 s77, s101, 0xffffff00
    s_bfm_b64 exec, 16, 0
    buffer_load_dword v19, v1, s[28:31], s77 offen sc1
    s_mov_b64 exec, -1
    v_mfma_f32_16x16x32_bf16 v[100:103], v[196:199], a[16:19], v[100:103]
    ds_read_b64_tr_b16 v[170:171], v9 offset:37888
    v_mfma_f32_16x16x32_bf16 v[104:107], v[200:203], a[16:19], v[104:107]
    ds_read_b64_tr_b16 v[172:173], v12 offset:29696
    v_mfma_f32_16x16x32_bf16 v[108:111], v[204:207], a[16:19], v[108:111]
    ds_read_b64_tr_b16 v[174:175], v12 offset:37888
    s_waitcnt vmcnt(10) lgkmcnt(8)
    s_barrier
    v_mfma_f32_16x16x32_bf16 v[112:115], v[224:227], a[28:31], v[112:115]
    ds_read_b64_tr_b16 v[176:177], v9 offset:30720
    s_add_u32 m0, s52, 71680
    s_add_u32 s76, s51, 1146880
    buffer_load_dwordx4 v16, s[16:19], s76 offen lds
    v_mfma_f32_16x16x32_bf16 v[116:119], v[228:231], a[28:31], v[116:119]
    ds_read_b64_tr_b16 v[178:179], v9 offset:38912
    v_mfma_f32_16x16x32_bf16 v[120:123], v[232:235], a[28:31], v[120:123]
    ds_read_b64_tr_b16 v[180:181], v12 offset:30720
    v_mfma_f32_16x16x32_bf16 v[124:127], v[236:239], a[28:31], v[124:127]
    ds_read_b64_tr_b16 v[182:183], v12 offset:38912
    v_mfma_f32_16x16x32_bf16 v[96:99], v[224:227], a[24:27], v[96:99]
    ds_read_b64_tr_b16 v[184:185], v9 offset:31744
    buffer_load_dwordx4 v17, s[16:19], s76 offen offset:1024 lds
    v_mfma_f32_16x16x32_bf16 v[100:103], v[228:231], a[24:27], v[100:103]
    ds_read_b64_tr_b16 v[186:187], v9 offset:39936
    v_mfma_f32_16x16x32_bf16 v[104:107], v[232:235], a[24:27], v[104:107]
    ds_read_b64_tr_b16 v[188:189], v12 offset:31744
    v_mfma_f32_16x16x32_bf16 v[108:111], v[236:239], a[24:27], v[108:111]
    ds_read_b64_tr_b16 v[190:191], v12 offset:39936
    s_waitcnt vmcnt(10) lgkmcnt(8)
    v_mfma_f32_16x16x32_bf16 v[112:115], v[160:163], a[36:39], v[112:115]
    ds_read_b64_tr_b16 v[192:193], v9 offset:45056
    buffer_load_dwordx4 v18, s[16:19], s76 offen offset:2048 lds
    v_mfma_f32_16x16x32_bf16 v[116:119], v[164:167], a[36:39], v[116:119]
    ds_read_b64_tr_b16 v[194:195], v9 offset:53248
    v_mfma_f32_16x16x32_bf16 v[120:123], v[168:171], a[36:39], v[120:123]
    ds_read_b64_tr_b16 v[196:197], v12 offset:45056
    v_mfma_f32_16x16x32_bf16 v[124:127], v[172:175], a[36:39], v[124:127]
    ds_read_b64_tr_b16 v[198:199], v12 offset:53248
    s_mov_b32 s77, 1576960
    v_mfma_f32_16x16x32_bf16 v[96:99], v[160:163], a[32:35], v[96:99]
    ds_read_b64_tr_b16 v[200:201], v9 offset:46080
    buffer_load_dword v19, v86, s[16:19], s77 offen
    v_mfma_f32_16x16x32_bf16 v[100:103], v[164:167], a[32:35], v[100:103]
    ds_read_b64_tr_b16 v[202:203], v9 offset:54272
    v_mfma_f32_16x16x32_bf16 v[104:107], v[168:171], a[32:35], v[104:107]
    ds_read_b64_tr_b16 v[204:205], v12 offset:46080
    v_mfma_f32_16x16x32_bf16 v[108:111], v[172:175], a[32:35], v[108:111]
    ds_read_b64_tr_b16 v[206:207], v12 offset:54272
    s_waitcnt vmcnt(11) lgkmcnt(8)
    v_mfma_f32_16x16x32_bf16 v[112:115], v[176:179], a[44:47], v[112:115]
    ds_read_b64_tr_b16 v[224:225], v9 offset:47104
    ds_read_b64_tr_b16 v[226:227], v9 offset:55296
    v_mfma_f32_16x16x32_bf16 v[116:119], v[180:183], a[44:47], v[116:119]
    ds_read_b64_tr_b16 v[228:229], v12 offset:47104
    ds_read_b64_tr_b16 v[230:231], v12 offset:55296
    v_mfma_f32_16x16x32_bf16 v[120:123], v[184:187], a[44:47], v[120:123]
    ds_read_b64_tr_b16 v[232:233], v9 offset:48128
    ds_read_b64_tr_b16 v[234:235], v9 offset:56320
    v_mfma_f32_16x16x32_bf16 v[124:127], v[188:191], a[44:47], v[124:127]
    ds_read_b64_tr_b16 v[236:237], v12 offset:48128
    ds_read_b64_tr_b16 v[238:239], v12 offset:56320
    s_waitcnt vmcnt(10) lgkmcnt(8)
    v_mfma_f32_16x16x32_bf16 v[112:115], v[192:195], a[52:55], v[112:115]
    v_mfma_f32_16x16x32_bf16 v[116:119], v[196:199], a[52:55], v[116:119]
    v_mfma_f32_16x16x32_bf16 v[120:123], v[200:203], a[52:55], v[120:123]
    v_mfma_f32_16x16x32_bf16 v[124:127], v[204:207], a[52:55], v[124:127]
    s_waitcnt vmcnt(9) lgkmcnt(0)
    v_mfma_f32_16x16x32_bf16 v[112:115], v[224:227], a[60:63], v[112:115]
    v_mfma_f32_16x16x32_bf16 v[116:119], v[228:231], a[60:63], v[116:119]
    v_mfma_f32_16x16x32_bf16 v[120:123], v[232:235], a[60:63], v[120:123]
    v_mfma_f32_16x16x32_bf16 v[124:127], v[236:239], a[60:63], v[124:127]
    s_waitcnt vmcnt(8)
    v_mfma_f32_16x16x32_bf16 v[96:99], v[176:179], a[40:43], v[96:99]
    s_add_u32 m0, s54, 63488
    s_add_u32 s76, s53, 917504
    v_mfma_f32_16x16x32_bf16 v[100:103], v[180:183], a[40:43], v[100:103]
    ds_write_b128 v26, v[112:115] offset:61440
    buffer_load_dwordx4 v15, s[16:19], s76 offen lds
    v_mfma_f32_16x16x32_bf16 v[104:107], v[184:187], a[40:43], v[104:107]
    v_mfma_f32_16x16x32_bf16 v[108:111], v[188:191], a[40:43], v[108:111]
    s_waitcnt vmcnt(8)
    v_mfma_f32_16x16x32_bf16 v[96:99], v[192:195], a[48:51], v[96:99]
    ds_write_b128 v26, v[116:119] offset:62464
    v_mfma_f32_16x16x32_bf16 v[100:103], v[196:199], a[48:51], v[100:103]
    v_mfma_f32_16x16x32_bf16 v[104:107], v[200:203], a[48:51], v[104:107]
    v_mfma_f32_16x16x32_bf16 v[108:111], v[204:207], a[48:51], v[108:111]
    ds_write_b128 v26, v[120:123] offset:63488
    s_waitcnt vmcnt(7)
    v_mfma_f32_16x16x32_bf16 v[96:99], v[224:227], a[56:59], v[96:99]
    v_mfma_f32_16x16x32_bf16 v[100:103], v[228:231], a[56:59], v[100:103]
    v_mfma_f32_16x16x32_bf16 v[104:107], v[232:235], a[56:59], v[104:107]
    ds_write_b128 v26, v[124:127] offset:64512
    v_mfma_f32_16x16x32_bf16 v[108:111], v[236:239], a[56:59], v[108:111]
    s_waitcnt lgkmcnt(0)
    s_barrier
    ds_read_b128 v[160:163], v27 offset:61440
    ds_read_b128 v[164:167], v27 offset:62464
    ds_read_b128 v[168:171], v27 offset:63488
    ds_read_b128 v[172:175], v27 offset:64512
    v_pk_add_f32 v[44:45], v[96:97], v[44:45]
    v_pk_add_f32 v[46:47], v[98:99], v[46:47]
    v_pk_add_f32 v[48:49], v[100:101], v[48:49]
    v_pk_add_f32 v[50:51], v[102:103], v[50:51]
    v_pk_add_f32 v[52:53], v[104:105], v[52:53]
    v_pk_add_f32 v[54:55], v[106:107], v[54:55]
    v_pk_add_f32 v[56:57], v[108:109], v[56:57]
    v_pk_add_f32 v[58:59], v[110:111], v[58:59]
    s_waitcnt lgkmcnt(3)
    v_pk_add_f32 v[44:45], v[160:161], v[44:45]
    v_pk_add_f32 v[46:47], v[162:163], v[46:47]
    s_waitcnt lgkmcnt(2)
    v_pk_add_f32 v[48:49], v[164:165], v[48:49]
    v_pk_add_f32 v[50:51], v[166:167], v[50:51]
    s_waitcnt lgkmcnt(1)
    v_pk_add_f32 v[52:53], v[168:169], v[52:53]
    v_pk_add_f32 v[54:55], v[170:171], v[54:55]
    s_waitcnt lgkmcnt(0)
    v_pk_add_f32 v[56:57], v[172:173], v[56:57]
    v_pk_add_f32 v[58:59], v[174:175], v[58:59]
    v_cvt_pk_bf16_f32 v224, v44, v45
    v_cvt_pk_bf16_f32 v225, v46, v47
    v_cvt_pk_bf16_f32 v226, v48, v49
    v_cvt_pk_bf16_f32 v227, v50, v51
    v_cvt_pk_bf16_f32 v228, v52, v53
    v_cvt_pk_bf16_f32 v229, v54, v55
    v_cvt_pk_bf16_f32 v230, v56, v57
    v_cvt_pk_bf16_f32 v231, v58, v59
    buffer_store_dwordx4 v[224:227], v1, s[28:31], s100 offen sc1
    buffer_store_dwordx4 v[228:231], v1, s[28:31], s100 offen offset:1024 sc1
    s_add_u32 m0, s52, 86016
    s_add_u32 s76, s51, 1376256
    buffer_load_dwordx4 v16, s[16:19], s76 offen lds
    v_pk_add_f32 v[232:233], v[44:45], v[46:47]
    buffer_load_dwordx4 v17, s[16:19], s76 offen offset:1024 lds
    v_pk_mul_f32 v[234:235], v[44:45], v[44:45]
    v_pk_add_f32 v[236:237], v[48:49], v[50:51]
    v_pk_mul_f32 v[238:239], v[46:47], v[46:47]
    buffer_load_dwordx4 v18, s[16:19], s76 offen offset:2048 lds
    v_pk_fma_f32 v[234:235], v[48:49], v[48:49], v[234:235]
    v_pk_fma_f32 v[238:239], v[50:51], v[50:51], v[238:239]
    v_pk_add_f32 v[232:233], v[232:233], v[52:53]
    s_add_u32 m0, s52, 100352
    s_add_u32 s76, s51, 1605632
    buffer_load_dwordx4 v16, s[16:19], s76 offen lds
    v_pk_fma_f32 v[234:235], v[52:53], v[52:53], v[234:235]
    buffer_load_dwordx4 v17, s[16:19], s76 offen offset:1024 lds
    v_pk_add_f32 v[236:237], v[236:237], v[54:55]
    v_pk_fma_f32 v[238:239], v[54:55], v[54:55], v[238:239]
    v_pk_add_f32 v[232:233], v[232:233], v[56:57]
    buffer_load_dwordx4 v18, s[16:19], s76 offen offset:2048 lds
    v_pk_fma_f32 v[234:235], v[56:57], v[56:57], v[234:235]
    v_pk_add_f32 v[236:237], v[236:237], v[58:59]
    v_pk_fma_f32 v[238:239], v[58:59], v[58:59], v[238:239]
    s_add_u32 m0, s54, 92160
    s_add_u32 s76, s53, 1376256
    buffer_load_dwordx4 v15, s[16:19], s76 offen lds
    v_pk_add_f32 v[232:233], v[232:233], v[236:237]
    v_pk_add_f32 v[234:235], v[234:235], v[238:239]
    v_add_f32 v232, v232, v233
    v_add_f32 v233, v234, v235
    s_nop 1
    v_permlane16_swap_b32 v232, v233
    v_add_f32 v232, v232, v233
    v_mov_b32 v233, v232
    s_nop 1
    v_permlane32_swap_b32 v232, v233
    v_add_f32 v232, v232, v233
    s_cmp_lg_u32 s38, 0
    s_cbranch_scc1 ELSE_14008
    buffer_store_dword v232, v60, s[28:31], s101 offen
    s_branch ENDIF_14009
ELSE_14008:
    buffer_store_dword v232, v60, s[28:31], s101 offen sc1
ENDIF_14009:
    s_add_u32 s68, s39, 16
    v_mov_b32 v216, s68
    v_mov_b32 v217, s40
    v_lshlrev_b32 v44, 16, v224
    v_and_b32 v45, 0xffff0000, v224
    v_lshlrev_b32 v46, 16, v225
    v_and_b32 v47, 0xffff0000, v225
    v_lshlrev_b32 v48, 16, v226
    v_and_b32 v49, 0xffff0000, v226
    v_lshlrev_b32 v50, 16, v227
    v_and_b32 v51, 0xffff0000, v227
    v_lshlrev_b32 v52, 16, v228
    v_and_b32 v53, 0xffff0000, v228
    v_lshlrev_b32 v54, 16, v229
    v_and_b32 v55, 0xffff0000, v229
    v_lshlrev_b32 v56, 16, v230
    v_and_b32 v57, 0xffff0000, v230
    v_lshlrev_b32 v58, 16, v231
    v_and_b32 v59, 0xffff0000, v231
    s_waitcnt vmcnt(0)
    s_mov_b64 exec, 1
    s_cmp_lg_u32 s38, 0
    s_cbranch_scc1 ELSE_18010
    buffer_store_dwordx2 v[216:217], off, s[28:31], s41
    s_branch ENDIF_18011
ELSE_18010:
    buffer_store_dwordx2 v[216:217], off, s[28:31], s41 sc1
ENDIF_18011:
    s_mov_b64 exec, -1
    s_barrier
    s_lshl_b32 s68, s36, 15
    s_add_u32 s68, s68, s44
    s_lshl_b32 s100, s36, 11
    s_add_u32 s100, s100, s46
    s_add_u32 s90, s68, 0
    s_add_u32 s91, s68, 4096
    s_add_u32 s92, s68, 8192
    s_add_u32 s93, s68, 12288
    s_lshl_b32 s101, s62, 10
    s_add_u32 s101, s101, s46
    v_add_u32 v222, 16, v20
    s_mov_b32 s80, 0
    s_and_b32 s68, s36, 1
    s_lshr_b32 s69, s36, 1
    s_mul_i32 s69, s69, 7168
    s_lshl_b32 s68, s68, 5
    v_xor_b32 v84, s68, v2
    v_add_u32 v84, s69, v84
    v_add_u32 v85, 57344, v84
    s_add_u32 s68, s54, 6144
    v_add_u32 v28, s68, v6
    v_add_u32 v29, 57344, v28
    s_and_b32 s68, s36, 1
    s_lshl_b32 s68, s68, 5
    s_lshr_b32 s69, s36, 1
    s_lshl_b32 s69, s69, 10
    v_xor_b32 v232, s68, v2
    v_add_u32 v236, 2048, v232
    v_add_u32 v232, s69, v232
    v_add_u32 v234, 3072, v232
    v_add_u32 v238, 3072, v236
    v_add_u32 v233, 6144, v6
    v_add_u32 v235, 6656, v6
    s_cmp_ge_u32 s36, 2
    s_cselect_b64 vcc, -1, 0
    v_cndmask_b32 v236, v236, v233, vcc
    v_cndmask_b32 v238, v238, v235, vcc
    v_add_u32 v233, 0x10000, v232
    v_add_u32 v235, 0x10000, v234
    v_add_u32 v237, 0x10000, v236
    v_add_u32 v239, 0x10000, v238
    ds_read_b64_tr_b16 v[96:97], v232 offset:0
    ds_read_b64_tr_b16 v[98:99], v234 offset:0
    ds_read_b64_tr_b16 v[100:101], v236 offset:0
    ds_read_b64_tr_b16 v[102:103], v238 offset:0
    ds_read_b64_tr_b16 v[104:105], v232 offset:7168
    ds_read_b64_tr_b16 v[106:107], v234 offset:7168
    ds_read_b64_tr_b16 v[108:109], v236 offset:7168
    ds_read_b64_tr_b16 v[110:111], v238 offset:7168
    s_waitcnt lgkmcnt(4)
    v_mfma_f32_16x16x32_bf16 v[224:227], v[96:99], v[68:71], 0
    ds_read_b64_tr_b16 v[112:113], v232 offset:14336
    ds_read_b64_tr_b16 v[114:115], v234 offset:14336
    v_mfma_f32_16x16x32_bf16 v[228:231], v[100:103], v[68:71], 0
    ds_read_b64_tr_b16 v[116:117], v236 offset:14336
    ds_read_b64_tr_b16 v[118:119], v238 offset:14336
    s_waitcnt lgkmcnt(4)
    v_mfma_f32_16x16x32_bf16 v[224:227], v[104:107], v[68:71], v[224:227]
    ds_read_b64_tr_b16 v[96:97], v232 offset:21504
    ds_read_b64_tr_b16 v[98:99], v234 offset:21504
    v_mfma_f32_16x16x32_bf16 v[228:231], v[108:111], v[68:71], v[228:231]
    ds_read_b64_tr_b16 v[100:101], v236 offset:21504
    ds_read_b64_tr_b16 v[102:103], v238 offset:21504
    s_waitcnt lgkmcnt(4)
    v_mfma_f32_16x16x32_bf16 v[224:227], v[112:115], v[68:71], v[224:227]
    ds_read_b64_tr_b16 v[104:105], v232 offset:28672
    ds_read_b64_tr_b16 v[106:107], v234 offset:28672
    v_mfma_f32_16x16x32_bf16 v[228:231], v[116:119], v[68:71], v[228:231]
    ds_read_b64_tr_b16 v[108:109], v236 offset:28672
    ds_read_b64_tr_b16 v[110:111], v238 offset:28672
    s_waitcnt lgkmcnt(4)
    v_mfma_f32_16x16x32_bf16 v[224:227], v[96:99], v[68:71], v[224:227]
    ds_read_b64_tr_b16 v[112:113], v232 offset:35840
    ds_read_b64_tr_b16 v[114:115], v234 offset:35840
    v_mfma_f32_16x16x32_bf16 v[228:231], v[100:103], v[68:71], v[228:231]
    ds_read_b64_tr_b16 v[116:117], v236 offset:35840
    ds_read_b64_tr_b16 v[118:119], v238 offset:35840
    s_waitcnt lgkmcnt(4)
    v_mfma_f32_16x16x32_bf16 v[224:227], v[104:107], v[68:71], v[224:227]
    ds_read_b64_tr_b16 v[96:97], v232 offset:43008
    ds_read_b64_tr_b16 v[98:99], v234 offset:43008
    v_mfma_f32_16x16x32_bf16 v[228:231], v[108:111], v[68:71], v[228:231]
    ds_read_b64_tr_b16 v[100:101], v236 offset:43008
    ds_read_b64_tr_b16 v[102:103], v238 offset:43008
    s_waitcnt lgkmcnt(4)
    v_mfma_f32_16x16x32_bf16 v[224:227], v[112:115], v[68:71], v[224:227]
    ds_read_b64_tr_b16 v[104:105], v232 offset:50176
    ds_read_b64_tr_b16 v[106:107], v234 offset:50176
    v_mfma_f32_16x16x32_bf16 v[228:231], v[116:119], v[68:71], v[228:231]
    ds_read_b64_tr_b16 v[108:109], v236 offset:50176
    ds_read_b64_tr_b16 v[110:111], v238 offset:50176
    s_waitcnt lgkmcnt(4)
    v_mfma_f32_16x16x32_bf16 v[224:227], v[96:99], v[68:71], v[224:227]
    ds_read_b64_tr_b16 v[112:113], v232 offset:57344
    ds_read_b64_tr_b16 v[114:115], v234 offset:57344
    v_mfma_f32_16x16x32_bf16 v[228:231], v[100:103], v[68:71], v[228:231]
    ds_read_b64_tr_b16 v[116:117], v236 offset:57344
    ds_read_b64_tr_b16 v[118:119], v238 offset:57344
    s_waitcnt lgkmcnt(4)
    v_mfma_f32_16x16x32_bf16 v[224:227], v[104:107], v[68:71], v[224:227]
    ds_read_b64_tr_b16 v[96:97], v232 offset:64512
    ds_read_b64_tr_b16 v[98:99], v234 offset:64512
    v_mfma_f32_16x16x32_bf16 v[228:231], v[108:111], v[68:71], v[228:231]
    ds_read_b64_tr_b16 v[100:101], v236 offset:64512
    ds_read_b64_tr_b16 v[102:103], v238 offset:64512
    s_waitcnt lgkmcnt(4)
    v_mfma_f32_16x16x32_bf16 v[224:227], v[112:115], v[68:71], v[224:227]
    ds_read_b64_tr_b16 v[104:105], v233 offset:6144
    ds_read_b64_tr_b16 v[106:107], v235 offset:6144
    v_mfma_f32_16x16x32_bf16 v[228:231], v[116:119], v[68:71], v[228:231]
    ds_read_b64_tr_b16 v[108:109], v237 offset:6144
    ds_read_b64_tr_b16 v[110:111], v239 offset:6144
    s_waitcnt lgkmcnt(4)
    v_mfma_f32_16x16x32_bf16 v[224:227], v[96:99], v[68:71], v[224:227]
    ds_read_b64_tr_b16 v[112:113], v233 offset:13312
    ds_read_b64_tr_b16 v[114:115], v235 offset:13312
    v_mfma_f32_16x16x32_bf16 v[228:231], v[100:103], v[68:71], v[228:231]
    ds_read_b64_tr_b16 v[116:117], v237 offset:13312
    ds_read_b64_tr_b16 v[118:119], v239 offset:13312
    s_waitcnt lgkmcnt(4)
    v_mfma_f32_16x16x32_bf16 v[224:227], v[104:107], v[68:71], v[224:227]
    ds_read_b64_tr_b16 v[96:97], v233 offset:20480
    ds_read_b64_tr_b16 v[98:99], v235 offset:20480
    v_mfma_f32_16x16x32_bf16 v[228:231], v[108:111], v[68:71], v[228:231]
    ds_read_b64_tr_b16 v[100:101], v237 offset:20480
    ds_read_b64_tr_b16 v[102:103], v239 offset:20480
    s_waitcnt lgkmcnt(4)
    v_mfma_f32_16x16x32_bf16 v[224:227], v[112:115], v[68:71], v[224:227]
    ds_read_b64_tr_b16 v[104:105], v233 offset:27648
    ds_read_b64_tr_b16 v[106:107], v235 offset:27648
    v_mfma_f32_16x16x32_bf16 v[228:231], v[116:119], v[68:71], v[228:231]
    ds_read_b64_tr_b16 v[108:109], v237 offset:27648
    ds_read_b64_tr_b16 v[110:111], v239 offset:27648
    s_waitcnt lgkmcnt(4)
    v_mfma_f32_16x16x32_bf16 v[224:227], v[96:99], v[68:71], v[224:227]
    ds_read_b64_tr_b16 v[112:113], v233 offset:34816
    ds_read_b64_tr_b16 v[114:115], v235 offset:34816
    v_mfma_f32_16x16x32_bf16 v[228:231], v[100:103], v[68:71], v[228:231]
    ds_read_b64_tr_b16 v[116:117], v237 offset:34816
    ds_read_b64_tr_b16 v[118:119], v239 offset:34816
    s_waitcnt lgkmcnt(4)
    v_mfma_f32_16x16x32_bf16 v[224:227], v[104:107], v[68:71], v[224:227]
    ds_read_b64_tr_b16 v[96:97], v233 offset:41984
    ds_read_b64_tr_b16 v[98:99], v235 offset:41984
    v_mfma_f32_16x16x32_bf16 v[228:231], v[108:111], v[68:71], v[228:231]
    ds_read_b64_tr_b16 v[100:101], v237 offset:41984
    ds_read_b64_tr_b16 v[102:103], v239 offset:41984
    s_waitcnt lgkmcnt(4)
    v_mfma_f32_16x16x32_bf16 v[224:227], v[112:115], v[68:71], v[224:227]
    v_mfma_f32_16x16x32_bf16 v[228:231], v[116:119], v[68:71], v[228:231]
    s_waitcnt lgkmcnt(0)
    v_mfma_f32_16x16x32_bf16 v[224:227], v[96:99], v[68:71], v[224:227]
    v_mfma_f32_16x16x32_bf16 v[228:231], v[100:103], v[68:71], v[228:231]
    s_mov_b64 exec, s[2:3]
    buffer_load_dwordx2 v[152:153], v22, s[28:31], 0 offen sc1
    s_mov_b64 exec, -1
    s_lshl_b32 s68, s36, 6
    s_min_u32 s69, s36, 2
    s_lshl_b32 s69, s69, 6
    v_add_u32 v232, s68, v64
    v_add_u32 v233, s69, v64
    s_mov_b32 s82, 0x00010001
    s_mov_b32 s83, 0x00010001
    s_mov_b64 exec, s[82:83]
    ds_write_b128 v232, v[224:227] offset:512
    ds_write_b128 v233, v[228:231] offset:768
    s_mov_b64 exec, -1
    s_waitcnt lgkmcnt(0)
    s_barrier
    s_mov_b64 exec, s[2:3]
    s_waitcnt vmcnt(0)
POLL_18013:
    buffer_load_dwordx2 v[154:155], v22, s[28:31], 0 offen sc1
    s_waitcnt vmcnt(1)
    v_sub_u32 v152, v152, v222
    v_cmp_eq_u32_e64 s[82:83], v153, v21
    v_cmp_gt_u32 vcc, 112, v152
    s_nop 1
    s_and_b64 vcc, vcc, s[82:83]
    s_cmp_eq_u64 vcc, exec
    s_cbranch_scc1 PDONE_18012
    buffer_load_dwordx2 v[152:153], v22, s[28:31], 0 offen sc1
    s_waitcnt vmcnt(1)
    v_sub_u32 v154, v154, v222
    v_cmp_eq_u32_e64 s[82:83], v155, v21
    v_cmp_gt_u32 vcc, 112, v154
    s_nop 1
    s_and_b64 vcc, vcc, s[82:83]
    s_cmp_eq_u64 vcc, exec
    s_cbranch_scc1 PDONE_18012
    s_add_u32 s80, s80, 1
    s_cmp_lt_u32 s80, 0x20000
    s_cbranch_scc1 POLL_18013
    s_branch L_END
PDONE_18012:
    s_mov_b64 exec, -1
    buffer_load_dwordx4 a[0:3], v1, s[28:31], s90 offen offset:0 sc1
    buffer_load_dwordx4 a[4:7], v95, s[28:31], s90 offen offset:0 sc1
    buffer_load_dwordx4 a[8:11], v1, s[28:31], s90 offen offset:1024 sc1
    buffer_load_dwordx4 a[12:15], v95, s[28:31], s90 offen offset:1024 sc1
    ds_read_b64_tr_b16 v[160:161], v2 offset:0
    ds_read_b64_tr_b16 v[162:163], v2 offset:3072
    ds_read_b64_tr_b16 v[164:165], v4 offset:0
    ds_read_b64_tr_b16 v[166:167], v4 offset:3072
    ds_read_b64_tr_b16 v[168:169], v2 offset:1024
    ds_read_b64_tr_b16 v[170:171], v2 offset:4096
    ds_read_b64_tr_b16 v[172:173], v4 offset:1024
    ds_read_b64_tr_b16 v[174:175], v4 offset:4096
    ds_read_b64_tr_b16 v[176:177], v2 offset:2048
    ds_read_b64_tr_b16 v[178:179], v2 offset:5120
    ds_read_b64_tr_b16 v[180:181], v4 offset:2048
    ds_read_b64_tr_b16 v[182:183], v4 offset:5120
    ds_read_b64_tr_b16 v[184:185], v6 offset:6144
    ds_read_b64_tr_b16 v[186:187], v6 offset:6656
    buffer_load_dwordx4 a[16:19], v1, s[28:31], s90 offen offset:2048 sc1
    buffer_load_dwordx4 a[20:23], v95, s[28:31], s90 offen offset:2048 sc1
    s_waitcnt vmcnt(4) lgkmcnt(6)
    v_mfma_f32_16x16x32_bf16 v[96:99], v[160:163], a[0:3], 0
    ds_read_b64_tr_b16 v[188:189], v2 offset:7168
    ds_read_b128 v[228:231], v64 offset:512
    v_mfma_f32_16x16x32_bf16 v[124:127], v[160:163], a[4:7], 0
    ds_read_b64_tr_b16 v[190:191], v2 offset:10240
    buffer_load_dwordx4 a[24:27], v1, s[28:31], s90 offen offset:3072 sc1
    v_mfma_f32_16x16x32_bf16 v[100:103], v[164:167], a[0:3], 0
    ds_read_b64_tr_b16 v[192:193], v4 offset:7168
    ds_read_b128 v[232:235], v64 offset:576
    v_mfma_f32_16x16x32_bf16 v[128:131], v[164:167], a[4:7], 0
    ds_read_b64_tr_b16 v[194:195], v4 offset:10240
    ds_read_b128 v[236:239], v64 offset:640
    v_mfma_f32_16x16x32_bf16 v[104:107], v[168:171], a[0:3], 0
    ds_read_b64_tr_b16 v[196:197], v2 offset:8192
    buffer_load_dwordx4 a[28:31], v95, s[28:31], s90 offen offset:3072 sc1
    v_mfma_f32_16x16x32_bf16 v[132:135], v[168:171], a[4:7], 0
    ds_read_b64_tr_b16 v[198:199], v2 offset:11264
    ds_read_b128 v[240:243], v64 offset:704
    v_mfma_f32_16x16x32_bf16 v[108:111], v[172:175], a[0:3], 0
    ds_read_b64_tr_b16 v[200:201], v4 offset:8192
    ds_read_b128 v[244:247], v64 offset:768
    v_mfma_f32_16x16x32_bf16 v[136:139], v[172:175], a[4:7], 0
    ds_read_b64_tr_b16 v[202:203], v4 offset:11264
    s_waitcnt lgkmcnt(13)
    v_mfma_f32_16x16x32_bf16 v[112:115], v[176:179], a[0:3], 0
    ds_read_b64_tr_b16 v[204:205], v2 offset:9216
    buffer_load_dwordx4 a[32:35], v1, s[28:31], s91 offen offset:0 sc1
    v_mfma_f32_16x16x32_bf16 v[140:143], v[176:179], a[4:7], 0
    ds_read_b64_tr_b16 v[206:207], v2 offset:12288
    ds_read_b128 v[248:251], v64 offset:832
    v_mfma_f32_16x16x32_bf16 v[116:119], v[180:183], a[0:3], 0
    ds_read_b64_tr_b16 v[208:209], v4 offset:9216
    ds_read_b128 v[252:255], v64 offset:896
    v_mfma_f32_16x16x32_bf16 v[144:147], v[180:183], a[4:7], 0
    ds_read_b64_tr_b16 v[210:211], v4 offset:12288
    buffer_load_dwordx4 a[36:39], v95, s[28:31], s91 offen offset:0 sc1
    v_mfma_f32_16x16x32_bf16 v[120:123], v[184:187], a[0:3], 0
    ds_read_b64_tr_b16 v[212:213], v6 offset:13312
    v_mfma_f32_16x16x32_bf16 v[148:151], v[184:187], a[4:7], 0
    ds_read_b64_tr_b16 v[214:215], v6 offset:13824
    s_waitcnt vmcnt(6) lgkmcnt(8)
    v_mfma_f32_16x16x32_bf16 v[96:99], v[188:191], a[8:11], v[96:99]
    ds_read_b64_tr_b16 v[160:161], v2 offset:14336
    v_mfma_f32_16x16x32_bf16 v[124:127], v[188:191], a[12:15], v[124:127]
    ds_read_b64_tr_b16 v[162:163], v2 offset:17408
    buffer_load_dwordx4 v[216:219], v1, s[28:31], s100 offen sc1
    v_mfma_f32_16x16x32_bf16 v[100:103], v[192:195], a[8:11], v[100:103]
    ds_read_b64_tr_b16 v[164:165], v4 offset:14336
    ds_read_b64_tr_b16 a[0:1], v84 offset:0
    v_mfma_f32_16x16x32_bf16 v[128:131], v[192:195], a[12:15], v[128:131]
    ds_read_b64_tr_b16 v[166:167], v4 offset:17408
    ds_read_b64_tr_b16 a[2:3], v84 offset:3072
    v_mfma_f32_16x16x32_bf16 v[104:107], v[196:199], a[8:11], v[104:107]
    ds_read_b64_tr_b16 v[168:169], v2 offset:15360
    buffer_load_dwordx4 v[220:223], v1, s[28:31], s100 offen offset:1024 sc1
    v_mfma_f32_16x16x32_bf16 v[132:135], v[196:199], a[12:15], v[132:135]
    ds_read_b64_tr_b16 v[170:171], v2 offset:18432
    ds_read_b64_tr_b16 a[4:5], v84 offset:1024
    v_mfma_f32_16x16x32_bf16 v[108:111], v[200:203], a[8:11], v[108:111]
    ds_read_b64_tr_b16 v[172:173], v4 offset:15360
    ds_read_b64_tr_b16 a[6:7], v84 offset:4096
    v_mfma_f32_16x16x32_bf16 v[136:139], v[200:203], a[12:15], v[136:139]
    ds_read_b64_tr_b16 v[174:175], v4 offset:18432
    s_waitcnt lgkmcnt(12)
    v_mfma_f32_16x16x32_bf16 v[112:115], v[204:207], a[8:11], v[112:115]
    ds_read_b64_tr_b16 v[176:177], v2 offset:16384
    buffer_load_dwordx4 a[40:43], v1, s[28:31], s91 offen offset:1024 sc1
    v_mfma_f32_16x16x32_bf16 v[140:143], v[204:207], a[12:15], v[140:143]
    ds_read_b64_tr_b16 v[178:179], v2 offset:19456
    v_mfma_f32_16x16x32_bf16 v[116:119], v[208:211], a[8:11], v[116:119]
    ds_read_b64_tr_b16 v[180:181], v4 offset:16384
    v_mfma_f32_16x16x32_bf16 v[144:147], v[208:211], a[12:15], v[144:147]
    ds_read_b64_tr_b16 v[182:183], v4 offset:19456
    buffer_load_dwordx4 a[44:47], v95, s[28:31], s91 offen offset:1024 sc1
    v_mfma_f32_16x16x32_bf16 v[120:123], v[212:215], a[8:11], v[120:123]
    ds_read_b64_tr_b16 v[184:185], v6 offset:20480
    v_mfma_f32_16x16x32_bf16 v[148:151], v[212:215], a[12:15], v[148:151]
    ds_read_b64_tr_b16 v[186:187], v6 offset:20992
    s_waitcnt vmcnt(8) lgkmcnt(6)
    v_mfma_f32_16x16x32_bf16 v[96:99], v[160:163], a[16:19], v[96:99]
    ds_read_b64_tr_b16 v[188:189], v2 offset:21504
    s_waitcnt vmcnt(3)
    v_add_f32 v216, v216, v218
    v_mfma_f32_16x16x32_bf16 v[124:127], v[160:163], a[20:23], v[124:127]
    ds_read_b64_tr_b16 v[190:191], v2 offset:24576
    buffer_load_dwordx4 a[48:51], v1, s[28:31], s91 offen offset:2048 sc1
    v_mfma_f32_16x16x32_bf16 v[100:103], v[164:167], a[16:19], v[100:103]
    ds_read_b64_tr_b16 v[192:193], v4 offset:21504
    ds_read_b64_tr_b16 a[8:9], v84 offset:2048
    v_mfma_f32_16x16x32_bf16 v[128:131], v[164:167], a[20:23], v[128:131]
    ds_read_b64_tr_b16 v[194:195], v4 offset:24576
    ds_read_b64_tr_b16 a[10:11], v84 offset:5120
    v_mfma_f32_16x16x32_bf16 v[104:107], v[168:171], a[16:19], v[104:107]
    ds_read_b64_tr_b16 v[196:197], v2 offset:22528
    buffer_load_dwordx4 a[52:55], v95, s[28:31], s91 offen offset:2048 sc1
    v_mfma_f32_16x16x32_bf16 v[132:135], v[168:171], a[20:23], v[132:135]
    ds_read_b64_tr_b16 v[198:199], v2 offset:25600
    ds_read_b64_tr_b16 a[12:13], v84 offset:14336
    v_mfma_f32_16x16x32_bf16 v[108:111], v[172:175], a[16:19], v[108:111]
    ds_read_b64_tr_b16 v[200:201], v4 offset:22528
    s_mov_b32 s77, 4096
    v_mfma_f32_16x16x32_bf16 v[136:139], v[172:175], a[20:23], v[136:139]
    ds_read_b64_tr_b16 v[202:203], v4 offset:25600
    s_waitcnt lgkmcnt(11)
    v_mfma_f32_16x16x32_bf16 v[112:115], v[176:179], a[16:19], v[112:115]
    ds_read_b64_tr_b16 v[204:205], v2 offset:23552
    buffer_load_dword v19, v14, s[20:23], s77 offen
    v_mfma_f32_16x16x32_bf16 v[140:143], v[176:179], a[20:23], v[140:143]
    ds_read_b64_tr_b16 v[206:207], v2 offset:26624
    ds_read_b64_tr_b16 a[14:15], v84 offset:17408
    v_mfma_f32_16x16x32_bf16 v[116:119], v[180:183], a[16:19], v[116:119]
    ds_read_b64_tr_b16 v[208:209], v4 offset:23552
    s_waitcnt vmcnt(5)
    v_add_f32 v220, v220, v222
    v_mfma_f32_16x16x32_bf16 v[144:147], v[180:183], a[20:23], v[144:147]
    ds_read_b64_tr_b16 v[210:211], v4 offset:26624
    buffer_load_dwordx4 a[56:59], v1, s[28:31], s91 offen offset:3072 sc1
    v_mfma_f32_16x16x32_bf16 v[120:123], v[184:187], a[16:19], v[120:123]
    ds_read_b64_tr_b16 v[212:213], v6 offset:27648
    v_permlane16_swap_b32 v216, v220
    v_mfma_f32_16x16x32_bf16 v[148:151], v[184:187], a[20:23], v[148:151]
    ds_read_b64_tr_b16 v[214:215], v6 offset:28160
    s_waitcnt lgkmcnt(7)
    v_mfma_f32_16x16x32_bf16 v[96:99], v[188:191], a[24:27], v[96:99]
    ds_read_b64_tr_b16 v[160:161], v2 offset:28672
    v_add_f32 v216, v216, v220
    v_mfma_f32_16x16x32_bf16 v[124:127], v[188:191], a[28:31], v[124:127]
    ds_read_b64_tr_b16 v[162:163], v2 offset:31744
    buffer_load_dwordx4 a[60:63], v95, s[28:31], s91 offen offset:3072 sc1
    v_mfma_f32_16x16x32_bf16 v[100:103], v[192:195], a[24:27], v[100:103]
    ds_read_b64_tr_b16 v[164:165], v4 offset:28672
    ds_read_b64_tr_b16 a[16:17], v84 offset:15360
    v_mfma_f32_16x16x32_bf16 v[128:131], v[192:195], a[28:31], v[128:131]
    ds_read_b64_tr_b16 v[166:167], v4 offset:31744
    ds_read_b64_tr_b16 a[18:19], v84 offset:18432
    v_mfma_f32_16x16x32_bf16 v[104:107], v[196:199], a[24:27], v[104:107]
    ds_read_b64_tr_b16 v[168:169], v2 offset:29696
    ds_read_b64_tr_b16 a[20:21], v84 offset:16384
    v_mfma_f32_16x16x32_bf16 v[132:135], v[196:199], a[28:31], v[132:135]
    ds_read_b64_tr_b16 v[170:171], v2 offset:32768
    buffer_load_dwordx4 a[64:67], v1, s[28:31], s92 offen offset:0 sc1
    v_mfma_f32_16x16x32_bf16 v[108:111], v[200:203], a[24:27], v[108:111]
    ds_read_b64_tr_b16 v[172:173], v4 offset:29696
    ds_read_b64_tr_b16 a[22:23], v84 offset:19456
    v_mfma_f32_16x16x32_bf16 v[136:139], v[200:203], a[28:31], v[136:139]
    ds_read_b64_tr_b16 v[174:175], v4 offset:32768
    s_waitcnt lgkmcnt(12)
    v_mfma_f32_16x16x32_bf16 v[112:115], v[204:207], a[24:27], v[112:115]
    ds_read_b64_tr_b16 v[176:177], v2 offset:30720
    v_mov_b32 v220, v216
    v_mfma_f32_16x16x32_bf16 v[140:143], v[204:207], a[28:31], v[140:143]
    ds_read_b64_tr_b16 v[178:179], v2 offset:33792
    v_permlane32_swap_b32 v216, v220
    v_mfma_f32_16x16x32_bf16 v[116:119], v[208:211], a[24:27], v[116:119]
    ds_read_b64_tr_b16 v[180:181], v4 offset:30720
    buffer_load_dwordx4 a[68:71], v95, s[28:31], s92 offen offset:0 sc1
    v_mfma_f32_16x16x32_bf16 v[144:147], v[208:211], a[28:31], v[144:147]
    ds_read_b64_tr_b16 v[182:183], v4 offset:33792
    v_add_f32 v216, v216, v220
    v_mfma_f32_16x16x32_bf16 v[120:123], v[212:215], a[24:27], v[120:123]
    ds_read_b64_tr_b16 v[184:185], v6 offset:34816
    v_mov_b32 v220, v216
    v_mfma_f32_16x16x32_bf16 v[148:151], v[212:215], a[28:31], v[148:151]
    ds_read_b64_tr_b16 v[186:187], v6 offset:35328
    s_waitcnt lgkmcnt(6)
    v_mfma_f32_16x16x32_bf16 v[96:99], v[160:163], a[32:35], v[96:99]
    ds_read_b64_tr_b16 v[188:189], v2 offset:35840
    s_mov_b32 s77, 135168
    v_mfma_f32_16x16x32_bf16 v[124:127], v[160:163], a[36:39], v[124:127]
    ds_read_b64_tr_b16 v[190:191], v2 offset:38912
    buffer_load_dword v19, v14, s[20:23], s77 offen
    v_mfma_f32_16x16x32_bf16 v[100:103], v[164:167], a[32:35], v[100:103]
    ds_read_b64_tr_b16 v[192:193], v4 offset:35840
    ds_read_b64_tr_b16 a[24:25], v28 offset:0
    v_mfma_f32_16x16x32_bf16 v[128:131], v[164:167], a[36:39], v[128:131]
    ds_read_b64_tr_b16 v[194:195], v4 offset:38912
    ds_read_b64_tr_b16 a[26:27], v28 offset:512
    v_mfma_f32_16x16x32_bf16 v[104:107], v[168:171], a[32:35], v[104:107]
    ds_read_b64_tr_b16 v[196:197], v2 offset:36864
    ds_read_b64_tr_b16 a[28:29], v84 offset:28672
    v_mfma_f32_16x16x32_bf16 v[132:135], v[168:171], a[36:39], v[132:135]
    ds_read_b64_tr_b16 v[198:199], v2 offset:39936
    buffer_load_dwordx4 a[72:75], v1, s[28:31], s92 offen offset:1024 sc1
    v_mfma_f32_16x16x32_bf16 v[108:111], v[172:175], a[32:35], v[108:111]
    ds_read_b64_tr_b16 v[200:201], v4 offset:36864
    ds_read_b64_tr_b16 a[30:31], v84 offset:31744
    v_mfma_f32_16x16x32_bf16 v[136:139], v[172:175], a[36:39], v[136:139]
    ds_read_b64_tr_b16 v[202:203], v4 offset:39936
    s_waitcnt lgkmcnt(12)
    v_mfma_f32_16x16x32_bf16 v[112:115], v[176:179], a[32:35], v[112:115]
    ds_read_b64_tr_b16 v[204:205], v2 offset:37888
    v_permlane16_swap_b32 v216, v220
    v_mfma_f32_16x16x32_bf16 v[140:143], v[176:179], a[36:39], v[140:143]
    ds_read_b64_tr_b16 v[206:207], v2 offset:40960
    v_mul_f32 v76, 0xbb000000, v216
    v_mfma_f32_16x16x32_bf16 v[116:119], v[180:183], a[32:35], v[116:119]
    ds_read_b64_tr_b16 v[208:209], v4 offset:37888
    buffer_load_dwordx4 a[76:79], v95, s[28:31], s92 offen offset:1024 sc1
    v_mfma_f32_16x16x32_bf16 v[144:147], v[180:183], a[36:39], v[144:147]
    ds_read_b64_tr_b16 v[210:211], v4 offset:40960
    v_mul_f32 v77, 0xbb000000, v220
    v_mfma_f32_16x16x32_bf16 v[120:123], v[184:187], a[32:35], v[120:123]
    ds_read_b64_tr_b16 v[212:213], v6 offset:41984
    v_mfma_f32_16x16x32_bf16 v[148:151], v[184:187], a[36:39], v[148:151]
    ds_read_b64_tr_b16 v[214:215], v6 offset:42496
    s_waitcnt vmcnt(10) lgkmcnt(6)
    v_mfma_f32_16x16x32_bf16 v[96:99], v[188:191], a[40:43], v[96:99]
    ds_read_b64_tr_b16 v[160:161], v2 offset:43008
    v_mfma_f32_16x16x32_bf16 v[124:127], v[188:191], a[44:47], v[124:127]
    ds_read_b64_tr_b16 v[162:163], v2 offset:46080
    buffer_load_dwordx4 a[80:83], v1, s[28:31], s92 offen offset:2048 sc1
    v_mfma_f32_16x16x32_bf16 v[100:103], v[192:195], a[40:43], v[100:103]
    ds_read_b64_tr_b16 v[164:165], v4 offset:43008
    ds_read_b64_tr_b16 a[32:33], v84 offset:29696
    v_mfma_f32_16x16x32_bf16 v[128:131], v[192:195], a[44:47], v[128:131]
    ds_read_b64_tr_b16 v[166:167], v4 offset:46080
    ds_read_b64_tr_b16 a[34:35], v84 offset:32768
    v_mfma_f32_16x16x32_bf16 v[104:107], v[196:199], a[40:43], v[104:107]
    ds_read_b64_tr_b16 v[168:169], v2 offset:44032
    ds_read_b64_tr_b16 a[36:37], v84 offset:30720
    v_mfma_f32_16x16x32_bf16 v[132:135], v[196:199], a[44:47], v[132:135]
    ds_read_b64_tr_b16 v[170:171], v2 offset:47104
    buffer_load_dwordx4 a[84:87], v95, s[28:31], s92 offen offset:2048 sc1
    v_mfma_f32_16x16x32_bf16 v[108:111], v[200:203], a[40:43], v[108:111]
    ds_read_b64_tr_b16 v[172:173], v4 offset:44032
    ds_read_b64_tr_b16 a[38:39], v84 offset:33792
    v_mfma_f32_16x16x32_bf16 v[136:139], v[200:203], a[44:47], v[136:139]
    ds_read_b64_tr_b16 v[174:175], v4 offset:47104
    s_waitcnt lgkmcnt(12)
    v_mfma_f32_16x16x32_bf16 v[112:115], v[204:207], a[40:43], v[112:115]
    ds_read_b64_tr_b16 v[176:177], v2 offset:45056
    v_mfma_f32_16x16x32_bf16 v[140:143], v[204:207], a[44:47], v[140:143]
    ds_read_b64_tr_b16 v[178:179], v2 offset:48128
    s_mov_b32 s77, 266240
    v_mfma_f32_16x16x32_bf16 v[116:119], v[208:211], a[40:43], v[116:119]
    ds_read_b64_tr_b16 v[180:181], v4 offset:45056
    buffer_load_dword v19, v14, s[20:23], s77 offen
    v_mfma_f32_16x16x32_bf16 v[144:147], v[208:211], a[44:47], v[144:147]
    ds_read_b64_tr_b16 v[182:183], v4 offset:48128
    v_mfma_f32_16x16x32_bf16 v[120:123], v[212:215], a[40:43], v[120:123]
    ds_read_b64_tr_b16 v[184:185], v6 offset:49152
    v_mfma_f32_16x16x32_bf16 v[148:151], v[212:215], a[44:47], v[148:151]
    ds_read_b64_tr_b16 v[186:187], v6 offset:49664
    s_waitcnt vmcnt(11) lgkmcnt(6)
    v_mfma_f32_16x16x32_bf16 v[96:99], v[160:163], a[48:51], v[96:99]
    ds_read_b64_tr_b16 v[188:189], v2 offset:50176
    v_mfma_f32_16x16x32_bf16 v[124:127], v[160:163], a[52:55], v[124:127]
    ds_read_b64_tr_b16 v[190:191], v2 offset:53248
    buffer_load_dwordx4 a[88:91], v1, s[28:31], s92 offen offset:3072 sc1
    v_mfma_f32_16x16x32_bf16 v[100:103], v[164:167], a[48:51], v[100:103]
    ds_read_b64_tr_b16 v[192:193], v4 offset:50176
    ds_read_b64_tr_b16 a[40:41], v84 offset:43008
    v_mfma_f32_16x16x32_bf16 v[128:131], v[164:167], a[52:55], v[128:131]
    ds_read_b64_tr_b16 v[194:195], v4 offset:53248
    ds_read_b64_tr_b16 a[42:43], v84 offset:46080
    v_mfma_f32_16x16x32_bf16 v[104:107], v[168:171], a[48:51], v[104:107]
    ds_read_b64_tr_b16 v[196:197], v2 offset:51200
    ds_read_b64_tr_b16 a[44:45], v84 offset:44032
    v_fmac_f32 v99, v76, v231
    v_mfma_f32_16x16x32_bf16 v[132:135], v[168:171], a[52:55], v[132:135]
    ds_read_b64_tr_b16 v[198:199], v2 offset:54272
    buffer_load_dwordx4 a[92:95], v95, s[28:31], s92 offen offset:3072 sc1
    v_mfma_f32_16x16x32_bf16 v[108:111], v[172:175], a[48:51], v[108:111]
    ds_read_b64_tr_b16 v[200:201], v4 offset:51200
    ds_read_b64_tr_b16 a[46:47], v84 offset:47104
    v_mfma_f32_16x16x32_bf16 v[136:139], v[172:175], a[52:55], v[136:139]
    ds_read_b64_tr_b16 v[202:203], v4 offset:54272
    s_waitcnt lgkmcnt(12)
    v_mfma_f32_16x16x32_bf16 v[112:115], v[176:179], a[48:51], v[112:115]
    ds_read_b64_tr_b16 v[204:205], v2 offset:52224
    v_fmac_f32 v96, v76, v228
    v_mfma_f32_16x16x32_bf16 v[140:143], v[176:179], a[52:55], v[140:143]
    ds_read_b64_tr_b16 v[206:207], v2 offset:55296
    v_fmac_f32 v97, v76, v229
    v_mfma_f32_16x16x32_bf16 v[116:119], v[180:183], a[48:51], v[116:119]
    ds_read_b64_tr_b16 v[208:209], v4 offset:52224
    buffer_load_dwordx4 a[96:99], v1, s[28:31], s93 offen offset:0 sc1
    v_mfma_f32_16x16x32_bf16 v[144:147], v[180:183], a[52:55], v[144:147]
    ds_read_b64_tr_b16 v[210:211], v4 offset:55296
    v_fmac_f32 v98, v76, v230
    v_mfma_f32_16x16x32_bf16 v[120:123], v[184:187], a[48:51], v[120:123]
    ds_read_b64_tr_b16 v[212:213], v6 offset:56320
    v_fmac_f32 v124, v77, v228
    v_mfma_f32_16x16x32_bf16 v[148:151], v[184:187], a[52:55], v[148:151]
    ds_read_b64_tr_b16 v[214:215], v6 offset:56832
    s_waitcnt vmcnt(11) lgkmcnt(6)
    v_mfma_f32_16x16x32_bf16 v[96:99], v[188:191], a[56:59], v[96:99]
    ds_read_b64_tr_b16 v[160:161], v2 offset:57344
    v_mfma_f32_16x16x32_bf16 v[124:127], v[188:191], a[60:63], v[124:127]
    ds_read_b64_tr_b16 v[162:163], v2 offset:60416
    buffer_load_dwordx4 a[100:103], v95, s[28:31], s93 offen offset:0 sc1
    v_mfma_f32_16x16x32_bf16 v[100:103], v[192:195], a[56:59], v[100:103]
    ds_read_b64_tr_b16 v[164:165], v4 offset:57344
    ds_read_b64_tr_b16 a[48:49], v84 offset:45056
    v_mfma_f32_16x16x32_bf16 v[128:131], v[192:195], a[60:63], v[128:131]
    ds_read_b64_tr_b16 v[166:167], v4 offset:60416
    ds_read_b64_tr_b16 a[50:51], v84 offset:48128
    v_mfma_f32_16x16x32_bf16 v[104:107], v[196:199], a[56:59], v[104:107]
    ds_read_b64_tr_b16 v[168:169], v2 offset:58368
    s_mov_b32 s77, 397312
    v_mfma_f32_16x16x32_bf16 v[132:135], v[196:199], a[60:63], v[132:135]
    ds_read_b64_tr_b16 v[170:171], v2 offset:61440
    buffer_load_dword v19, v14, s[20:23], s77 offen
    v_mfma_f32_16x16x32_bf16 v[108:111], v[200:203], a[56:59], v[108:111]
    ds_read_b64_tr_b16 v[172:173], v4 offset:58368
    ds_read_b64_tr_b16 a[52:53], v28 offset:28672
    v_fmac_f32 v100, v76, v232
    v_mfma_f32_16x16x32_bf16 v[136:139], v[200:203], a[60:63], v[136:139]
    ds_read_b64_tr_b16 v[174:175], v4 offset:61440
    v_fmac_f32 v101, v76, v233
    s_waitcnt lgkmcnt(11)
    v_mfma_f32_16x16x32_bf16 v[112:115], v[204:207], a[56:59], v[112:115]
    ds_read_b64_tr_b16 v[176:177], v2 offset:59392
    ds_read_b64_tr_b16 a[54:55], v28 offset:29184
    v_mfma_f32_16x16x32_bf16 v[140:143], v[204:207], a[60:63], v[140:143]
    ds_read_b64_tr_b16 v[178:179], v2 offset:62464
    v_fmac_f32 v125, v77, v229
    v_mfma_f32_16x16x32_bf16 v[116:119], v[208:211], a[56:59], v[116:119]
    ds_read_b64_tr_b16 v[180:181], v4 offset:59392
    buffer_load_dwordx4 a[104:107], v1, s[28:31], s93 offen offset:1024 sc1
    v_mfma_f32_16x16x32_bf16 v[144:147], v[208:211], a[60:63], v[144:147]
    ds_read_b64_tr_b16 v[182:183], v4 offset:62464
    v_fmac_f32 v126, v77, v230
    v_mfma_f32_16x16x32_bf16 v[120:123], v[212:215], a[56:59], v[120:123]
    ds_read_b64_tr_b16 v[184:185], v6 offset:63488
    v_fmac_f32 v127, v77, v231
    v_mfma_f32_16x16x32_bf16 v[148:151], v[212:215], a[60:63], v[148:151]
    ds_read_b64_tr_b16 v[186:187], v6 offset:64000
    s_waitcnt vmcnt(12) lgkmcnt(7)
    v_mfma_f32_16x16x32_bf16 v[96:99], v[160:163], a[64:67], v[96:99]
    ds_read_b64_tr_b16 v[188:189], v2 offset:64512
    s_barrier
    v_mfma_f32_16x16x32_bf16 v[124:127], v[160:163], a[68:71], v[124:127]
    ds_read_b64_tr_b16 v[190:191], v3 offset:2048
    buffer_load_dwordx4 a[108:111], v95, s[28:31], s93 offen offset:1024 sc1
    v_mfma_f32_16x16x32_bf16 v[100:103], v[164:167], a[64:67], v[100:103]
    ds_read_b64_tr_b16 v[192:193], v4 offset:64512
    ds_read_b64_tr_b16 a[56:57], v85 offset:0
    v_mfma_f32_16x16x32_bf16 v[128:131], v[164:167], a[68:71], v[128:131]
    ds_read_b64_tr_b16 v[194:195], v5 offset:2048
    ds_read_b64_tr_b16 a[58:59], v85 offset:3072
    v_mfma_f32_16x16x32_bf16 v[104:107], v[168:171], a[64:67], v[104:107]
    ds_read_b64_tr_b16 v[196:197], v3 offset:0
    ds_read_b64_tr_b16 a[60:61], v85 offset:1024
    v_mfma_f32_16x16x32_bf16 v[132:135], v[168:171], a[68:71], v[132:135]
    ds_read_b64_tr_b16 v[198:199], v3 offset:3072
    buffer_load_dwordx4 a[112:115], v1, s[28:31], s93 offen offset:2048 sc1
    v_mfma_f32_16x16x32_bf16 v[108:111], v[172:175], a[64:67], v[108:111]
    ds_read_b64_tr_b16 v[200:201], v5 offset:0
    ds_read_b64_tr_b16 a[62:63], v85 offset:4096
    v_mfma_f32_16x16x32_bf16 v[136:139], v[172:175], a[68:71], v[136:139]
    ds_read_b64_tr_b16 v[202:203], v5 offset:3072
    v_fmac_f32 v130, v77, v234
    s_waitcnt lgkmcnt(12)
    v_mfma_f32_16x16x32_bf16 v[112:115], v[176:179], a[64:67], v[112:115]
    ds_read_b64_tr_b16 v[204:205], v3 offset:1024
    v_fmac_f32 v102, v76, v234
    v_mfma_f32_16x16x32_bf16 v[140:143], v[176:179], a[68:71], v[140:143]
    ds_read_b64_tr_b16 v[206:207], v3 offset:4096
    v_fmac_f32 v103, v76, v235
    v_mfma_f32_16x16x32_bf16 v[116:119], v[180:183], a[64:67], v[116:119]
    ds_read_b64_tr_b16 v[208:209], v5 offset:1024
    buffer_load_dwordx4 a[116:119], v95, s[28:31], s93 offen offset:2048 sc1
    v_mfma_f32_16x16x32_bf16 v[144:147], v[180:183], a[68:71], v[144:147]
    ds_read_b64_tr_b16 v[210:211], v5 offset:4096
    v_fmac_f32 v128, v77, v232
    v_mfma_f32_16x16x32_bf16 v[120:123], v[184:187], a[64:67], v[120:123]
    ds_read_b64_tr_b16 v[212:213], v7 offset:5120
    v_fmac_f32 v129, v77, v233
    v_mfma_f32_16x16x32_bf16 v[148:151], v[184:187], a[68:71], v[148:151]
    ds_read_b64_tr_b16 v[214:215], v7 offset:5632
    s_waitcnt vmcnt(12) lgkmcnt(6)
    v_mfma_f32_16x16x32_bf16 v[96:99], v[188:191], a[72:75], v[96:99]
    ds_read_b64_tr_b16 v[160:161], v3 offset:6144
    v_fmac_f32 v107, v76, v239
    v_mfma_f32_16x16x32_bf16 v[124:127], v[188:191], a[76:79], v[124:127]
    ds_read_b64_tr_b16 v[162:163], v3 offset:9216
    buffer_load_dwordx4 a[120:123], v1, s[28:31], s93 offen offset:3072 sc1
    v_mfma_f32_16x16x32_bf16 v[100:103], v[192:195], a[72:75], v[100:103]
    ds_read_b64_tr_b16 v[164:165], v5 offset:6144
    ds_read_b64_tr_b16 a[64:65], v85 offset:2048
    v_mfma_f32_16x16x32_bf16 v[128:131], v[192:195], a[76:79], v[128:131]
    ds_read_b64_tr_b16 v[166:167], v5 offset:9216
    ds_read_b64_tr_b16 a[66:67], v85 offset:5120
    v_mfma_f32_16x16x32_bf16 v[104:107], v[196:199], a[72:75], v[104:107]
    ds_read_b64_tr_b16 v[168:169], v3 offset:7168
    ds_read_b64_tr_b16 a[68:69], v85 offset:14336
    v_mfma_f32_16x16x32_bf16 v[132:135], v[196:199], a[76:79], v[132:135]
    ds_read_b64_tr_b16 v[170:171], v3 offset:10240
    buffer_load_dwordx4 a[124:127], v95, s[28:31], s93 offen offset:3072 sc1
    v_mfma_f32_16x16x32_bf16 v[108:111], v[200:203], a[72:75], v[108:111]
    ds_read_b64_tr_b16 v[172:173], v5 offset:7168
    ds_read_b64_tr_b16 a[70:71], v85 offset:17408
    v_mfma_f32_16x16x32_bf16 v[136:139], v[200:203], a[76:79], v[136:139]
    ds_read_b64_tr_b16 v[174:175], v5 offset:10240
    s_waitcnt lgkmcnt(12)
    v_mfma_f32_16x16x32_bf16 v[112:115], v[204:207], a[72:75], v[112:115]
    ds_read_b64_tr_b16 v[176:177], v3 offset:8192
    v_fmac_f32 v131, v77, v235
    v_mfma_f32_16x16x32_bf16 v[140:143], v[204:207], a[76:79], v[140:143]
    ds_read_b64_tr_b16 v[178:179], v3 offset:11264
    v_fmac_f32 v104, v76, v236
    v_mfma_f32_16x16x32_bf16 v[116:119], v[208:211], a[72:75], v[116:119]
    ds_read_b64_tr_b16 v[180:181], v5 offset:8192
    buffer_load_dwordx4 v[224:227], v1, s[28:31], s101 offen sc1
    v_mfma_f32_16x16x32_bf16 v[144:147], v[208:211], a[76:79], v[144:147]
    ds_read_b64_tr_b16 v[182:183], v5 offset:11264
    v_fmac_f32 v105, v76, v237
    v_mfma_f32_16x16x32_bf16 v[120:123], v[212:215], a[72:75], v[120:123]
    ds_read_b64_tr_b16 v[184:185], v7 offset:12288
    v_fmac_f32 v106, v76, v238
    v_mfma_f32_16x16x32_bf16 v[148:151], v[212:215], a[76:79], v[148:151]
    ds_read_b64_tr_b16 v[186:187], v7 offset:12800
    s_waitcnt vmcnt(13) lgkmcnt(6)
    v_mfma_f32_16x16x32_bf16 v[96:99], v[160:163], a[80:83], v[96:99]
    ds_read_b64_tr_b16 v[188:189], v3 offset:13312
    s_add_u32 m0, s57, 114688
    v_mfma_f32_16x16x32_bf16 v[124:127], v[160:163], a[84:87], v[124:127]
    ds_read_b64_tr_b16 v[190:191], v3 offset:16384
    s_add_u32 s76, s55, 0
    buffer_load_dwordx4 v80, s[20:23], s76 offen lds
    v_mfma_f32_16x16x32_bf16 v[100:103], v[164:167], a[80:83], v[100:103]
    ds_read_b64_tr_b16 v[192:193], v5 offset:13312
    ds_read_b64_tr_b16 a[72:73], v85 offset:15360
    v_mfma_f32_16x16x32_bf16 v[128:131], v[164:167], a[84:87], v[128:131]
    ds_read_b64_tr_b16 v[194:195], v5 offset:16384
    ds_read_b64_tr_b16 a[74:75], v85 offset:18432
    v_mfma_f32_16x16x32_bf16 v[104:107], v[168:171], a[80:83], v[104:107]
    ds_read_b64_tr_b16 v[196:197], v3 offset:14336
    buffer_load_dwordx4 v81, s[20:23], s76 offen offset:1024 lds
    v_mfma_f32_16x16x32_bf16 v[132:135], v[168:171], a[84:87], v[132:135]
    ds_read_b64_tr_b16 v[198:199], v3 offset:17408
    ds_read_b64_tr_b16 a[76:77], v85 offset:16384
    v_mfma_f32_16x16x32_bf16 v[108:111], v[172:175], a[80:83], v[108:111]
    ds_read_b64_tr_b16 v[200:201], v5 offset:14336
    ds_read_b64_tr_b16 a[78:79], v85 offset:19456
    v_mfma_f32_16x16x32_bf16 v[136:139], v[172:175], a[84:87], v[136:139]
    ds_read_b64_tr_b16 v[202:203], v5 offset:17408
    s_waitcnt lgkmcnt(12)
    v_mfma_f32_16x16x32_bf16 v[112:115], v[176:179], a[80:83], v[112:115]
    ds_read_b64_tr_b16 v[204:205], v3 offset:15360
    buffer_load_dwordx4 v82, s[20:23], s76 offen offset:2048 lds
    v_mfma_f32_16x16x32_bf16 v[140:143], v[176:179], a[84:87], v[140:143]
    ds_read_b64_tr_b16 v[206:207], v3 offset:18432
    v_fmac_f32 v132, v77, v236
    v_fmac_f32 v135, v77, v239
    v_mfma_f32_16x16x32_bf16 v[116:119], v[180:183], a[80:83], v[116:119]
    ds_read_b64_tr_b16 v[208:209], v5 offset:15360
    v_fmac_f32 v133, v77, v237
    v_fmac_f32 v108, v76, v240
    v_mfma_f32_16x16x32_bf16 v[144:147], v[180:183], a[84:87], v[144:147]
    ds_read_b64_tr_b16 v[210:211], v5 offset:18432
    buffer_load_dwordx4 v83, s[20:23], s76 offen offset:3072 lds
    v_fmac_f32 v109, v76, v241
    v_mfma_f32_16x16x32_bf16 v[120:123], v[184:187], a[80:83], v[120:123]
    ds_read_b64_tr_b16 v[212:213], v7 offset:19456
    v_fmac_f32 v134, v77, v238
    v_mfma_f32_16x16x32_bf16 v[148:151], v[184:187], a[84:87], v[148:151]
    ds_read_b64_tr_b16 v[214:215], v7 offset:19968
    s_waitcnt vmcnt(14) lgkmcnt(6)
    v_mfma_f32_16x16x32_bf16 v[96:99], v[188:191], a[88:91], v[96:99]
    ds_read_b64_tr_b16 v[160:161], v3 offset:20480
    s_add_u32 m0, s57, 131072
    v_fmac_f32 v138, v77, v242
    v_mfma_f32_16x16x32_bf16 v[124:127], v[188:191], a[92:95], v[124:127]
    ds_read_b64_tr_b16 v[162:163], v3 offset:23552
    s_add_u32 s76, s55, 65536
    buffer_load_dwordx4 v80, s[20:23], s76 offen lds
    v_mfma_f32_16x16x32_bf16 v[100:103], v[192:195], a[88:91], v[100:103]
    ds_read_b64_tr_b16 v[164:165], v5 offset:20480
    ds_read_b64_tr_b16 a[80:81], v29 offset:0
    v_fmac_f32 v139, v77, v243
    v_mfma_f32_16x16x32_bf16 v[128:131], v[192:195], a[92:95], v[128:131]
    ds_read_b64_tr_b16 v[166:167], v5 offset:23552
    ds_read_b64_tr_b16 a[82:83], v29 offset:512
    v_mfma_f32_16x16x32_bf16 v[104:107], v[196:199], a[88:91], v[104:107]
    ds_read_b64_tr_b16 v[168:169], v3 offset:21504
    buffer_load_dwordx4 v81, s[20:23], s76 offen offset:1024 lds
    v_mfma_f32_16x16x32_bf16 v[132:135], v[196:199], a[92:95], v[132:135]
    ds_read_b64_tr_b16 v[170:171], v3 offset:24576
    ds_read_b64_tr_b16 a[84:85], v85 offset:28672
    v_mfma_f32_16x16x32_bf16 v[108:111], v[200:203], a[88:91], v[108:111]
    ds_read_b64_tr_b16 v[172:173], v5 offset:21504
    ds_read_b64_tr_b16 a[86:87], v85 offset:31744
    v_mfma_f32_16x16x32_bf16 v[136:139], v[200:203], a[92:95], v[136:139]
    ds_read_b64_tr_b16 v[174:175], v5 offset:24576
    s_waitcnt lgkmcnt(12)
    v_mfma_f32_16x16x32_bf16 v[112:115], v[204:207], a[88:91], v[112:115]
    ds_read_b64_tr_b16 v[176:177], v3 offset:27648
    buffer_load_dwordx4 v82, s[20:23], s76 offen offset:2048 lds
    v_mfma_f32_16x16x32_bf16 v[140:143], v[204:207], a[92:95], v[140:143]
    ds_read_b64_tr_b16 v[178:179], v3 offset:30720
    s_waitcnt vmcnt(7)
    v_add_f32 v224, v224, v226
    v_mfma_f32_16x16x32_bf16 v[116:119], v[208:211], a[88:91], v[116:119]
    ds_read_b64_tr_b16 v[180:181], v5 offset:27648
    v_fmac_f32 v110, v76, v242
    v_mfma_f32_16x16x32_bf16 v[144:147], v[208:211], a[92:95], v[144:147]
    ds_read_b64_tr_b16 v[182:183], v5 offset:30720
    buffer_load_dwordx4 v83, s[20:23], s76 offen offset:3072 lds
    v_fmac_f32 v136, v77, v240
    v_mfma_f32_16x16x32_bf16 v[120:123], v[212:215], a[88:91], v[120:123]
    ds_read_b64_tr_b16 v[184:185], v3 offset:28672
    v_fmac_f32 v111, v76, v243
    v_fmac_f32 v137, v77, v241
    v_mfma_f32_16x16x32_bf16 v[148:151], v[212:215], a[92:95], v[148:151]
    ds_read_b64_tr_b16 v[186:187], v3 offset:31744
    ds_read_b64_tr_b16 v[152:153], v5 offset:28672
    ds_read_b64_tr_b16 v[154:155], v5 offset:31744
    s_waitcnt lgkmcnt(8)
    v_mfma_f32_16x16x32_bf16 v[96:99], v[160:163], a[96:99], v[96:99]
    ds_read_b64_tr_b16 v[188:189], v3 offset:34816
    v_fmac_f32 v141, v77, v245
    s_barrier
    v_mfma_f32_16x16x32_bf16 v[124:127], v[160:163], a[100:103], v[124:127]
    ds_read_b64_tr_b16 v[190:191], v3 offset:37888
    s_add_u32 m0, s57, 0
    s_add_u32 s76, s55, 131072
    buffer_load_dwordx4 v80, s[20:23], s76 offen lds
    v_mfma_f32_16x16x32_bf16 v[100:103], v[164:167], a[96:99], v[100:103]
    ds_read_b64_tr_b16 v[192:193], v5 offset:34816
    ds_read_b64_tr_b16 a[88:89], v85 offset:29696
    v_fmac_f32 v142, v77, v246
    v_mfma_f32_16x16x32_bf16 v[128:131], v[164:167], a[100:103], v[128:131]
    ds_read_b64_tr_b16 v[194:195], v5 offset:37888
    ds_read_b64_tr_b16 a[90:91], v85 offset:32768
    v_fmac_f32 v143, v77, v247
    v_mfma_f32_16x16x32_bf16 v[104:107], v[168:171], a[96:99], v[104:107]
    ds_read_b64_tr_b16 v[196:197], v3 offset:35840
    buffer_load_dwordx4 v81, s[20:23], s76 offen offset:1024 lds
    v_fmac_f32 v116, v76, v248
    v_mfma_f32_16x16x32_bf16 v[132:135], v[168:171], a[100:103], v[132:135]
    ds_read_b64_tr_b16 v[198:199], v3 offset:38912
    ds_read_b64_tr_b16 a[92:93], v85 offset:30720
    v_fmac_f32 v117, v76, v249
    v_mfma_f32_16x16x32_bf16 v[108:111], v[172:175], a[96:99], v[108:111]
    ds_read_b64_tr_b16 v[200:201], v5 offset:35840
    ds_read_b64_tr_b16 a[94:95], v85 offset:33792
    v_fmac_f32 v118, v76, v250
    v_mfma_f32_16x16x32_bf16 v[136:139], v[172:175], a[100:103], v[136:139]
    ds_read_b64_tr_b16 v[202:203], v5 offset:38912
    v_fmac_f32 v119, v76, v251
    s_waitcnt lgkmcnt(12)
    v_mfma_f32_16x16x32_bf16 v[96:99], v[176:179], a[104:107], v[96:99]
    ds_read_b64_tr_b16 v[204:205], v3 offset:41984
    buffer_load_dwordx4 v82, s[20:23], s76 offen offset:2048 lds
    v_mfma_f32_16x16x32_bf16 v[124:127], v[176:179], a[108:111], v[124:127]
    ds_read_b64_tr_b16 v[206:207], v3 offset:45056
    v_fmac_f32 v112, v76, v244
    v_mfma_f32_16x16x32_bf16 v[100:103], v[180:183], a[104:107], v[100:103]
    ds_read_b64_tr_b16 v[208:209], v5 offset:41984
    v_fmac_f32 v113, v76, v245
    v_mfma_f32_16x16x32_bf16 v[128:131], v[180:183], a[108:111], v[128:131]
    ds_read_b64_tr_b16 v[210:211], v5 offset:45056
    buffer_load_dwordx4 v83, s[20:23], s76 offen offset:3072 lds
    v_mfma_f32_16x16x32_bf16 v[104:107], v[184:187], a[104:107], v[104:107]
    ds_read_b64_tr_b16 v[212:213], v3 offset:43008
    v_fmac_f32 v114, v76, v246
    v_mfma_f32_16x16x32_bf16 v[132:135], v[184:187], a[108:111], v[132:135]
    ds_read_b64_tr_b16 v[214:215], v3 offset:46080
    v_fmac_f32 v115, v76, v247
    v_mfma_f32_16x16x32_bf16 v[108:111], v[152:155], a[104:107], v[108:111]
    ds_read_b64_tr_b16 v[156:157], v5 offset:43008
    v_fmac_f32 v140, v77, v244
    v_mfma_f32_16x16x32_bf16 v[136:139], v[152:155], a[108:111], v[136:139]
    ds_read_b64_tr_b16 v[158:159], v5 offset:46080
    s_waitcnt lgkmcnt(8)
    v_mfma_f32_16x16x32_bf16 v[96:99], v[188:191], a[112:115], v[96:99]
    ds_read_b64_tr_b16 v[160:161], v3 offset:22528
    s_add_u32 m0, s57, 16384
    v_mfma_f32_16x16x32_bf16 v[124:127], v[188:191], a[116:119], v[124:127]
    ds_read_b64_tr_b16 v[162:163], v3 offset:25600
    s_add_u32 s76, s55, 196608
    buffer_load_dwordx4 v80, s[20:23], s76 offen lds
    v_mfma_f32_16x16x32_bf16 v[100:103], v[192:195], a[112:115], v[100:103]
    ds_read_b64_tr_b16 v[164:165], v5 offset:22528
    v_fmac_f32 v144, v77, v248
    v_mfma_f32_16x16x32_bf16 v[128:131], v[192:195], a[116:119], v[128:131]
    ds_read_b64_tr_b16 v[166:167], v5 offset:25600
    v_fmac_f32 v145, v77, v249
    v_mfma_f32_16x16x32_bf16 v[104:107], v[196:199], a[112:115], v[104:107]
    ds_read_b64_tr_b16 v[168:169], v7 offset:26624
    buffer_load_dwordx4 v81, s[20:23], s76 offen offset:1024 lds
    v_mfma_f32_16x16x32_bf16 v[132:135], v[196:199], a[116:119], v[132:135]
    ds_read_b64_tr_b16 v[170:171], v7 offset:27136
    v_fmac_f32 v146, v77, v250
    v_mfma_f32_16x16x32_bf16 v[108:111], v[200:203], a[112:115], v[108:111]
    ds_read_b64_tr_b16 v[172:173], v3 offset:29696
    v_fmac_f32 v147, v77, v251
    v_mfma_f32_16x16x32_bf16 v[136:139], v[200:203], a[116:119], v[136:139]
    ds_read_b64_tr_b16 v[174:175], v3 offset:32768
    s_waitcnt lgkmcnt(8)
    v_mfma_f32_16x16x32_bf16 v[96:99], v[204:207], a[120:123], v[96:99]
    ds_read_b64_tr_b16 v[176:177], v5 offset:29696
    buffer_load_dwordx4 v82, s[20:23], s76 offen offset:2048 lds
    v_mfma_f32_16x16x32_bf16 v[124:127], v[204:207], a[124:127], v[124:127]
    ds_read_b64_tr_b16 v[178:179], v5 offset:32768
    v_fmac_f32 v120, v76, v252
    v_mfma_f32_16x16x32_bf16 v[100:103], v[208:211], a[120:123], v[100:103]
    ds_read_b64_tr_b16 v[180:181], v7 offset:33792
    v_fmac_f32 v121, v76, v253
    v_mfma_f32_16x16x32_bf16 v[128:131], v[208:211], a[124:127], v[128:131]
    ds_read_b64_tr_b16 v[182:183], v7 offset:34304
    buffer_load_dwordx4 v83, s[20:23], s76 offen offset:3072 lds
    v_mfma_f32_16x16x32_bf16 v[104:107], v[212:215], a[120:123], v[104:107]
    v_fmac_f32 v122, v76, v254
    v_fmac_f32 v123, v76, v255
    v_mfma_f32_16x16x32_bf16 v[132:135], v[212:215], a[124:127], v[132:135]
    v_fmac_f32 v148, v77, v252
    v_fmac_f32 v149, v77, v253
    v_mfma_f32_16x16x32_bf16 v[108:111], v[156:159], a[120:123], v[108:111]
    v_fmac_f32 v150, v77, v254
    v_fmac_f32 v151, v77, v255
    v_mfma_f32_16x16x32_bf16 v[136:139], v[156:159], a[124:127], v[136:139]
    v_add_f32 v225, v225, v227
    s_add_u32 s100, s45, s60
    s_add_u32 s101, s100, 57344
    s_waitcnt lgkmcnt(6)
    v_mfma_f32_16x16x32_bf16 v[112:115], v[160:163], a[96:99], v[112:115]
    ds_read_b64_tr_b16 v[188:189], v3 offset:36864
    s_add_u32 m0, s57, 32768
    v_mfma_f32_16x16x32_bf16 v[140:143], v[160:163], a[100:103], v[140:143]
    ds_read_b64_tr_b16 v[190:191], v3 offset:39936
    s_add_u32 s76, s55, 262144
    buffer_load_dwordx4 v80, s[20:23], s76 offen lds
    v_mfma_f32_16x16x32_bf16 v[116:119], v[164:167], a[96:99], v[116:119]
    ds_read_b64_tr_b16 v[192:193], v5 offset:36864
    v_permlane16_swap_b32 v224, v225
    v_mfma_f32_16x16x32_bf16 v[144:147], v[164:167], a[100:103], v[144:147]
    ds_read_b64_tr_b16 v[194:195], v5 offset:39936
    v_add_f32 v224, v224, v225
    v_mfma_f32_16x16x32_bf16 v[120:123], v[168:171], a[96:99], v[120:123]
    ds_read_b64_tr_b16 v[196:197], v7 offset:40960
    buffer_load_dwordx4 v81, s[20:23], s76 offen offset:1024 lds
    v_mfma_f32_16x16x32_bf16 v[148:151], v[168:171], a[100:103], v[148:151]
    ds_read_b64_tr_b16 v[198:199], v7 offset:41472
    s_waitcnt lgkmcnt(6)
    v_mfma_f32_16x16x32_bf16 v[112:115], v[172:175], a[104:107], v[112:115]
    ds_read_b64_tr_b16 v[200:201], v3 offset:44032
    v_mov_b32 v225, v224
    v_mfma_f32_16x16x32_bf16 v[140:143], v[172:175], a[108:111], v[140:143]
    ds_read_b64_tr_b16 v[202:203], v3 offset:47104
    v_permlane32_swap_b32 v224, v225
    v_mfma_f32_16x16x32_bf16 v[116:119], v[176:179], a[104:107], v[116:119]
    ds_read_b64_tr_b16 v[204:205], v5 offset:44032
    buffer_load_dwordx4 v82, s[20:23], s76 offen offset:2048 lds
    v_mfma_f32_16x16x32_bf16 v[144:147], v[176:179], a[108:111], v[144:147]
    ds_read_b64_tr_b16 v[206:207], v5 offset:47104
    v_add_f32 v224, v224, v225
    v_mfma_f32_16x16x32_bf16 v[120:123], v[180:183], a[104:107], v[120:123]
    ds_read_b64_tr_b16 v[208:209], v7 offset:48128
    v_mov_b32 v225, v224
    v_mfma_f32_16x16x32_bf16 v[148:151], v[180:183], a[108:111], v[148:151]
    ds_read_b64_tr_b16 v[210:211], v7 offset:48640
    buffer_load_dwordx4 v83, s[20:23], s76 offen offset:3072 lds
    s_waitcnt lgkmcnt(6)
    v_mfma_f32_16x16x32_bf16 v[112:115], v[188:191], a[112:115], v[112:115]
    s_add_u32 m0, s57, 49152
    s_add_u32 s76, s55, 327680
    v_mfma_f32_16x16x32_bf16 v[140:143], v[188:191], a[116:119], v[140:143]
    buffer_load_dwordx4 v80, s[20:23], s76 offen lds
    ds_read_b64_tr_b16 a[96:97], v85 offset:43008
    v_mfma_f32_16x16x32_bf16 v[116:119], v[192:195], a[112:115], v[116:119]
    ds_read_b64_tr_b16 a[98:99], v85 offset:46080
    v_permlane16_swap_b32 v224, v225
    v_mfma_f32_16x16x32_bf16 v[144:147], v[192:195], a[116:119], v[144:147]
    ds_read_b64_tr_b16 a[100:101], v85 offset:44032
    v_mul_f32 v226, 0xbb000000, v224
    v_mfma_f32_16x16x32_bf16 v[120:123], v[196:199], a[112:115], v[120:123]
    buffer_load_dwordx4 v81, s[20:23], s76 offen offset:1024 lds
    ds_read_b64_tr_b16 a[102:103], v85 offset:47104
    v_mfma_f32_16x16x32_bf16 v[148:151], v[196:199], a[116:119], v[148:151]
    ds_read_b64_tr_b16 a[104:105], v85 offset:45056
    s_waitcnt lgkmcnt(5)
    v_mfma_f32_16x16x32_bf16 v[112:115], v[200:203], a[120:123], v[112:115]
    ds_read_b64_tr_b16 a[106:107], v85 offset:48128
    v_mul_f32 v225, s89, v225
    v_mfma_f32_16x16x32_bf16 v[140:143], v[200:203], a[124:127], v[140:143]
    ds_read_b64_tr_b16 a[108:109], v29 offset:28672
    v_fma_f32 v225, -v226, v226, v225
    v_mfma_f32_16x16x32_bf16 v[116:119], v[204:207], a[120:123], v[116:119]
    buffer_load_dwordx4 v82, s[20:23], s76 offen offset:2048 lds
    ds_read_b64_tr_b16 a[110:111], v29 offset:29184
    v_mfma_f32_16x16x32_bf16 v[144:147], v[204:207], a[124:127], v[144:147]
    v_max_f32 v225, 0, v225
    v_add_f32 v225, s88, v225
    v_mfma_f32_16x16x32_bf16 v[120:123], v[208:211], a[120:123], v[120:123]
    v_rsq_f32 v72, v225
    v_cvt_pk_bf16_f32 v228, v96, v97
    v_mfma_f32_16x16x32_bf16 v[148:151], v[208:211], a[124:127], v[148:151]
    buffer_load_dwordx4 v83, s[20:23], s76 offen offset:3072 lds
    v_cvt_pk_bf16_f32 v229, v98, v99
    v_pk_max_i16 v228, v228, 0
    v_pk_max_i16 v229, v229, 0
    v_cvt_pk_bf16_f32 v230, v100, v101
    v_cvt_pk_bf16_f32 v231, v102, v103
    v_pk_max_i16 v230, v230, 0
    v_pk_max_i16 v231, v231, 0
    v_cvt_pk_bf16_f32 v232, v104, v105
    v_cvt_pk_bf16_f32 v233, v106, v107
    v_pk_max_i16 v232, v232, 0
    v_pk_max_i16 v233, v233, 0
    v_cvt_pk_bf16_f32 v234, v108, v109
    v_cvt_pk_bf16_f32 v235, v110, v111
    v_pk_max_i16 v234, v234, 0
    v_pk_max_i16 v235, v235, 0
    v_cvt_pk_bf16_f32 v236, v124, v125
    v_cvt_pk_bf16_f32 v237, v126, v127
    v_pk_max_i16 v236, v236, 0
    v_pk_max_i16 v237, v237, 0
    v_cvt_pk_bf16_f32 v238, v128, v129
    v_cvt_pk_bf16_f32 v239, v130, v131
    v_pk_max_i16 v238, v238, 0
    v_pk_max_i16 v239, v239, 0
    v_cvt_pk_bf16_f32 v240, v132, v133
    v_cvt_pk_bf16_f32 v241, v134, v135
    v_pk_max_i16 v240, v240, 0
    v_pk_max_i16 v241, v241, 0
    v_cvt_pk_bf16_f32 v242, v136, v137
    v_cvt_pk_bf16_f32 v243, v138, v139
    v_pk_max_i16 v242, v242, 0
    v_pk_max_i16 v243, v243, 0
    buffer_store_dwordx4 v[228:231], v1, s[28:31], s100 offen offset:0 sc1
    buffer_store_dwordx4 v[232:235], v1, s[28:31], s100 offen offset:1024 sc1
    buffer_store_dwordx4 v[236:239], v1, s[28:31], s101 offen offset:0 sc1
    buffer_store_dwordx4 v[240:243], v1, s[28:31], s101 offen offset:1024 sc1
    s_waitcnt lgkmcnt(0)
    s_barrier
    s_add_u32 m0, s57, 65536
    s_add_u32 s76, s55, 393216
    buffer_load_dwordx4 v80, s[20:23], s76 offen lds
    s_add_u32 s70, s45, s61
    s_add_u32 s71, s70, 57344
    v_cvt_pk_bf16_f32 v192, v112, v113
    v_cvt_pk_bf16_f32 v193, v114, v115
    v_pk_max_i16 v192, v192, 0
    v_pk_max_i16 v193, v193, 0
    v_cvt_pk_bf16_f32 v194, v116, v117
    v_cvt_pk_bf16_f32 v195, v118, v119
    v_pk_max_i16 v194, v194, 0
    v_pk_max_i16 v195, v195, 0
    v_cvt_pk_bf16_f32 v196, v120, v121
    v_cvt_pk_bf16_f32 v197, v122, v123
    v_pk_max_i16 v196, v196, 0
    v_pk_max_i16 v197, v197, 0
    buffer_store_dwordx4 v[192:195], v1, s[28:31], s100 offen offset:2048 sc1
    buffer_store_dwordx2 v[196:197], v1, s[28:31], s70 offen sc1
    buffer_load_dwordx4 v81, s[20:23], s76 offen offset:1024 lds
    v_cvt_pk_bf16_f32 v208, v140, v141
    v_cvt_pk_bf16_f32 v209, v142, v143
    v_pk_max_i16 v208, v208, 0
    v_pk_max_i16 v209, v209, 0
    v_cvt_pk_bf16_f32 v210, v144, v145
    v_cvt_pk_bf16_f32 v211, v146, v147
    v_pk_max_i16 v210, v210, 0
    v_pk_max_i16 v211, v211, 0
    v_cvt_pk_bf16_f32 v212, v148, v149
    v_cvt_pk_bf16_f32 v213, v150, v151
    v_pk_max_i16 v212, v212, 0
    v_pk_max_i16 v213, v213, 0
    buffer_store_dwordx4 v[208:211], v1, s[28:31], s101 offen offset:2048 sc1
    buffer_store_dwordx2 v[212:213], v1, s[28:31], s71 offen sc1
    buffer_load_dwordx4 v82, s[20:23], s76 offen offset:2048 lds
    buffer_load_dwordx4 v83, s[20:23], s76 offen offset:3072 lds
    s_add_u32 m0, s57, 81920
    s_add_u32 s76, s55, 458752
    buffer_load_dwordx4 v80, s[20:23], s76 offen lds
    buffer_load_dwordx4 v81, s[20:23], s76 offen offset:1024 lds
    buffer_load_dwordx4 v82, s[20:23], s76 offen offset:2048 lds
    buffer_load_dwordx4 v83, s[20:23], s76 offen offset:3072 lds
    s_add_u32 m0, s57, 98304
    s_add_u32 s76, s55, 524288
    buffer_load_dwordx4 v80, s[20:23], s76 offen lds
    buffer_load_dwordx4 v81, s[20:23], s76 offen offset:1024 lds
    s_add_u32 s68, s39, 24
    v_mov_b32 v216, s68
    v_mov_b32 v217, s40
    s_waitcnt vmcnt(8)
    s_mov_b64 exec, 1
    s_cmp_lg_u32 s38, 0
    s_cbranch_scc1 ELSE_22014
    buffer_store_dwordx2 v[216:217], off, s[28:31], s41
    s_branch ENDIF_22015
ELSE_22014:
    buffer_store_dwordx2 v[216:217], off, s[28:31], s41 sc1
ENDIF_22015:
    s_mov_b64 exec, -1
    buffer_load_dwordx4 v82, s[20:23], s76 offen offset:2048 lds
    buffer_load_dwordx4 v83, s[20:23], s76 offen offset:3072 lds
    s_and_b32 s72, s36, 1
    s_mul_i32 s72, s72, 28672
    s_add_u32 s72, s72, s45
    s_mul_i32 s90, s62, 57344
    s_add_u32 s90, s90, s72
    s_xor_b32 s73, s62, 1
    s_mul_i32 s91, s73, 57344
    s_add_u32 s91, s91, s72
    s_add_u32 s45, s45, s47
    s_add_u32 s44, s44, s47
    s_add_u32 s46, s46, 0x20000
    s_add_u32 s100, s44, s98
    s_add_u32 s101, s46, s99
    s_and_b32 s68, s36, 1
    s_lshr_b32 s69, s36, 1
    s_mul_i32 s69, s69, 6144
    s_lshl_b32 s68, s68, 10
    s_add_u32 s68, s68, s69
    v_add_u32 v84, s68, v1
    v_add_u32 v85, 49152, v84
    v_add_u32 v222, 24, v20
    s_mov_b32 s80, 0
    s_mov_b64 exec, s[0:1]
    buffer_load_dwordx2 v[152:153], v22, s[28:31], 0 offen sc1
    s_waitcnt vmcnt(0)
    s_nop 0
POLL_22017:
    buffer_load_dwordx2 v[154:155], v22, s[28:31], 0 offen sc1
    s_waitcnt vmcnt(1)
    v_sub_u32 v152, v152, v222
    v_cmp_eq_u32_e64 s[82:83], v153, v21
    v_cmp_gt_u32 vcc, 104, v152
    s_nop 1
    s_and_b64 vcc, vcc, s[82:83]
    s_cmp_eq_u64 vcc, exec
    s_cbranch_scc1 PDONE_22016
    buffer_load_dwordx2 v[152:153], v22, s[28:31], 0 offen sc1
    s_waitcnt vmcnt(1)
    v_sub_u32 v154, v154, v222
    v_cmp_eq_u32_e64 s[82:83], v155, v21
    v_cmp_gt_u32 vcc, 104, v154
    s_nop 1
    s_and_b64 vcc, vcc, s[82:83]
    s_cmp_eq_u64 vcc, exec
    s_cbranch_scc1 PDONE_22016
    s_add_u32 s80, s80, 1
    s_cmp_lt_u32 s80, 0x20000
    s_cbranch_scc1 POLL_22017
    s_branch L_END
PDONE_22016:
    s_mov_b64 exec, -1
    buffer_load_dwordx4 a[116:119], v1, s[28:31], s91 offen offset:0 sc1
    buffer_load_dwordx4 a[112:115], v1, s[28:31], s90 offen offset:0 sc1
    buffer_load_dwordx4 a[124:127], v1, s[28:31], s91 offen offset:1024 sc1
    buffer_load_dwordx4 a[120:123], v1, s[28:31], s90 offen offset:1024 sc1
    s_barrier
    ds_read_b64_tr_b16 v[160:161], v9 offset:49152
    ds_read_b64_tr_b16 v[162:163], v9 offset:57344
    ds_read_b64_tr_b16 v[164:165], v12 offset:49152
    ds_read_b64_tr_b16 v[166:167], v12 offset:57344
    ds_read_b64_tr_b16 v[168:169], v9 offset:50176
    ds_read_b64_tr_b16 v[170:171], v9 offset:58368
    ds_read_b64_tr_b16 v[172:173], v12 offset:50176
    ds_read_b64_tr_b16 v[174:175], v12 offset:58368
    buffer_load_dwordx4 a[228:231], v1, s[28:31], s91 offen offset:2048 sc1
    buffer_load_dwordx4 a[224:227], v1, s[28:31], s90 offen offset:2048 sc1
    ds_read_b64_tr_b16 v[176:177], v9 offset:51200
    ds_read_b64_tr_b16 v[178:179], v9 offset:59392
    ds_read_b64_tr_b16 v[180:181], v12 offset:51200
    ds_read_b64_tr_b16 v[182:183], v12 offset:59392
    ds_read_b64_tr_b16 v[184:185], v9 offset:52224
    ds_read_b64_tr_b16 v[186:187], v9 offset:60416
    ds_read_b64_tr_b16 v[188:189], v12 offset:52224
    ds_read_b64_tr_b16 v[190:191], v12 offset:60416
    buffer_load_dwordx4 a[236:239], v1, s[28:31], s91 offen offset:3072 sc1
    buffer_load_dwordx4 a[232:235], v1, s[28:31], s90 offen offset:3072 sc1
    s_waitcnt vmcnt(6) lgkmcnt(8)
    v_mfma_f32_16x16x32_bf16 v[112:115], v[160:163], a[116:119], 0
    ds_read_b64_tr_b16 v[192:193], v10 offset:0
    s_add_u32 s91, s91, 4096
    buffer_load_dwordx4 a[244:247], v1, s[28:31], s91 offen offset:0 sc1
    v_mfma_f32_16x16x32_bf16 v[116:119], v[164:167], a[116:119], 0
    ds_read_b64_tr_b16 v[194:195], v10 offset:8192
    s_add_u32 s90, s90, 4096
    v_mfma_f32_16x16x32_bf16 v[120:123], v[168:171], a[116:119], 0
    ds_read_b64_tr_b16 v[196:197], v13 offset:0
    buffer_load_dwordx4 a[240:243], v1, s[28:31], s90 offen offset:0 sc1
    v_mfma_f32_16x16x32_bf16 v[124:127], v[172:175], a[116:119], 0
    ds_read_b64_tr_b16 v[198:199], v13 offset:8192
    v_mfma_f32_16x16x32_bf16 v[96:99], v[160:163], a[112:115], 0
    ds_read_b64_tr_b16 v[200:201], v10 offset:1024
    buffer_load_dwordx4 a[252:255], v1, s[28:31], s91 offen offset:1024 sc1
    v_mfma_f32_16x16x32_bf16 v[100:103], v[164:167], a[112:115], 0
    ds_read_b64_tr_b16 v[202:203], v10 offset:9216
    v_mfma_f32_16x16x32_bf16 v[104:107], v[168:171], a[112:115], 0
    ds_read_b64_tr_b16 v[204:205], v13 offset:1024
    buffer_load_dwordx4 a[248:251], v1, s[28:31], s90 offen offset:1024 sc1
    v_mfma_f32_16x16x32_bf16 v[108:111], v[172:175], a[112:115], 0
    ds_read_b64_tr_b16 v[206:207], v13 offset:9216
    s_waitcnt vmcnt(8) lgkmcnt(8)
    v_mfma_f32_16x16x32_bf16 v[112:115], v[176:179], a[124:127], v[112:115]
    ds_read_b64_tr_b16 v[224:225], v10 offset:2048
    buffer_load_dwordx4 v[244:247], v1, s[28:31], s91 offen offset:2048 sc1
    v_mfma_f32_16x16x32_bf16 v[116:119], v[180:183], a[124:127], v[116:119]
    ds_read_b64_tr_b16 v[226:227], v10 offset:10240
    v_mfma_f32_16x16x32_bf16 v[120:123], v[184:187], a[124:127], v[120:123]
    ds_read_b64_tr_b16 v[228:229], v13 offset:2048
    buffer_load_dwordx4 v[240:243], v1, s[28:31], s90 offen offset:2048 sc1
    v_mfma_f32_16x16x32_bf16 v[124:127], v[188:191], a[124:127], v[124:127]
    ds_read_b64_tr_b16 v[230:231], v13 offset:10240
    v_mfma_f32_16x16x32_bf16 v[96:99], v[176:179], a[120:123], v[96:99]
    ds_read_b64_tr_b16 v[232:233], v10 offset:3072
    buffer_load_dwordx4 v[252:255], v1, s[28:31], s91 offen offset:3072 sc1
    v_mfma_f32_16x16x32_bf16 v[100:103], v[180:183], a[120:123], v[100:103]
    ds_read_b64_tr_b16 v[234:235], v10 offset:11264
    v_mfma_f32_16x16x32_bf16 v[104:107], v[184:187], a[120:123], v[104:107]
    ds_read_b64_tr_b16 v[236:237], v13 offset:3072
    buffer_load_dwordx4 v[248:251], v1, s[28:31], s90 offen offset:3072 sc1
    v_mfma_f32_16x16x32_bf16 v[108:111], v[188:191], a[120:123], v[108:111]
    ds_read_b64_tr_b16 v[238:239], v13 offset:11264
    s_waitcnt vmcnt(10) lgkmcnt(8)
    v_mfma_f32_16x16x32_bf16 v[112:115], v[192:195], a[228:231], v[112:115]
    ds_read_b64_tr_b16 v[160:161], v8 offset:0
    s_add_u32 s91, s91, 4096
    buffer_load_dwordx4 v[132:135], v1, s[28:31], s91 offen offset:0 sc1
    v_mfma_f32_16x16x32_bf16 v[116:119], v[196:199], a[228:231], v[116:119]
    ds_read_b64_tr_b16 v[162:163], v8 offset:8192
    s_add_u32 s90, s90, 4096
    v_mfma_f32_16x16x32_bf16 v[120:123], v[200:203], a[228:231], v[120:123]
    ds_read_b64_tr_b16 v[164:165], v11 offset:0
    buffer_load_dwordx4 v[128:131], v1, s[28:31], s90 offen offset:0 sc1
    v_mfma_f32_16x16x32_bf16 v[124:127], v[204:207], a[228:231], v[124:127]
    ds_read_b64_tr_b16 v[166:167], v11 offset:8192
    v_mfma_f32_16x16x32_bf16 v[96:99], v[192:195], a[224:227], v[96:99]
    ds_read_b64_tr_b16 v[168:169], v8 offset:1024
    buffer_load_dwordx4 v[140:143], v1, s[28:31], s91 offen offset:1024 sc1
    v_mfma_f32_16x16x32_bf16 v[100:103], v[196:199], a[224:227], v[100:103]
    ds_read_b64_tr_b16 v[170:171], v8 offset:9216
    v_mfma_f32_16x16x32_bf16 v[104:107], v[200:203], a[224:227], v[104:107]
    ds_read_b64_tr_b16 v[172:173], v11 offset:1024
    buffer_load_dwordx4 v[136:139], v1, s[28:31], s90 offen offset:1024 sc1
    v_mfma_f32_16x16x32_bf16 v[108:111], v[204:207], a[224:227], v[108:111]
    ds_read_b64_tr_b16 v[174:175], v11 offset:9216
    s_waitcnt vmcnt(12) lgkmcnt(8)
    v_mfma_f32_16x16x32_bf16 v[112:115], v[224:227], a[236:239], v[112:115]
    ds_read_b64_tr_b16 v[176:177], v8 offset:2048
    buffer_load_dwordx4 v[148:151], v1, s[28:31], s91 offen offset:2048 sc1
    v_mfma_f32_16x16x32_bf16 v[116:119], v[228:231], a[236:239], v[116:119]
    ds_read_b64_tr_b16 v[178:179], v8 offset:10240
    v_mfma_f32_16x16x32_bf16 v[120:123], v[232:235], a[236:239], v[120:123]
    ds_read_b64_tr_b16 v[180:181], v11 offset:2048
    buffer_load_dwordx4 v[144:147], v1, s[28:31], s90 offen offset:2048 sc1
    v_mfma_f32_16x16x32_bf16 v[124:127], v[236:239], a[236:239], v[124:127]
    ds_read_b64_tr_b16 v[182:183], v11 offset:10240
    v_mfma_f32_16x16x32_bf16 v[96:99], v[224:227], a[232:235], v[96:99]
    ds_read_b64_tr_b16 v[184:185], v8 offset:3072
    s_mov_b32 s77, 528384
    v_mfma_f32_16x16x32_bf16 v[100:103], v[228:231], a[232:235], v[100:103]
    ds_read_b64_tr_b16 v[186:187], v8 offset:11264
    buffer_load_dword v19, v14, s[20:23], s77 offen
    v_mfma_f32_16x16x32_bf16 v[104:107], v[232:235], a[232:235], v[104:107]
    ds_read_b64_tr_b16 v[188:189], v11 offset:3072
    v_mfma_f32_16x16x32_bf16 v[108:111], v[236:239], a[232:235], v[108:111]
    ds_read_b64_tr_b16 v[190:191], v11 offset:11264
    s_waitcnt vmcnt(13) lgkmcnt(8)
    v_mfma_f32_16x16x32_bf16 v[112:115], v[160:163], a[244:247], v[112:115]
    ds_read_b64_tr_b16 v[192:193], v8 offset:16384
    buffer_load_dwordx4 v[156:159], v1, s[28:31], s91 offen offset:3072 sc1
    v_mfma_f32_16x16x32_bf16 v[116:119], v[164:167], a[244:247], v[116:119]
    ds_read_b64_tr_b16 v[194:195], v8 offset:24576
    v_mfma_f32_16x16x32_bf16 v[120:123], v[168:171], a[244:247], v[120:123]
    ds_read_b64_tr_b16 v[196:197], v11 offset:16384
    v_mfma_f32_16x16x32_bf16 v[124:127], v[172:175], a[244:247], v[124:127]
    ds_read_b64_tr_b16 v[198:199], v11 offset:24576
    v_mfma_f32_16x16x32_bf16 v[96:99], v[160:163], a[240:243], v[96:99]
    ds_read_b64_tr_b16 v[200:201], v8 offset:17408
    buffer_load_dwordx4 v[152:155], v1, s[28:31], s90 offen offset:3072 sc1
    v_mfma_f32_16x16x32_bf16 v[100:103], v[164:167], a[240:243], v[100:103]
    ds_read_b64_tr_b16 v[202:203], v8 offset:25600
    v_mfma_f32_16x16x32_bf16 v[104:107], v[168:171], a[240:243], v[104:107]
    ds_read_b64_tr_b16 v[204:205], v11 offset:17408
    v_mfma_f32_16x16x32_bf16 v[108:111], v[172:175], a[240:243], v[108:111]
    ds_read_b64_tr_b16 v[206:207], v11 offset:25600
    s_waitcnt vmcnt(13) lgkmcnt(8)
    s_barrier
    v_mfma_f32_16x16x32_bf16 v[112:115], v[176:179], a[252:255], v[112:115]
    ds_read_b64_tr_b16 v[224:225], v8 offset:18432
    s_add_u32 s91, s91, 4096
    buffer_load_dwordx4 a[116:119], v1, s[28:31], s91 offen offset:0 sc1
    v_mfma_f32_16x16x32_bf16 v[116:119], v[180:183], a[252:255], v[116:119]
    ds_read_b64_tr_b16 v[226:227], v8 offset:26624
    s_add_u32 s90, s90, 4096
    v_mfma_f32_16x16x32_bf16 v[120:123], v[184:187], a[252:255], v[120:123]
    ds_read_b64_tr_b16 v[228:229], v11 offset:18432
    buffer_load_dwordx4 a[112:115], v1, s[28:31], s90 offen offset:0 sc1
    v_mfma_f32_16x16x32_bf16 v[124:127], v[188:191], a[252:255], v[124:127]
    ds_read_b64_tr_b16 v[230:231], v11 offset:26624
    s_add_u32 m0, s57, 114688
    v_mfma_f32_16x16x32_bf16 v[96:99], v[176:179], a[248:251], v[96:99]
    ds_read_b64_tr_b16 v[232:233], v8 offset:19456
    s_add_u32 s76, s55, 589824
    buffer_load_dwordx4 v80, s[20:23], s76 offen lds
    v_mfma_f32_16x16x32_bf16 v[100:103], v[180:183], a[248:251], v[100:103]
    ds_read_b64_tr_b16 v[234:235], v8 offset:27648
    v_mfma_f32_16x16x32_bf16 v[104:107], v[184:187], a[248:251], v[104:107]
    ds_read_b64_tr_b16 v[236:237], v11 offset:19456
    buffer_load_dwordx4 v81, s[20:23], s76 offen offset:1024 lds
    v_mfma_f32_16x16x32_bf16 v[108:111], v[188:191], a[248:251], v[108:111]
    ds_read_b64_tr_b16 v[238:239], v11 offset:27648
    s_waitcnt vmcnt(15) lgkmcnt(8)
    v_mfma_f32_16x16x32_bf16 v[112:115], v[192:195], v[244:247], v[112:115]
    ds_read_b64_tr_b16 v[160:161], v8 offset:32768
    buffer_load_dwordx4 a[124:127], v1, s[28:31], s91 offen offset:1024 sc1
    v_mfma_f32_16x16x32_bf16 v[116:119], v[196:199], v[244:247], v[116:119]
    ds_read_b64_tr_b16 v[162:163], v8 offset:40960
    v_mfma_f32_16x16x32_bf16 v[120:123], v[200:203], v[244:247], v[120:123]
    ds_read_b64_tr_b16 v[164:165], v11 offset:32768
    buffer_load_dwordx4 a[120:123], v1, s[28:31], s90 offen offset:1024 sc1
    v_mfma_f32_16x16x32_bf16 v[124:127], v[204:207], v[244:247], v[124:127]
    ds_read_b64_tr_b16 v[166:167], v11 offset:40960
    v_mfma_f32_16x16x32_bf16 v[96:99], v[192:195], v[240:243], v[96:99]
    ds_read_b64_tr_b16 v[168:169], v8 offset:33792
    buffer_load_dwordx4 v82, s[20:23], s76 offen offset:2048 lds
    v_mfma_f32_16x16x32_bf16 v[100:103], v[196:199], v[240:243], v[100:103]
    ds_read_b64_tr_b16 v[170:171], v8 offset:41984
    v_mfma_f32_16x16x32_bf16 v[104:107], v[200:203], v[240:243], v[104:107]
    ds_read_b64_tr_b16 v[172:173], v11 offset:33792
    buffer_load_dwordx4 v83, s[20:23], s76 offen offset:3072 lds
    v_mfma_f32_16x16x32_bf16 v[108:111], v[204:207], v[240:243], v[108:111]
    ds_read_b64_tr_b16 v[174:175], v11 offset:41984
    s_waitcnt vmcnt(17) lgkmcnt(8)
    v_mfma_f32_16x16x32_bf16 v[112:115], v[224:227], v[252:255], v[112:115]
    ds_read_b64_tr_b16 v[176:177], v8 offset:34816
    buffer_load_dwordx4 a[228:231], v1, s[28:31], s91 offen offset:2048 sc1
    v_mfma_f32_16x16x32_bf16 v[116:119], v[228:231], v[252:255], v[116:119]
    ds_read_b64_tr_b16 v[178:179], v8 offset:43008
    buffer_load_dwordx4 a[224:227], v1, s[28:31], s90 offen offset:2048 sc1
    v_mfma_f32_16x16x32_bf16 v[120:123], v[232:235], v[252:255], v[120:123]
    ds_read_b64_tr_b16 v[180:181], v11 offset:34816
    s_add_u32 m0, s57, 131072
    v_mfma_f32_16x16x32_bf16 v[124:127], v[236:239], v[252:255], v[124:127]
    ds_read_b64_tr_b16 v[182:183], v11 offset:43008
    s_add_u32 s76, s55, 655360
    buffer_load_dwordx4 v80, s[20:23], s76 offen lds
    v_mfma_f32_16x16x32_bf16 v[96:99], v[224:227], v[248:251], v[96:99]
    ds_read_b64_tr_b16 v[184:185], v8 offset:35840
    buffer_load_dwordx4 v81, s[20:23], s76 offen offset:1024 lds
    v_mfma_f32_16x16x32_bf16 v[100:103], v[228:231], v[248:251], v[100:103]
    ds_read_b64_tr_b16 v[186:187], v8 offset:44032
    s_mov_b32 s77, 659456
    v_mfma_f32_16x16x32_bf16 v[104:107], v[232:235], v[248:251], v[104:107]
    ds_read_b64_tr_b16 v[188:189], v11 offset:35840
    buffer_load_dword v19, v14, s[20:23], s77 offen
    v_mfma_f32_16x16x32_bf16 v[108:111], v[236:239], v[248:251], v[108:111]
    ds_read_b64_tr_b16 v[190:191], v11 offset:44032
    s_waitcnt vmcnt(20) lgkmcnt(8)
    v_mfma_f32_16x16x32_bf16 v[112:115], v[160:163], v[132:135], v[112:115]
    ds_read_b64_tr_b16 v[192:193], v8 offset:49152
    buffer_load_dwordx4 a[236:239], v1, s[28:31], s91 offen offset:3072 sc1
    v_mfma_f32_16x16x32_bf16 v[116:119], v[164:167], v[132:135], v[116:119]
    ds_read_b64_tr_b16 v[194:195], v8 offset:57344
    v_mfma_f32_16x16x32_bf16 v[120:123], v[168:171], v[132:135], v[120:123]
    ds_read_b64_tr_b16 v[196:197], v11 offset:49152
    buffer_load_dwordx4 a[232:235], v1, s[28:31], s90 offen offset:3072 sc1
    v_mfma_f32_16x16x32_bf16 v[124:127], v[172:175], v[132:135], v[124:127]
    ds_read_b64_tr_b16 v[198:199], v11 offset:57344
    v_mfma_f32_16x16x32_bf16 v[96:99], v[160:163], v[128:131], v[96:99]
    ds_read_b64_tr_b16 v[200:201], v8 offset:50176
    buffer_load_dwordx4 v82, s[20:23], s76 offen offset:2048 lds
    v_mfma_f32_16x16x32_bf16 v[100:103], v[164:167], v[128:131], v[100:103]
    ds_read_b64_tr_b16 v[202:203], v8 offset:58368
    v_mfma_f32_16x16x32_bf16 v[104:107], v[168:171], v[128:131], v[104:107]
    ds_read_b64_tr_b16 v[204:205], v11 offset:50176
    buffer_load_dwordx4 v83, s[20:23], s76 offen offset:3072 lds
    v_mfma_f32_16x16x32_bf16 v[108:111], v[172:175], v[128:131], v[108:111]
    ds_read_b64_tr_b16 v[206:207], v11 offset:58368
    s_waitcnt vmcnt(22) lgkmcnt(8)
    v_mfma_f32_16x16x32_bf16 v[112:115], v[176:179], v[140:143], v[112:115]
    ds_read_b64_tr_b16 v[224:225], v8 offset:51200
    s_add_u32 s91, s91, 4096
    buffer_load_dwordx4 a[244:247], v1, s[28:31], s91 offen offset:0 sc1
    v_mfma_f32_16x16x32_bf16 v[116:119], v[180:183], v[140:143], v[116:119]
    ds_read_b64_tr_b16 v[226:227], v8 offset:59392
    v_mfma_f32_16x16x32_bf16 v[120:123], v[184:187], v[140:143], v[120:123]
    ds_read_b64_tr_b16 v[228:229], v11 offset:51200
    v_mfma_f32_16x16x32_bf16 v[124:127], v[188:191], v[140:143], v[124:127]
    ds_read_b64_tr_b16 v[230:231], v11 offset:59392
    s_add_u32 s90, s90, 4096
    v_mfma_f32_16x16x32_bf16 v[96:99], v[176:179], v[136:139], v[96:99]
    ds_read_b64_tr_b16 v[232:233], v8 offset:52224
    buffer_load_dwordx4 a[240:243], v1, s[28:31], s90 offen offset:0 sc1
    v_mfma_f32_16x16x32_bf16 v[100:103], v[180:183], v[136:139], v[100:103]
    ds_read_b64_tr_b16 v[234:235], v8 offset:60416
    v_mfma_f32_16x16x32_bf16 v[104:107], v[184:187], v[136:139], v[104:107]
    ds_read_b64_tr_b16 v[236:237], v11 offset:52224
    v_mfma_f32_16x16x32_bf16 v[108:111], v[188:191], v[136:139], v[108:111]
    ds_read_b64_tr_b16 v[238:239], v11 offset:60416
    s_waitcnt vmcnt(22) lgkmcnt(8)
    v_mfma_f32_16x16x32_bf16 v[112:115], v[192:195], v[148:151], v[112:115]
    ds_read_b64_tr_b16 v[160:161], v9 offset:0
    buffer_load_dwordx4 a[252:255], v1, s[28:31], s91 offen offset:1024 sc1
    v_mfma_f32_16x16x32_bf16 v[116:119], v[196:199], v[148:151], v[116:119]
    ds_read_b64_tr_b16 v[162:163], v9 offset:8192
    v_mfma_f32_16x16x32_bf16 v[120:123], v[200:203], v[148:151], v[120:123]
    ds_read_b64_tr_b16 v[164:165], v12 offset:0
    v_mfma_f32_16x16x32_bf16 v[124:127], v[204:207], v[148:151], v[124:127]
    ds_read_b64_tr_b16 v[166:167], v12 offset:8192
    v_mfma_f32_16x16x32_bf16 v[96:99], v[192:195], v[144:147], v[96:99]
    ds_read_b64_tr_b16 v[168:169], v9 offset:1024
    buffer_load_dwordx4 a[248:251], v1, s[28:31], s90 offen offset:1024 sc1
    v_mfma_f32_16x16x32_bf16 v[100:103], v[196:199], v[144:147], v[100:103]
    ds_read_b64_tr_b16 v[170:171], v9 offset:9216
    v_mfma_f32_16x16x32_bf16 v[104:107], v[200:203], v[144:147], v[104:107]
    ds_read_b64_tr_b16 v[172:173], v12 offset:1024
    v_mfma_f32_16x16x32_bf16 v[108:111], v[204:207], v[144:147], v[108:111]
    ds_read_b64_tr_b16 v[174:175], v12 offset:9216
    s_waitcnt vmcnt(21) lgkmcnt(8)
    s_barrier
    v_mfma_f32_16x16x32_bf16 v[112:115], v[224:227], v[156:159], v[112:115]
    ds_read_b64_tr_b16 v[176:177], v9 offset:2048
    buffer_load_dwordx4 v[244:247], v1, s[28:31], s91 offen offset:2048 sc1
    v_mfma_f32_16x16x32_bf16 v[116:119], v[228:231], v[156:159], v[116:119]
    ds_read_b64_tr_b16 v[178:179], v9 offset:10240
    buffer_load_dwordx4 v[240:243], v1, s[28:31], s90 offen offset:2048 sc1
    v_mfma_f32_16x16x32_bf16 v[120:123], v[232:235], v[156:159], v[120:123]
    ds_read_b64_tr_b16 v[180:181], v12 offset:2048
    s_add_u32 m0, s57, 0
    v_mfma_f32_16x16x32_bf16 v[124:127], v[236:239], v[156:159], v[124:127]
    ds_read_b64_tr_b16 v[182:183], v12 offset:10240
    s_add_u32 s76, s55, 720896
    buffer_load_dwordx4 v80, s[20:23], s76 offen lds
    v_mfma_f32_16x16x32_bf16 v[96:99], v[224:227], v[152:155], v[96:99]
    ds_read_b64_tr_b16 v[184:185], v9 offset:3072
    buffer_load_dwordx4 v81, s[20:23], s76 offen offset:1024 lds
    v_mfma_f32_16x16x32_bf16 v[100:103], v[228:231], v[152:155], v[100:103]
    ds_read_b64_tr_b16 v[186:187], v9 offset:11264
    s_mov_b32 s77, 790528
    v_mfma_f32_16x16x32_bf16 v[104:107], v[232:235], v[152:155], v[104:107]
    ds_read_b64_tr_b16 v[188:189], v12 offset:3072
    buffer_load_dword v19, v14, s[20:23], s77 offen
    v_mfma_f32_16x16x32_bf16 v[108:111], v[236:239], v[152:155], v[108:111]
    ds_read_b64_tr_b16 v[190:191], v12 offset:11264
    s_waitcnt vmcnt(24) lgkmcnt(8)
    v_mfma_f32_16x16x32_bf16 v[112:115], v[160:163], a[116:119], v[112:115]
    ds_read_b64_tr_b16 v[192:193], v9 offset:16384
    buffer_load_dwordx4 v[252:255], v1, s[28:31], s91 offen offset:3072 sc1
    v_mfma_f32_16x16x32_bf16 v[116:119], v[164:167], a[116:119], v[116:119]
    ds_read_b64_tr_b16 v[194:195], v9 offset:24576
    v_mfma_f32_16x16x32_bf16 v[120:123], v[168:171], a[116:119], v[120:123]
    ds_read_b64_tr_b16 v[196:197], v12 offset:16384
    buffer_load_dwordx4 v[248:251], v1, s[28:31], s90 offen offset:3072 sc1
    v_mfma_f32_16x16x32_bf16 v[124:127], v[172:175], a[116:119], v[124:127]
    ds_read_b64_tr_b16 v[198:199], v12 offset:24576
    v_mfma_f32_16x16x32_bf16 v[96:99], v[160:163], a[112:115], v[96:99]
    ds_read_b64_tr_b16 v[200:201], v9 offset:17408
    buffer_load_dwordx4 v82, s[20:23], s76 offen offset:2048 lds
    v_mfma_f32_16x16x32_bf16 v[100:103], v[164:167], a[112:115], v[100:103]
    ds_read_b64_tr_b16 v[202:203], v9 offset:25600
    v_mfma_f32_16x16x32_bf16 v[104:107], v[168:171], a[112:115], v[104:107]
    ds_read_b64_tr_b16 v[204:205], v12 offset:17408
    buffer_load_dwordx4 v83, s[20:23], s76 offen offset:3072 lds
    v_mfma_f32_16x16x32_bf16 v[108:111], v[172:175], a[112:115], v[108:111]
    ds_read_b64_tr_b16 v[206:207], v12 offset:25600
    s_waitcnt vmcnt(24) lgkmcnt(8)
    v_mfma_f32_16x16x32_bf16 v[112:115], v[176:179], a[124:127], v[112:115]
    ds_read_b64_tr_b16 v[224:225], v9 offset:18432
    s_add_u32 s91, s91, 4096
    buffer_load_dwordx4 v[132:135], v1, s[28:31], s91 offen offset:0 sc1
    v_mfma_f32_16x16x32_bf16 v[116:119], v[180:183], a[124:127], v[116:119]
    ds_read_b64_tr_b16 v[226:227], v9 offset:26624
    s_add_u32 s90, s90, 4096
    v_mfma_f32_16x16x32_bf16 v[120:123], v[184:187], a[124:127], v[120:123]
    ds_read_b64_tr_b16 v[228:229], v12 offset:18432
    buffer_load_dwordx4 v[128:131], v1, s[28:31], s90 offen offset:0 sc1
    v_mfma_f32_16x16x32_bf16 v[124:127], v[188:191], a[124:127], v[124:127]
    ds_read_b64_tr_b16 v[230:231], v12 offset:26624
    s_add_u32 m0, s57, 16384
    v_mfma_f32_16x16x32_bf16 v[96:99], v[176:179], a[120:123], v[96:99]
    ds_read_b64_tr_b16 v[232:233], v9 offset:19456
    s_add_u32 s76, s55, 786432
    buffer_load_dwordx4 v80, s[20:23], s76 offen lds
    v_mfma_f32_16x16x32_bf16 v[100:103], v[180:183], a[120:123], v[100:103]
    ds_read_b64_tr_b16 v[234:235], v9 offset:27648
    v_mfma_f32_16x16x32_bf16 v[104:107], v[184:187], a[120:123], v[104:107]
    ds_read_b64_tr_b16 v[236:237], v12 offset:19456
    buffer_load_dwordx4 v81, s[20:23], s76 offen offset:1024 lds
    v_mfma_f32_16x16x32_bf16 v[108:111], v[188:191], a[120:123], v[108:111]
    ds_read_b64_tr_b16 v[238:239], v12 offset:27648
    s_waitcnt vmcnt(24) lgkmcnt(8)
    v_mfma_f32_16x16x32_bf16 v[112:115], v[192:195], a[228:231], v[112:115]
    ds_read_b64_tr_b16 v[160:161], v9 offset:32768
    buffer_load_dwordx4 v[140:143], v1, s[28:31], s91 offen offset:1024 sc1
    v_mfma_f32_16x16x32_bf16 v[116:119], v[196:199], a[228:231], v[116:119]
    ds_read_b64_tr_b16 v[162:163], v9 offset:40960
    v_mfma_f32_16x16x32_bf16 v[120:123], v[200:203], a[228:231], v[120:123]
    ds_read_b64_tr_b16 v[164:165], v12 offset:32768
    buffer_load_dwordx4 v[136:139], v1, s[28:31], s90 offen offset:1024 sc1
    v_mfma_f32_16x16x32_bf16 v[124:127], v[204:207], a[228:231], v[124:127]
    ds_read_b64_tr_b16 v[166:167], v12 offset:40960
    v_mfma_f32_16x16x32_bf16 v[96:99], v[192:195], a[224:227], v[96:99]
    ds_read_b64_tr_b16 v[168:169], v9 offset:33792
    buffer_load_dwordx4 v82, s[20:23], s76 offen offset:2048 lds
    v_mfma_f32_16x16x32_bf16 v[100:103], v[196:199], a[224:227], v[100:103]
    ds_read_b64_tr_b16 v[170:171], v9 offset:41984
    v_mfma_f32_16x16x32_bf16 v[104:107], v[200:203], a[224:227], v[104:107]
    ds_read_b64_tr_b16 v[172:173], v12 offset:33792
    buffer_load_dwordx4 v83, s[20:23], s76 offen offset:3072 lds
    v_mfma_f32_16x16x32_bf16 v[108:111], v[204:207], a[224:227], v[108:111]
    ds_read_b64_tr_b16 v[174:175], v12 offset:41984
    s_waitcnt vmcnt(23) lgkmcnt(8)
    v_mfma_f32_16x16x32_bf16 v[112:115], v[224:227], a[236:239], v[112:115]
    ds_read_b64_tr_b16 v[176:177], v9 offset:34816
    buffer_load_dwordx4 v[148:151], v1, s[28:31], s91 offen offset:2048 sc1
    v_mfma_f32_16x16x32_bf16 v[116:119], v[228:231], a[236:239], v[116:119]
    ds_read_b64_tr_b16 v[178:179], v9 offset:43008
    v_mfma_f32_16x16x32_bf16 v[120:123], v[232:235], a[236:239], v[120:123]
    ds_read_b64_tr_b16 v[180:181], v12 offset:34816
    buffer_load_dwordx4 v[144:147], v1, s[28:31], s90 offen offset:2048 sc1
    v_mfma_f32_16x16x32_bf16 v[124:127], v[236:239], a[236:239], v[124:127]
    ds_read_b64_tr_b16 v[182:183], v12 offset:43008
    s_add_u32 m0, s57, 32768
    v_mfma_f32_16x16x32_bf16 v[96:99], v[224:227], a[232:235], v[96:99]
    ds_read_b64_tr_b16 v[184:185], v9 offset:35840
    s_add_u32 s76, s55, 851968
    buffer_load_dwordx4 v80, s[20:23], s76 offen lds
    v_mfma_f32_16x16x32_bf16 v[100:103], v[228:231], a[232:235], v[100:103]
    ds_read_b64_tr_b16 v[186:187], v9 offset:44032
    v_mfma_f32_16x16x32_bf16 v[104:107], v[232:235], a[232:235], v[104:107]
    ds_read_b64_tr_b16 v[188:189], v12 offset:35840
    buffer_load_dwordx4 v81, s[20:23], s76 offen offset:1024 lds
    v_mfma_f32_16x16x32_bf16 v[108:111], v[236:239], a[232:235], v[108:111]
    ds_read_b64_tr_b16 v[190:191], v12 offset:44032
    s_waitcnt vmcnt(23) lgkmcnt(8)
    s_barrier
    v_mfma_f32_16x16x32_bf16 v[112:115], v[160:163], a[244:247], v[112:115]
    ds_read_b64_tr_b16 v[192:193], v9 offset:49152
    buffer_load_dwordx4 v[156:159], v1, s[28:31], s91 offen offset:3072 sc1
    v_mfma_f32_16x16x32_bf16 v[116:119], v[164:167], a[244:247], v[116:119]
    ds_read_b64_tr_b16 v[194:195], v9 offset:57344
    v_mfma_f32_16x16x32_bf16 v[120:123], v[168:171], a[244:247], v[120:123]
    ds_read_b64_tr_b16 v[196:197], v12 offset:49152
    buffer_load_dwordx4 v[152:155], v1, s[28:31], s90 offen offset:3072 sc1
    v_mfma_f32_16x16x32_bf16 v[124:127], v[172:175], a[244:247], v[124:127]
    ds_read_b64_tr_b16 v[198:199], v12 offset:57344
    v_mfma_f32_16x16x32_bf16 v[96:99], v[160:163], a[240:243], v[96:99]
    ds_read_b64_tr_b16 v[200:201], v9 offset:50176
    buffer_load_dwordx4 v82, s[20:23], s76 offen offset:2048 lds
    v_mfma_f32_16x16x32_bf16 v[100:103], v[164:167], a[240:243], v[100:103]
    ds_read_b64_tr_b16 v[202:203], v9 offset:58368
    v_mfma_f32_16x16x32_bf16 v[104:107], v[168:171], a[240:243], v[104:107]
    ds_read_b64_tr_b16 v[204:205], v12 offset:50176
    buffer_load_dwordx4 v83, s[20:23], s76 offen offset:3072 lds
    v_mfma_f32_16x16x32_bf16 v[108:111], v[172:175], a[240:243], v[108:111]
    ds_read_b64_tr_b16 v[206:207], v12 offset:58368
    s_waitcnt vmcnt(25) lgkmcnt(8)
    v_mfma_f32_16x16x32_bf16 v[112:115], v[176:179], a[252:255], v[112:115]
    ds_read_b64_tr_b16 v[224:225], v9 offset:51200
    s_add_u32 s91, s91, 4096
    buffer_load_dwordx4 a[116:119], v1, s[28:31], s91 offen offset:0 sc1
    v_mfma_f32_16x16x32_bf16 v[116:119], v[180:183], a[252:255], v[116:119]
    ds_write_b128 v85, a[176:179] offset:0
    ds_read_b64_tr_b16 v[226:227], v9 offset:59392
    v_mfma_f32_16x16x32_bf16 v[120:123], v[184:187], a[252:255], v[120:123]
    ds_read_b64_tr_b16 v[228:229], v12 offset:51200
    v_mfma_f32_16x16x32_bf16 v[124:127], v[188:191], a[252:255], v[124:127]
    ds_read_b64_tr_b16 v[230:231], v12 offset:59392
    s_add_u32 s90, s90, 4096
    v_mfma_f32_16x16x32_bf16 v[96:99], v[176:179], a[248:251], v[96:99]
    ds_read_b64_tr_b16 v[232:233], v9 offset:52224
    buffer_load_dwordx4 a[112:115], v1, s[28:31], s90 offen offset:0 sc1
    v_mfma_f32_16x16x32_bf16 v[100:103], v[180:183], a[248:251], v[100:103]
    ds_write_b128 v85, a[180:183] offset:2048
    ds_read_b64_tr_b16 v[234:235], v9 offset:60416
    v_mfma_f32_16x16x32_bf16 v[104:107], v[184:187], a[248:251], v[104:107]
    ds_read_b64_tr_b16 v[236:237], v12 offset:52224
    v_mfma_f32_16x16x32_bf16 v[108:111], v[188:191], a[248:251], v[108:111]
    ds_read_b64_tr_b16 v[238:239], v12 offset:60416
    s_waitcnt vmcnt(25) lgkmcnt(10)
    v_mfma_f32_16x16x32_bf16 v[112:115], v[192:195], v[244:247], v[112:115]
    ds_read_b64_tr_b16 v[160:161], v10 offset:0
    buffer_load_dwordx4 a[124:127], v1, s[28:31], s91 offen offset:1024 sc1
    v_mfma_f32_16x16x32_bf16 v[116:119], v[196:199], v[244:247], v[116:119]
    ds_write_b128 v85, a[184:187] offset:4096
    ds_read_b64_tr_b16 v[162:163], v10 offset:8192
    v_mfma_f32_16x16x32_bf16 v[120:123], v[200:203], v[244:247], v[120:123]
    ds_read_b64_tr_b16 v[164:165], v13 offset:0
    v_mfma_f32_16x16x32_bf16 v[124:127], v[204:207], v[244:247], v[124:127]
    ds_read_b64_tr_b16 v[166:167], v13 offset:8192
    v_mfma_f32_16x16x32_bf16 v[96:99], v[192:195], v[240:243], v[96:99]
    ds_read_b64_tr_b16 v[168:169], v10 offset:1024
    buffer_load_dwordx4 a[228:231], v1, s[28:31], s91 offen offset:2048 sc1
    v_mfma_f32_16x16x32_bf16 v[100:103], v[196:199], v[240:243], v[100:103]
    ds_write_b128 v85, a[188:191] offset:12288
    ds_read_b64_tr_b16 v[170:171], v10 offset:9216
    v_mfma_f32_16x16x32_bf16 v[104:107], v[200:203], v[240:243], v[104:107]
    ds_read_b64_tr_b16 v[172:173], v13 offset:1024
    v_mfma_f32_16x16x32_bf16 v[108:111], v[204:207], v[240:243], v[108:111]
    ds_read_b64_tr_b16 v[174:175], v13 offset:9216
    s_waitcnt vmcnt(22) lgkmcnt(10)
    v_mfma_f32_16x16x32_bf16 v[112:115], v[224:227], v[252:255], v[112:115]
    ds_read_b64_tr_b16 v[176:177], v10 offset:2048
    buffer_load_dwordx4 a[236:239], v1, s[28:31], s91 offen offset:3072 sc1
    v_mfma_f32_16x16x32_bf16 v[116:119], v[228:231], v[252:255], v[116:119]
    ds_write_b128 v85, a[192:195] offset:14336
    ds_read_b64_tr_b16 v[178:179], v10 offset:10240
    v_mfma_f32_16x16x32_bf16 v[120:123], v[232:235], v[252:255], v[120:123]
    ds_read_b64_tr_b16 v[180:181], v13 offset:2048
    buffer_load_dwordx4 a[120:123], v1, s[28:31], s90 offen offset:1024 sc1
    v_mfma_f32_16x16x32_bf16 v[124:127], v[236:239], v[252:255], v[124:127]
    ds_read_b64_tr_b16 v[182:183], v13 offset:10240
    v_mfma_f32_16x16x32_bf16 v[96:99], v[224:227], v[248:251], v[96:99]
    ds_read_b64_tr_b16 v[184:185], v10 offset:3072
    buffer_load_dwordx4 a[224:227], v1, s[28:31], s90 offen offset:2048 sc1
    v_mfma_f32_16x16x32_bf16 v[100:103], v[228:231], v[248:251], v[100:103]
    ds_write_b128 v85, a[196:199] offset:16384
    ds_read_b64_tr_b16 v[186:187], v10 offset:11264
    v_mfma_f32_16x16x32_bf16 v[104:107], v[232:235], v[248:251], v[104:107]
    ds_read_b64_tr_b16 v[188:189], v13 offset:3072
    buffer_load_dwordx4 a[232:235], v1, s[28:31], s90 offen offset:3072 sc1
    v_mfma_f32_16x16x32_bf16 v[108:111], v[236:239], v[248:251], v[108:111]
    ds_read_b64_tr_b16 v[190:191], v13 offset:11264
    s_waitcnt vmcnt(22) lgkmcnt(10)
    s_waitcnt vmcnt(8)
    s_barrier
    v_mfma_f32_16x16x32_bf16 v[112:115], v[160:163], v[132:135], v[112:115]
    ds_read_b64_tr_b16 v[192:193], v8 offset:0
    s_and_b32 s77, s101, 0xffffff00
    s_bfm_b64 exec, 16, 0
    buffer_load_dword v19, v1, s[28:31], s77 offen sc1
    s_mov_b64 exec, -1
    v_mfma_f32_16x16x32_bf16 v[116:119], v[164:167], v[132:135], v[116:119]
    ds_write_b128 v85, a[200:203] offset:24576
    ds_read_b64_tr_b16 v[194:195], v8 offset:8192
    v_mfma_f32_16x16x32_bf16 v[120:123], v[168:171], v[132:135], v[120:123]
    ds_read_b64_tr_b16 v[196:197], v11 offset:0
    v_mfma_f32_16x16x32_bf16 v[124:127], v[172:175], v[132:135], v[124:127]
    ds_read_b64_tr_b16 v[198:199], v11 offset:8192
    v_mfma_f32_16x16x32_bf16 v[96:99], v[160:163], v[128:131], v[96:99]
    ds_read_b64_tr_b16 v[200:201], v8 offset:1024
    v_mfma_f32_16x16x32_bf16 v[100:103], v[164:167], v[128:131], v[100:103]
    ds_write_b128 v85, a[204:207] offset:26624
    ds_read_b64_tr_b16 v[202:203], v8 offset:9216
    v_mfma_f32_16x16x32_bf16 v[104:107], v[168:171], v[128:131], v[104:107]
    ds_read_b64_tr_b16 v[204:205], v11 offset:1024
    v_mfma_f32_16x16x32_bf16 v[108:111], v[172:175], v[128:131], v[108:111]
    ds_read_b64_tr_b16 v[206:207], v11 offset:9216
    s_waitcnt lgkmcnt(10)
    v_mfma_f32_16x16x32_bf16 v[112:115], v[176:179], v[140:143], v[112:115]
    ds_read_b64_tr_b16 v[224:225], v8 offset:2048
    v_mfma_f32_16x16x32_bf16 v[116:119], v[180:183], v[140:143], v[116:119]
    ds_write_b128 v85, a[208:211] offset:28672
    ds_read_b64_tr_b16 v[226:227], v8 offset:10240
    v_mfma_f32_16x16x32_bf16 v[120:123], v[184:187], v[140:143], v[120:123]
    ds_read_b64_tr_b16 v[228:229], v11 offset:2048
    v_mfma_f32_16x16x32_bf16 v[124:127], v[188:191], v[140:143], v[124:127]
    ds_read_b64_tr_b16 v[230:231], v11 offset:10240
    v_mfma_f32_16x16x32_bf16 v[96:99], v[176:179], v[136:139], v[96:99]
    ds_read_b64_tr_b16 v[232:233], v8 offset:3072
    v_mfma_f32_16x16x32_bf16 v[100:103], v[180:183], v[136:139], v[100:103]
    ds_write_b128 v85, a[212:215] offset:36864
    ds_read_b64_tr_b16 v[234:235], v8 offset:11264
    v_mfma_f32_16x16x32_bf16 v[104:107], v[184:187], v[136:139], v[104:107]
    ds_read_b64_tr_b16 v[236:237], v11 offset:3072
    v_mfma_f32_16x16x32_bf16 v[108:111], v[188:191], v[136:139], v[108:111]
    ds_read_b64_tr_b16 v[238:239], v11 offset:11264
    s_waitcnt lgkmcnt(10)
    v_mfma_f32_16x16x32_bf16 v[112:115], v[192:195], v[148:151], v[112:115]
    ds_read_b64_tr_b16 v[160:161], v8 offset:16384
    v_mfma_f32_16x16x32_bf16 v[116:119], v[196:199], v[148:151], v[116:119]
    ds_write_b128 v85, a[216:219] offset:38912
    ds_read_b64_tr_b16 v[162:163], v8 offset:24576
    v_mfma_f32_16x16x32_bf16 v[120:123], v[200:203], v[148:151], v[120:123]
    ds_read_b64_tr_b16 v[164:165], v11 offset:16384
    v_mfma_f32_16x16x32_bf16 v[124:127], v[204:207], v[148:151], v[124:127]
    ds_read_b64_tr_b16 v[166:167], v11 offset:24576
    v_mfma_f32_16x16x32_bf16 v[96:99], v[192:195], v[144:147], v[96:99]
    ds_read_b64_tr_b16 v[168:169], v8 offset:17408
    v_mfma_f32_16x16x32_bf16 v[100:103], v[196:199], v[144:147], v[100:103]
    ds_write_b128 v85, a[220:223] offset:40960
    ds_read_b64_tr_b16 v[170:171], v8 offset:25600
    v_mfma_f32_16x16x32_bf16 v[104:107], v[200:203], v[144:147], v[104:107]
    ds_read_b64_tr_b16 v[172:173], v11 offset:17408
    v_mfma_f32_16x16x32_bf16 v[108:111], v[204:207], v[144:147], v[108:111]
    ds_read_b64_tr_b16 v[174:175], v11 offset:25600
    s_waitcnt lgkmcnt(10)
    v_mfma_f32_16x16x32_bf16 v[112:115], v[224:227], v[156:159], v[112:115]
    ds_read_b64_tr_b16 v[176:177], v8 offset:18432
    v_mfma_f32_16x16x32_bf16 v[116:119], v[228:231], v[156:159], v[116:119]
    ds_read_b64_tr_b16 v[178:179], v8 offset:26624
    v_mfma_f32_16x16x32_bf16 v[120:123], v[232:235], v[156:159], v[120:123]
    ds_read_b64_tr_b16 v[180:181], v11 offset:18432
    v_mfma_f32_16x16x32_bf16 v[124:127], v[236:239], v[156:159], v[124:127]
    ds_read_b64_tr_b16 v[182:183], v11 offset:26624
    v_mfma_f32_16x16x32_bf16 v[96:99], v[224:227], v[152:155], v[96:99]
    ds_read_b64_tr_b16 v[184:185], v8 offset:19456
    v_mfma_f32_16x16x32_bf16 v[100:103], v[228:231], v[152:155], v[100:103]
    ds_read_b64_tr_b16 v[186:187], v8 offset:27648
    v_mfma_f32_16x16x32_bf16 v[104:107], v[232:235], v[152:155], v[104:107]
    ds_read_b64_tr_b16 v[188:189], v11 offset:19456
    v_mfma_f32_16x16x32_bf16 v[108:111], v[236:239], v[152:155], v[108:111]
    ds_read_b64_tr_b16 v[190:191], v11 offset:27648
    s_waitcnt vmcnt(7) lgkmcnt(8)
    v_mfma_f32_16x16x32_bf16 v[112:115], v[160:163], a[116:119], v[112:115]
    ds_read_b64_tr_b16 v[192:193], v8 offset:32768
    v_mfma_f32_16x16x32_bf16 v[116:119], v[164:167], a[116:119], v[116:119]
    ds_read_b64_tr_b16 v[194:195], v8 offset:40960
    v_mfma_f32_16x16x32_bf16 v[120:123], v[168:171], a[116:119], v[120:123]
    ds_read_b64_tr_b16 v[196:197], v11 offset:32768
    v_mfma_f32_16x16x32_bf16 v[124:127], v[172:175], a[116:119], v[124:127]
    ds_read_b64_tr_b16 v[198:199], v11 offset:40960
    v_mfma_f32_16x16x32_bf16 v[96:99], v[160:163], a[112:115], v[96:99]
    ds_read_b64_tr_b16 v[200:201], v8 offset:33792
    v_mfma_f32_16x16x32_bf16 v[100:103], v[164:167], a[112:115], v[100:103]
    ds_read_b64_tr_b16 v[202:203], v8 offset:41984
    v_mfma_f32_16x16x32_bf16 v[104:107], v[168:171], a[112:115], v[104:107]
    ds_read_b64_tr_b16 v[204:205], v11 offset:33792
    v_mfma_f32_16x16x32_bf16 v[108:111], v[172:175], a[112:115], v[108:111]
    ds_read_b64_tr_b16 v[206:207], v11 offset:41984
    s_waitcnt vmcnt(6) lgkmcnt(8)
    v_mfma_f32_16x16x32_bf16 v[112:115], v[176:179], a[124:127], v[112:115]
    ds_read_b64_tr_b16 v[224:225], v8 offset:34816
    ds_read_b64_tr_b16 v[226:227], v8 offset:43008
    v_mfma_f32_16x16x32_bf16 v[116:119], v[180:183], a[124:127], v[116:119]
    ds_read_b64_tr_b16 v[228:229], v11 offset:34816
    ds_read_b64_tr_b16 v[230:231], v11 offset:43008
    v_mfma_f32_16x16x32_bf16 v[120:123], v[184:187], a[124:127], v[120:123]
    ds_read_b64_tr_b16 v[232:233], v8 offset:35840
    ds_read_b64_tr_b16 v[234:235], v8 offset:44032
    v_mfma_f32_16x16x32_bf16 v[124:127], v[188:191], a[124:127], v[124:127]
    ds_read_b64_tr_b16 v[236:237], v11 offset:35840
    ds_read_b64_tr_b16 v[238:239], v11 offset:44032
    s_waitcnt vmcnt(5) lgkmcnt(8)
    v_mfma_f32_16x16x32_bf16 v[112:115], v[192:195], a[228:231], v[112:115]
    v_mfma_f32_16x16x32_bf16 v[116:119], v[196:199], a[228:231], v[116:119]
    v_mfma_f32_16x16x32_bf16 v[120:123], v[200:203], a[228:231], v[120:123]
    v_mfma_f32_16x16x32_bf16 v[124:127], v[204:207], a[228:231], v[124:127]
    s_waitcnt vmcnt(4) lgkmcnt(0)
    v_mfma_f32_16x16x32_bf16 v[112:115], v[224:227], a[236:239], v[112:115]
    v_mfma_f32_16x16x32_bf16 v[116:119], v[228:231], a[236:239], v[116:119]
    v_mfma_f32_16x16x32_bf16 v[120:123], v[232:235], a[236:239], v[120:123]
    v_mfma_f32_16x16x32_bf16 v[124:127], v[236:239], a[236:239], v[124:127]
    s_waitcnt vmcnt(3)
    v_mfma_f32_16x16x32_bf16 v[96:99], v[176:179], a[120:123], v[96:99]
    v_mfma_f32_16x16x32_bf16 v[100:103], v[180:183], a[120:123], v[100:103]
    s_nop 1
    ds_write_b128 v26, v[112:115] offset:32768
    v_mfma_f32_16x16x32_bf16 v[104:107], v[184:187], a[120:123], v[104:107]
    v_mfma_f32_16x16x32_bf16 v[108:111], v[188:191], a[120:123], v[108:111]
    s_waitcnt vmcnt(2)
    v_mfma_f32_16x16x32_bf16 v[96:99], v[192:195], a[224:227], v[96:99]
    ds_write_b128 v26, v[116:119] offset:33792
    v_mfma_f32_16x16x32_bf16 v[100:103], v[196:199], a[224:227], v[100:103]
    v_mfma_f32_16x16x32_bf16 v[104:107], v[200:203], a[224:227], v[104:107]
    v_mfma_f32_16x16x32_bf16 v[108:111], v[204:207], a[224:227], v[108:111]
    ds_write_b128 v26, v[120:123] offset:34816
    s_waitcnt vmcnt(1)
    v_mfma_f32_16x16x32_bf16 v[96:99], v[224:227], a[232:235], v[96:99]
    v_mfma_f32_16x16x32_bf16 v[100:103], v[228:231], a[232:235], v[100:103]
    v_mfma_f32_16x16x32_bf16 v[104:107], v[232:235], a[232:235], v[104:107]
    ds_write_b128 v26, v[124:127] offset:35840
    v_mfma_f32_16x16x32_bf16 v[108:111], v[236:239], a[232:235], v[108:111]
    s_waitcnt lgkmcnt(0)
    s_barrier
    ds_read_b128 v[160:163], v27 offset:32768
    ds_read_b128 v[164:167], v27 offset:33792
    ds_read_b128 v[168:171], v27 offset:34816
    ds_read_b128 v[172:175], v27 offset:35840
    v_pk_fma_f32 v[44:45], v[96:97], v[72:73], v[44:45] op_sel_hi:[1,0,1]
    v_pk_fma_f32 v[46:47], v[98:99], v[72:73], v[46:47] op_sel_hi:[1,0,1]
    v_pk_fma_f32 v[48:49], v[100:101], v[72:73], v[48:49] op_sel_hi:[1,0,1]
    v_pk_fma_f32 v[50:51], v[102:103], v[72:73], v[50:51] op_sel_hi:[1,0,1]
    v_pk_fma_f32 v[52:53], v[104:105], v[72:73], v[52:53] op_sel_hi:[1,0,1]
    v_pk_fma_f32 v[54:55], v[106:107], v[72:73], v[54:55] op_sel_hi:[1,0,1]
    v_pk_fma_f32 v[56:57], v[108:109], v[72:73], v[56:57] op_sel_hi:[1,0,1]
    v_pk_fma_f32 v[58:59], v[110:111], v[72:73], v[58:59] op_sel_hi:[1,0,1]
    s_waitcnt lgkmcnt(3)
    v_pk_fma_f32 v[44:45], v[160:161], v[72:73], v[44:45] op_sel_hi:[1,0,1]
    v_pk_fma_f32 v[46:47], v[162:163], v[72:73], v[46:47] op_sel_hi:[1,0,1]
    s_waitcnt lgkmcnt(2)
    v_pk_fma_f32 v[48:49], v[164:165], v[72:73], v[48:49] op_sel_hi:[1,0,1]
    v_pk_fma_f32 v[50:51], v[166:167], v[72:73], v[50:51] op_sel_hi:[1,0,1]
    s_waitcnt lgkmcnt(1)
    v_pk_fma_f32 v[52:53], v[168:169], v[72:73], v[52:53] op_sel_hi:[1,0,1]
    v_pk_fma_f32 v[54:55], v[170:171], v[72:73], v[54:55] op_sel_hi:[1,0,1]
    s_waitcnt lgkmcnt(0)
    v_pk_fma_f32 v[56:57], v[172:173], v[72:73], v[56:57] op_sel_hi:[1,0,1]
    v_pk_fma_f32 v[58:59], v[174:175], v[72:73], v[58:59] op_sel_hi:[1,0,1]
    v_cvt_pk_bf16_f32 v224, v44, v45
    v_cvt_pk_bf16_f32 v225, v46, v47
    v_cvt_pk_bf16_f32 v226, v48, v49
    v_cvt_pk_bf16_f32 v227, v50, v51
    v_cvt_pk_bf16_f32 v228, v52, v53
    v_cvt_pk_bf16_f32 v229, v54, v55
    v_cvt_pk_bf16_f32 v230, v56, v57
    v_cvt_pk_bf16_f32 v231, v58, v59
    s_cmp_lg_u32 s38, 0
    s_cbranch_scc1 ELSE_26018
    buffer_store_dwordx4 v[224:227], v1, s[28:31], s100 offen
    buffer_store_dwordx4 v[228:231], v1, s[28:31], s100 offen offset:1024
    s_branch ENDIF_26019
ELSE_26018:
    buffer_store_dwordx4 v[224:227], v1, s[28:31], s100 offen sc1
    buffer_store_dwordx4 v[228:231], v1, s[28:31], s100 offen offset:1024 sc1
ENDIF_26019:
    v_pk_add_f32 v[232:233], v[44:45], v[46:47]
    v_pk_mul_f32 v[234:235], v[44:45], v[44:45]
    v_pk_add_f32 v[236:237], v[48:49], v[50:51]
    v_pk_mul_f32 v[238:239], v[46:47], v[46:47]
    v_pk_fma_f32 v[234:235], v[48:49], v[48:49], v[234:235]
    v_pk_fma_f32 v[238:239], v[50:51], v[50:51], v[238:239]
    v_pk_add_f32 v[232:233], v[232:233], v[52:53]
    v_pk_fma_f32 v[234:235], v[52:53], v[52:53], v[234:235]
    v_pk_add_f32 v[236:237], v[236:237], v[54:55]
    v_pk_fma_f32 v[238:239], v[54:55], v[54:55], v[238:239]
    v_pk_add_f32 v[232:233], v[232:233], v[56:57]
    v_pk_fma_f32 v[234:235], v[56:57], v[56:57], v[234:235]
    v_pk_add_f32 v[236:237], v[236:237], v[58:59]
    v_pk_fma_f32 v[238:239], v[58:59], v[58:59], v[238:239]
    v_pk_add_f32 v[232:233], v[232:233], v[236:237]
    v_pk_add_f32 v[234:235], v[234:235], v[238:239]
    v_add_f32 v232, v232, v233
    v_add_f32 v233, v234, v235
    s_nop 1
    v_permlane16_swap_b32 v232, v233
    v_add_f32 v232, v232, v233
    v_mov_b32 v233, v232
    s_nop 1
    v_permlane32_swap_b32 v232, v233
    v_add_f32 v232, v232, v233
    s_cmp_lg_u32 s38, 0
    s_cbranch_scc1 ELSE_32020
    buffer_store_dword v232, v60, s[28:31], s101 offen
    s_branch ENDIF_32021
ELSE_32020:
    buffer_store_dword v232, v60, s[28:31], s101 offen sc1
ENDIF_32021:
    s_add_u32 s68, s59, 524288
    s_mov_b64 exec, s[84:85]
    buffer_store_dwordx4 v[224:227], v67, s[28:31], s68 offen sc1
    buffer_store_dwordx4 v[228:231], v67, s[28:31], s68 offen offset:1024 sc1
    buffer_store_dword v232, v87, s[28:31], s68 offen sc1
    s_mov_b64 exec, -1
    s_add_u32 s68, s39, 32
    v_mov_b32 v216, s68
    v_mov_b32 v217, s40
    v_lshlrev_b32 v44, 16, v224
    v_and_b32 v45, 0xffff0000, v224
    v_lshlrev_b32 v46, 16, v225
    v_and_b32 v47, 0xffff0000, v225
    v_lshlrev_b32 v48, 16, v226
    v_and_b32 v49, 0xffff0000, v226
    v_lshlrev_b32 v50, 16, v227
    v_and_b32 v51, 0xffff0000, v227
    v_lshlrev_b32 v52, 16, v228
    v_and_b32 v53, 0xffff0000, v228
    v_lshlrev_b32 v54, 16, v229
    v_and_b32 v55, 0xffff0000, v229
    v_lshlrev_b32 v56, 16, v230
    v_and_b32 v57, 0xffff0000, v230
    v_lshlrev_b32 v58, 16, v231
    v_and_b32 v59, 0xffff0000, v231
    ds_write_b128 v84, a[128:131] offset:0
    ds_write_b128 v84, a[132:135] offset:2048
    ds_write_b128 v84, a[136:139] offset:4096
    ds_write_b128 v84, a[140:143] offset:12288
    s_waitcnt vmcnt(3)
    s_mov_b64 exec, 1
    s_cmp_lg_u32 s38, 0
    s_cbranch_scc1 ELSE_36022
    buffer_store_dwordx2 v[216:217], off, s[28:31], s41
    s_branch ENDIF_36023
ELSE_36022:
    buffer_store_dwordx2 v[216:217], off, s[28:31], s41 sc1
ENDIF_36023:
    s_mov_b64 exec, -1
    ds_write_b128 v84, a[144:147] offset:14336
    ds_write_b128 v84, a[148:151] offset:16384
    ds_write_b128 v84, a[152:155] offset:24576
    s_add_u32 s68, s63, 1
    v_mov_b32 v218, s68
    v_mov_b32 v219, s64
    s_waitcnt vmcnt(1)
    s_mov_b64 exec, s[66:67]
    buffer_store_dwordx2 v[218:219], off, s[28:31], s65 sc1
    s_mov_b64 exec, -1
    s_lshl_b32 s68, s36, 15
    s_add_u32 s68, s68, s44
    s_lshl_b32 s100, s36, 11
    s_add_u32 s100, s100, s46
    s_add_u32 s69, s36, 0
    s_and_b32 s69, s69, 3
    s_lshl_b32 s69, s69, 12
    s_add_u32 s90, s68, s69
    s_add_u32 s69, s36, 1
    s_and_b32 s69, s69, 3
    s_lshl_b32 s69, s69, 12
    s_add_u32 s91, s68, s69
    s_add_u32 s69, s36, 2
    s_and_b32 s69, s69, 3
    s_lshl_b32 s69, s69, 12
    s_add_u32 s92, s68, s69
    s_add_u32 s69, s36, 3
    s_and_b32 s69, s69, 3
    s_lshl_b32 s69, s69, 12
    s_add_u32 s93, s68, s69
    s_add_u32 s69, s36, 3
    s_and_b32 s69, s69, 3
    s_lshl_b32 s69, s69, 12
    s_add_u32 s101, s58, 524288
    s_add_u32 s81, s101, 16384
    s_add_u32 s101, s101, s69
    v_add_u32 v88, s94, v1
    v_add_u32 v222, 32, v20
    s_mov_b32 s80, 0
    s_mov_b64 exec, s[2:3]
    buffer_load_dwordx2 v[152:153], v22, s[28:31], 0 offen sc1
    s_mov_b64 exec, -1
    ds_write_b128 v84, a[156:159] offset:26624
    ds_write_b128 v84, a[160:163] offset:28672
    ds_write_b128 v84, a[164:167] offset:36864
    ds_write_b128 v84, a[168:171] offset:38912
    ds_write_b128 v84, a[172:175] offset:40960
    s_waitcnt lgkmcnt(0)
    s_barrier
    s_mov_b64 exec, s[2:3]
    s_waitcnt vmcnt(0)
POLL_36025:
    buffer_load_dwordx2 v[154:155], v22, s[28:31], 0 offen sc1
    s_waitcnt vmcnt(1)
    v_sub_u32 v152, v152, v222
    v_cmp_eq_u32_e64 s[82:83], v153, v21
    v_cmp_gt_u32 vcc, 96, v152
    s_nop 1
    s_and_b64 vcc, vcc, s[82:83]
    s_cmp_eq_u64 vcc, exec
    s_cbranch_scc1 PDONE_36024
    buffer_load_dwordx2 v[152:153], v22, s[28:31], 0 offen sc1
    s_waitcnt vmcnt(1)
    v_sub_u32 v154, v154, v222
    v_cmp_eq_u32_e64 s[82:83], v155, v21
    v_cmp_gt_u32 vcc, 96, v154
    s_nop 1
    s_and_b64 vcc, vcc, s[82:83]
    s_cmp_eq_u64 vcc, exec
    s_cbranch_scc1 PDONE_36024
    s_add_u32 s80, s80, 1
    s_cmp_lt_u32 s80, 0x20000
    s_cbranch_scc1 POLL_36025
    s_branch L_END
PDONE_36024:
    s_mov_b64 exec, -1
    buffer_load_dwordx4 a[128:131], v1, s[28:31], s90 offen offset:0 sc1
    buffer_load_dwordx4 a[132:135], v95, s[28:31], s90 offen offset:0 sc1
    buffer_load_dwordx4 a[136:139], v1, s[28:31], s90 offen offset:1024 sc1
    buffer_load_dwordx4 a[140:143], v95, s[28:31], s90 offen offset:1024 sc1
    ds_read_b128 v[160:163], v88 offset:0
    ds_read_b128 v[164:167], v88 offset:1024
    ds_read_b128 v[168:171], v88 offset:2048
    ds_read_b128 v[172:175], v88 offset:3072
    ds_read_b128 v[176:179], v88 offset:4096
    ds_read_b128 v[180:183], v88 offset:5120
    buffer_load_dwordx4 a[144:147], v1, s[28:31], s90 offen offset:2048 sc1
    buffer_load_dwordx4 a[148:151], v95, s[28:31], s90 offen offset:2048 sc1
    s_waitcnt vmcnt(4) lgkmcnt(3)
    v_mfma_f32_16x16x32_bf16 v[96:99], v[160:163], a[128:131], 0
    ds_read_b128 v[188:191], v88 offset:6144
    v_add_u32 v90, s95, v1
    v_mfma_f32_16x16x32_bf16 v[104:107], v[160:163], a[132:135], 0
    buffer_load_dwordx4 a[152:155], v1, s[28:31], s90 offen offset:3072 sc1
    v_add_u32 v222, 1, v23
    v_mfma_f32_16x16x32_bf16 v[100:103], v[164:167], a[128:131], 0
    ds_read_b128 v[192:195], v88 offset:7168
    s_mov_b32 s80, 0
    v_mfma_f32_16x16x32_bf16 v[108:111], v[164:167], a[132:135], 0
    ds_read_b128 v[238:241], v64 offset:0
    ds_read_b128 v[242:245], v64 offset:64
    v_mfma_f32_16x16x32_bf16 v[112:115], v[168:171], a[128:131], 0
    ds_read_b128 v[196:199], v88 offset:8192
    ds_read_b128 v[246:249], v64 offset:128
    v_mfma_f32_16x16x32_bf16 v[120:123], v[168:171], a[132:135], 0
    buffer_load_dwordx4 a[156:159], v95, s[28:31], s90 offen offset:3072 sc1
    s_waitcnt lgkmcnt(6)
    v_mfma_f32_16x16x32_bf16 v[116:119], v[172:175], a[128:131], 0
    ds_read_b128 v[200:203], v88 offset:9216
    ds_read_b128 v[250:253], v64 offset:192
    v_mfma_f32_16x16x32_bf16 v[124:127], v[172:175], a[132:135], 0
    ds_read_b32 v254, v65 offset:256
    ds_read_b32 v255, v65 offset:320
    v_mfma_f32_16x16x32_bf16 v[128:131], a[128:131], v[176:179], 0
    ds_read_b128 v[204:207], v88 offset:10240
    s_and_b32 s68, s36, 1
    s_lshr_b32 s69, s36, 1
    s_mul_i32 s69, s69, 7168
    s_lshl_b32 s68, s68, 10
    s_add_u32 s68, s68, s69
    v_add_u32 v84, s68, v1
    v_add_u32 v85, 57344, v84
    s_add_u32 s68, s54, 6144
    v_add_u32 v28, s68, v1
    v_add_u32 v29, 57344, v28
    v_mfma_f32_16x16x32_bf16 v[136:139], a[132:135], v[176:179], 0
    buffer_load_dwordx4 a[160:163], v1, s[28:31], s91 offen offset:0 sc1
    v_mov_b32 v6, v1
    v_mfma_f32_16x16x32_bf16 v[132:135], a[128:131], v[180:183], 0
    ds_read_b128 v[208:211], v88 offset:11264
    v_add_u32 v7, 0x10000, v1
    v_mfma_f32_16x16x32_bf16 v[140:143], a[132:135], v[180:183], 0
    s_waitcnt vmcnt(5) lgkmcnt(7)
    v_mfma_f32_16x16x32_bf16 v[96:99], v[188:191], a[136:139], v[96:99]
    ds_read_b128 v[160:163], v88 offset:12288
    v_mfma_f32_16x16x32_bf16 v[104:107], v[188:191], a[140:143], v[104:107]
    buffer_load_dwordx4 a[164:167], v95, s[28:31], s91 offen offset:0 sc1
    v_mfma_f32_16x16x32_bf16 v[100:103], v[192:195], a[136:139], v[100:103]
    ds_read_b128 v[164:167], v88 offset:13312
    v_mfma_f32_16x16x32_bf16 v[108:111], v[192:195], a[140:143], v[108:111]
    v_mfma_f32_16x16x32_bf16 v[112:115], v[196:199], a[136:139], v[112:115]
    ds_read_b128 v[168:171], v88 offset:14336
    v_mfma_f32_16x16x32_bf16 v[120:123], v[196:199], a[140:143], v[120:123]
    buffer_load_dwordx4 v[224:227], v1, s[28:31], s100 offen sc1
    s_waitcnt lgkmcnt(3)
    v_mfma_f32_16x16x32_bf16 v[116:119], v[200:203], a[136:139], v[116:119]
    ds_read_b128 v[172:175], v88 offset:15360
    v_mfma_f32_16x16x32_bf16 v[124:127], v[200:203], a[140:143], v[124:127]
    v_mfma_f32_16x16x32_bf16 v[128:131], a[136:139], v[204:207], v[128:131]
    ds_read_b128 v[176:179], v88 offset:16384
    v_mfma_f32_16x16x32_bf16 v[136:139], a[140:143], v[204:207], v[136:139]
    buffer_load_dwordx4 v[228:231], v1, s[28:31], s100 offen offset:1024 sc1
    v_mfma_f32_16x16x32_bf16 v[132:135], a[136:139], v[208:211], v[132:135]
    ds_read_b128 v[180:183], v88 offset:17408
    v_mfma_f32_16x16x32_bf16 v[140:143], a[140:143], v[208:211], v[140:143]
    s_waitcnt vmcnt(6) lgkmcnt(3)
    v_mfma_f32_16x16x32_bf16 v[96:99], v[160:163], a[144:147], v[96:99]
    ds_read_b128 v[188:191], v88 offset:18432
    s_waitcnt vmcnt(1)
    v_add_f32 v224, v224, v226
    v_mfma_f32_16x16x32_bf16 v[104:107], v[160:163], a[148:151], v[104:107]
    buffer_load_dwordx4 a[168:171], v1, s[28:31], s91 offen offset:1024 sc1
    s_waitcnt vmcnt(1)
    v_add_f32 v228, v228, v230
    v_mfma_f32_16x16x32_bf16 v[100:103], v[164:167], a[144:147], v[100:103]
    ds_read_b128 v[192:195], v88 offset:19456
    v_add_f32 v225, v225, v227
    v_mfma_f32_16x16x32_bf16 v[108:111], v[164:167], a[148:151], v[108:111]
    v_add_f32 v229, v229, v231
    v_permlane16_swap_b32 v224, v225
    v_mfma_f32_16x16x32_bf16 v[112:115], v[168:171], a[144:147], v[112:115]
    ds_read_b128 v[196:199], v88 offset:20480
    v_permlane16_swap_b32 v228, v229
    v_mfma_f32_16x16x32_bf16 v[120:123], v[168:171], a[148:151], v[120:123]
    buffer_load_dwordx4 a[172:175], v95, s[28:31], s91 offen offset:1024 sc1
    s_waitcnt lgkmcnt(3)
    v_mfma_f32_16x16x32_bf16 v[116:119], v[172:175], a[144:147], v[116:119]
    ds_read_b128 v[200:203], v88 offset:21504
    v_add_f32 v224, v224, v225
    v_mfma_f32_16x16x32_bf16 v[124:127], v[172:175], a[148:151], v[124:127]
    v_add_f32 v228, v228, v229
    v_mov_b32 v225, v224
    v_mfma_f32_16x16x32_bf16 v[128:131], a[144:147], v[176:179], v[128:131]
    ds_read_b128 v[204:207], v88 offset:22528
    v_mov_b32 v229, v228
    v_mfma_f32_16x16x32_bf16 v[136:139], a[148:151], v[176:179], v[136:139]
    buffer_load_dwordx4 a[176:179], v1, s[28:31], s91 offen offset:2048 sc1
    v_permlane32_swap_b32 v224, v225
    v_mfma_f32_16x16x32_bf16 v[132:135], a[144:147], v[180:183], v[132:135]
    ds_read_b128 v[208:211], v88 offset:23552
    v_permlane32_swap_b32 v228, v229
    v_mfma_f32_16x16x32_bf16 v[140:143], a[148:151], v[180:183], v[140:143]
    v_add_f32 v224, v224, v225
    s_waitcnt lgkmcnt(3)
    v_mfma_f32_16x16x32_bf16 v[96:99], v[188:191], a[152:155], v[96:99]
    ds_read_b128 v[160:163], v90 offset:0
    v_add_f32 v228, v228, v229
    v_mfma_f32_16x16x32_bf16 v[104:107], v[188:191], a[156:159], v[104:107]
    buffer_load_dwordx4 a[180:183], v95, s[28:31], s91 offen offset:2048 sc1
    v_mov_b32 v225, v224
    v_mfma_f32_16x16x32_bf16 v[100:103], v[192:195], a[152:155], v[100:103]
    ds_read_b128 v[164:167], v90 offset:1024
    v_mov_b32 v229, v228
    v_mfma_f32_16x16x32_bf16 v[108:111], v[192:195], a[156:159], v[108:111]
    v_permlane16_swap_b32 v224, v225
    v_permlane16_swap_b32 v228, v229
    v_mfma_f32_16x16x32_bf16 v[112:115], v[196:199], a[152:155], v[112:115]
    ds_read_b128 v[168:171], v90 offset:2048
    v_mul_f32 v76, 0xbb000000, v224
    v_mfma_f32_16x16x32_bf16 v[120:123], v[196:199], a[156:159], v[120:123]
    buffer_load_dwordx4 a[184:187], v1, s[28:31], s91 offen offset:3072 sc1
    s_waitcnt lgkmcnt(3)
    v_mfma_f32_16x16x32_bf16 v[116:119], v[200:203], a[152:155], v[116:119]
    ds_read_b128 v[172:175], v90 offset:3072
    v_mul_f32 v77, 0xbb000000, v228
    v_mfma_f32_16x16x32_bf16 v[124:127], v[200:203], a[156:159], v[124:127]
    v_mul_f32 v225, s89, v225
    v_mul_f32 v229, s89, v229
    v_mfma_f32_16x16x32_bf16 v[128:131], a[152:155], v[204:207], v[128:131]
    ds_read_b128 v[176:179], v90 offset:4096
    v_fma_f32 v225, -v76, v76, v225
    v_mfma_f32_16x16x32_bf16 v[136:139], a[156:159], v[204:207], v[136:139]
    buffer_load_dwordx2 v[220:221], v25, s[28:31], 0 offen sc1
    v_fma_f32 v229, -v77, v77, v229
    v_mfma_f32_16x16x32_bf16 v[132:135], a[152:155], v[208:211], v[132:135]
    ds_read_b128 v[180:183], v90 offset:5120
    v_max_f32 v225, 0, v225
    v_mfma_f32_16x16x32_bf16 v[140:143], a[156:159], v[208:211], v[140:143]
    v_max_f32 v229, 0, v229
    s_waitcnt lgkmcnt(3)
    v_mfma_f32_16x16x32_bf16 v[96:99], v[160:163], a[160:163], v[96:99]
    ds_read_b128 v[188:191], v90 offset:6144
    v_add_u32 v88, s96, v1
    v_mfma_f32_16x16x32_bf16 v[104:107], v[160:163], a[164:167], v[104:107]
    buffer_load_dwordx4 a[188:191], v95, s[28:31], s91 offen offset:3072 sc1
    v_add_f32 v225, s88, v225
    v_mfma_f32_16x16x32_bf16 v[100:103], v[164:167], a[160:163], v[100:103]
    ds_read_b128 v[192:195], v90 offset:7168
    v_add_f32 v229, s88, v229
    v_mfma_f32_16x16x32_bf16 v[108:111], v[164:167], a[164:167], v[108:111]
    v_rsq_f32 v78, v225
    v_rsq_f32 v79, v229
    v_mfma_f32_16x16x32_bf16 v[112:115], v[168:171], a[160:163], v[112:115]
    ds_read_b128 v[196:199], v90 offset:8192
    ds_write_b32 v62, v76 offset:0
    v_mfma_f32_16x16x32_bf16 v[120:123], v[168:171], a[164:167], v[120:123]
    buffer_load_dwordx4 a[192:195], v1, s[28:31], s92 offen offset:0 sc1
    s_waitcnt lgkmcnt(4)
    v_mfma_f32_16x16x32_bf16 v[116:119], v[172:175], a[160:163], v[116:119]
    ds_read_b128 v[200:203], v90 offset:9216
    ds_write_b32 v62, v78 offset:64
    v_mfma_f32_16x16x32_bf16 v[124:127], v[172:175], a[164:167], v[124:127]
    ds_write_b32 v62, v77 offset:128
    ds_write_b32 v62, v79 offset:192
    v_mfma_f32_16x16x32_bf16 v[128:131], a[160:163], v[176:179], v[128:131]
    ds_read_b128 v[204:207], v90 offset:10240
    ds_read_b128 v[224:227], v63 offset:0
    v_mfma_f32_16x16x32_bf16 v[136:139], a[164:167], v[176:179], v[136:139]
    buffer_load_dwordx4 a[196:199], v95, s[28:31], s92 offen offset:0 sc1
    ds_read_b128 v[228:231], v63 offset:128
    v_mfma_f32_16x16x32_bf16 v[132:135], a[160:163], v[180:183], v[132:135]
    ds_read_b128 v[208:211], v90 offset:11264
    v_mfma_f32_16x16x32_bf16 v[140:143], a[164:167], v[180:183], v[140:143]
    s_waitcnt vmcnt(7) lgkmcnt(9)
    v_mfma_f32_16x16x32_bf16 v[96:99], v[188:191], a[168:171], v[96:99]
    ds_read_b128 v[160:163], v90 offset:12288
    v_mfma_f32_16x16x32_bf16 v[104:107], v[188:191], a[172:175], v[104:107]
    buffer_load_dwordx4 a[200:203], v1, s[28:31], s92 offen offset:1024 sc1
    v_mfma_f32_16x16x32_bf16 v[100:103], v[192:195], a[168:171], v[100:103]
    ds_read_b128 v[164:167], v90 offset:13312
    v_mfma_f32_16x16x32_bf16 v[108:111], v[192:195], a[172:175], v[108:111]
    v_mfma_f32_16x16x32_bf16 v[112:115], v[196:199], a[168:171], v[112:115]
    ds_read_b128 v[168:171], v90 offset:14336
    v_mfma_f32_16x16x32_bf16 v[120:123], v[196:199], a[172:175], v[120:123]
    buffer_load_dwordx4 a[204:207], v95, s[28:31], s92 offen offset:1024 sc1
    s_waitcnt lgkmcnt(3)
    v_mfma_f32_16x16x32_bf16 v[116:119], v[200:203], a[168:171], v[116:119]
    ds_read_b128 v[172:175], v90 offset:15360
    v_mfma_f32_16x16x32_bf16 v[124:127], v[200:203], a[172:175], v[124:127]
    v_mfma_f32_16x16x32_bf16 v[128:131], a[168:171], v[204:207], v[128:131]
    ds_read_b128 v[176:179], v90 offset:16384
    v_mfma_f32_16x16x32_bf16 v[136:139], a[172:175], v[204:207], v[136:139]
    buffer_load_dwordx4 a[208:211], v1, s[28:31], s92 offen offset:2048 sc1
    v_mfma_f32_16x16x32_bf16 v[132:135], a[168:171], v[208:211], v[132:135]
    ds_read_b128 v[180:183], v90 offset:17408
    v_mfma_f32_16x16x32_bf16 v[140:143], a[172:175], v[208:211], v[140:143]
    s_waitcnt vmcnt(8) lgkmcnt(3)
    v_mfma_f32_16x16x32_bf16 v[96:99], v[160:163], a[176:179], v[96:99]
    ds_read_b128 v[188:191], v90 offset:18432
    v_mfma_f32_16x16x32_bf16 v[104:107], v[160:163], a[180:183], v[104:107]
    buffer_load_dwordx4 a[212:215], v95, s[28:31], s92 offen offset:2048 sc1
    v_mfma_f32_16x16x32_bf16 v[100:103], v[164:167], a[176:179], v[100:103]
    ds_read_b128 v[192:195], v90 offset:19456
    v_mfma_f32_16x16x32_bf16 v[108:111], v[164:167], a[180:183], v[108:111]
    v_mfma_f32_16x16x32_bf16 v[112:115], v[168:171], a[176:179], v[112:115]
    ds_read_b128 v[196:199], v90 offset:20480
    v_mfma_f32_16x16x32_bf16 v[120:123], v[168:171], a[180:183], v[120:123]
    buffer_load_dwordx4 a[216:219], v1, s[28:31], s92 offen offset:3072 sc1
    s_waitcnt lgkmcnt(3)
    v_mfma_f32_16x16x32_bf16 v[116:119], v[172:175], a[176:179], v[116:119]
    ds_read_b128 v[200:203], v90 offset:21504
    v_mfma_f32_16x16x32_bf16 v[124:127], v[172:175], a[180:183], v[124:127]
    v_mfma_f32_16x16x32_bf16 v[128:131], a[176:179], v[176:179], v[128:131]
    ds_read_b128 v[204:207], v90 offset:22528
    v_mfma_f32_16x16x32_bf16 v[136:139], a[180:183], v[176:179], v[136:139]
    buffer_load_dwordx4 a[220:223], v95, s[28:31], s92 offen offset:3072 sc1
    v_mfma_f32_16x16x32_bf16 v[132:135], a[176:179], v[180:183], v[132:135]
    ds_read_b128 v[208:211], v90 offset:23552
    v_mfma_f32_16x16x32_bf16 v[140:143], a[180:183], v[180:183], v[140:143]
    s_waitcnt vmcnt(8) lgkmcnt(3)
    v_mfma_f32_16x16x32_bf16 v[96:99], v[188:191], a[184:187], v[96:99]
    ds_read_b128 v[160:163], v88 offset:0
    s_cmp_eq_u32 s32, 0
    s_cbranch_scc1 HDONE_36026
    s_branch PCHK_36028
POLL_36027:
    buffer_load_dwordx2 v[220:221], v25, s[28:31], 0 offen sc1
    s_waitcnt vmcnt(0)
PCHK_36028:
    v_sub_u32 v220, v220, v222
    v_cmp_eq_u32_e64 s[82:83], v221, v24
    v_cmp_gt_u32 vcc, 127, v220
    s_nop 1
    s_and_b64 vcc, vcc, s[82:83]
    s_cmp_eq_u64 vcc, -1
    s_cbranch_scc1 HDONE_36026
    s_add_u32 s80, s80, 1
    s_cmp_lt_u32 s80, 0x40000
    s_cbranch_scc1 POLL_36027
    s_branch L_END
HDONE_36026:
    v_mfma_f32_16x16x32_bf16 v[104:107], v[188:191], a[188:191], v[104:107]
    buffer_load_dwordx4 a[224:227], v1, s[28:31], s93 offen offset:0 sc1
    v_fmac_f32 v128, v224, v254
    v_mfma_f32_16x16x32_bf16 v[100:103], v[192:195], a[184:187], v[100:103]
    ds_read_b128 v[164:167], v88 offset:1024
    v_fmac_f32 v129, v225, v254
    v_mfma_f32_16x16x32_bf16 v[108:111], v[192:195], a[188:191], v[108:111]
    v_mfma_f32_16x16x32_bf16 v[112:115], v[196:199], a[184:187], v[112:115]
    ds_read_b128 v[168:171], v88 offset:2048
    v_fmac_f32 v96, v76, v238
    v_mfma_f32_16x16x32_bf16 v[120:123], v[196:199], a[188:191], v[120:123]
    buffer_load_dwordx4 a[228:231], v95, s[28:31], s93 offen offset:0 sc1
    s_waitcnt lgkmcnt(3)
    v_mfma_f32_16x16x32_bf16 v[116:119], v[200:203], a[184:187], v[116:119]
    ds_read_b128 v[172:175], v88 offset:3072
    v_fmac_f32 v97, v76, v239
    v_mfma_f32_16x16x32_bf16 v[124:127], v[200:203], a[188:191], v[124:127]
    v_fmac_f32 v98, v76, v240
    v_fmac_f32 v99, v76, v241
    v_mfma_f32_16x16x32_bf16 v[128:131], a[184:187], v[204:207], v[128:131]
    ds_read_b128 v[176:179], v88 offset:4096
    v_fmac_f32 v112, v76, v246
    v_mfma_f32_16x16x32_bf16 v[136:139], a[188:191], v[204:207], v[136:139]
    buffer_load_dwordx4 v[232:235], v1, s[28:31], s81 offen sc1
    v_fmac_f32 v113, v76, v247
    v_mfma_f32_16x16x32_bf16 v[132:135], a[184:187], v[208:211], v[132:135]
    ds_read_b128 v[180:183], v88 offset:5120
    v_fmac_f32 v114, v76, v248
    v_mfma_f32_16x16x32_bf16 v[140:143], a[188:191], v[208:211], v[140:143]
    v_fmac_f32 v115, v76, v249
    s_waitcnt vmcnt(9) lgkmcnt(3)
    v_mfma_f32_16x16x32_bf16 v[96:99], v[160:163], a[192:195], v[96:99]
    ds_read_b128 v[188:191], v88 offset:6144
    v_fmac_f32 v130, v226, v254
    v_mfma_f32_16x16x32_bf16 v[104:107], v[160:163], a[196:199], v[104:107]
    buffer_load_dwordx4 a[112:115], v1, s[28:31], s101 offen offset:0 sc1
    v_fmac_f32 v131, v227, v254
    v_mfma_f32_16x16x32_bf16 v[100:103], v[164:167], a[192:195], v[100:103]
    ds_read_b128 v[192:195], v88 offset:7168
    v_fmac_f32 v118, v76, v252
    v_mfma_f32_16x16x32_bf16 v[108:111], v[164:167], a[196:199], v[108:111]
    v_fmac_f32 v119, v76, v253
    v_add_u32 v90, s97, v1
    v_mfma_f32_16x16x32_bf16 v[112:115], v[168:171], a[192:195], v[112:115]
    ds_read_b128 v[196:199], v88 offset:8192
    v_mfma_f32_16x16x32_bf16 v[120:123], v[168:171], a[196:199], v[120:123]
    buffer_load_dwordx4 a[116:119], v1, s[28:31], s101 offen offset:1024 sc1
    s_waitcnt lgkmcnt(3)
    v_mfma_f32_16x16x32_bf16 v[116:119], v[172:175], a[192:195], v[116:119]
    ds_read_b128 v[200:203], v88 offset:9216
    v_fmac_f32 v100, v76, v242
    v_mfma_f32_16x16x32_bf16 v[124:127], v[172:175], a[196:199], v[124:127]
    v_fmac_f32 v101, v76, v243
    v_fmac_f32 v102, v76, v244
    v_mfma_f32_16x16x32_bf16 v[128:131], a[192:195], v[176:179], v[128:131]
    ds_read_b128 v[204:207], v88 offset:10240
    v_fmac_f32 v103, v76, v245
    v_mfma_f32_16x16x32_bf16 v[136:139], a[196:199], v[176:179], v[136:139]
    buffer_load_dwordx4 a[120:123], v1, s[28:31], s101 offen offset:2048 sc1
    v_mfma_f32_16x16x32_bf16 v[132:135], a[192:195], v[180:183], v[132:135]
    ds_read_b128 v[208:211], v88 offset:11264
    v_fmac_f32 v116, v76, v250
    v_mfma_f32_16x16x32_bf16 v[140:143], a[196:199], v[180:183], v[140:143]
    v_fmac_f32 v117, v76, v251
    s_waitcnt vmcnt(10) lgkmcnt(3)
    v_mfma_f32_16x16x32_bf16 v[96:99], v[188:191], a[200:203], v[96:99]
    ds_read_b128 v[160:163], v88 offset:12288
    v_mfma_f32_16x16x32_bf16 v[104:107], v[188:191], a[204:207], v[104:107]
    buffer_load_dwordx4 a[124:127], v1, s[28:31], s101 offen offset:3072 sc1
    v_mfma_f32_16x16x32_bf16 v[100:103], v[192:195], a[200:203], v[100:103]
    ds_read_b128 v[164:167], v88 offset:13312
    v_fmac_f32 v132, v224, v255
    v_mfma_f32_16x16x32_bf16 v[108:111], v[192:195], a[204:207], v[108:111]
    v_fmac_f32 v133, v225, v255
    v_fmac_f32 v134, v226, v255
    v_mfma_f32_16x16x32_bf16 v[112:115], v[196:199], a[200:203], v[112:115]
    ds_read_b128 v[168:171], v88 offset:14336
    v_fmac_f32 v135, v227, v255
    v_mfma_f32_16x16x32_bf16 v[120:123], v[196:199], a[204:207], v[120:123]
    buffer_load_dwordx4 a[232:235], v1, s[28:31], s93 offen offset:1024 sc1
    s_waitcnt lgkmcnt(3)
    v_mfma_f32_16x16x32_bf16 v[116:119], v[200:203], a[200:203], v[116:119]
    ds_read_b128 v[172:175], v88 offset:15360
    v_fmac_f32 v104, v77, v238
    v_mfma_f32_16x16x32_bf16 v[124:127], v[200:203], a[204:207], v[124:127]
    v_fmac_f32 v105, v77, v239
    v_fmac_f32 v106, v77, v240
    v_mfma_f32_16x16x32_bf16 v[128:131], a[200:203], v[204:207], v[128:131]
    ds_read_b128 v[176:179], v88 offset:16384
    v_fmac_f32 v107, v77, v241
    v_mfma_f32_16x16x32_bf16 v[136:139], a[204:207], v[204:207], v[136:139]
    buffer_load_dwordx4 a[236:239], v95, s[28:31], s93 offen offset:1024 sc1
    v_fmac_f32 v120, v77, v246
    v_mfma_f32_16x16x32_bf16 v[132:135], a[200:203], v[208:211], v[132:135]
    ds_read_b128 v[180:183], v88 offset:17408
    v_fmac_f32 v121, v77, v247
    v_mfma_f32_16x16x32_bf16 v[140:143], a[204:207], v[208:211], v[140:143]
    s_waitcnt vmcnt(11) lgkmcnt(3)
    v_mfma_f32_16x16x32_bf16 v[96:99], v[160:163], a[208:211], v[96:99]
    ds_read_b128 v[188:191], v88 offset:18432
    v_mfma_f32_16x16x32_bf16 v[104:107], v[160:163], a[212:215], v[104:107]
    buffer_load_dwordx4 a[240:243], v1, s[28:31], s93 offen offset:2048 sc1
    v_fmac_f32 v136, v228, v254
    v_mfma_f32_16x16x32_bf16 v[100:103], v[164:167], a[208:211], v[100:103]
    ds_read_b128 v[192:195], v88 offset:19456
    v_fmac_f32 v137, v229, v254
    v_mfma_f32_16x16x32_bf16 v[108:111], v[164:167], a[212:215], v[108:111]
    v_fmac_f32 v138, v230, v254
    v_fmac_f32 v139, v231, v254
    v_mfma_f32_16x16x32_bf16 v[112:115], v[168:171], a[208:211], v[112:115]
    ds_read_b128 v[196:199], v88 offset:20480
    v_mfma_f32_16x16x32_bf16 v[120:123], v[168:171], a[212:215], v[120:123]
    buffer_load_dwordx4 a[244:247], v95, s[28:31], s93 offen offset:2048 sc1
    s_waitcnt lgkmcnt(3)
    v_mfma_f32_16x16x32_bf16 v[116:119], v[172:175], a[208:211], v[116:119]
    ds_read_b128 v[200:203], v88 offset:21504
    v_mfma_f32_16x16x32_bf16 v[124:127], v[172:175], a[212:215], v[124:127]
    v_fmac_f32 v108, v77, v242
    v_fmac_f32 v109, v77, v243
    v_mfma_f32_16x16x32_bf16 v[128:131], a[208:211], v[176:179], v[128:131]
    ds_read_b128 v[204:207], v88 offset:22528
    v_fmac_f32 v110, v77, v244
    v_mfma_f32_16x16x32_bf16 v[136:139], a[212:215], v[176:179], v[136:139]
    buffer_load_dwordx4 a[248:251], v1, s[28:31], s93 offen offset:3072 sc1
    v_fmac_f32 v122, v77, v248
    v_mfma_f32_16x16x32_bf16 v[132:135], a[208:211], v[180:183], v[132:135]
    ds_read_b128 v[208:211], v88 offset:23552
    v_fmac_f32 v123, v77, v249
    v_mfma_f32_16x16x32_bf16 v[140:143], a[212:215], v[180:183], v[140:143]
    v_fmac_f32 v111, v77, v245
    s_waitcnt vmcnt(12) lgkmcnt(3)
    v_mfma_f32_16x16x32_bf16 v[96:99], v[188:191], a[216:219], v[96:99]
    ds_read_b128 v[160:163], v90 offset:0
    v_fmac_f32 v125, v77, v251
    v_mfma_f32_16x16x32_bf16 v[104:107], v[188:191], a[220:223], v[104:107]
    buffer_load_dwordx4 a[252:255], v95, s[28:31], s93 offen offset:3072 sc1
    v_fmac_f32 v126, v77, v252
    v_mfma_f32_16x16x32_bf16 v[100:103], v[192:195], a[216:219], v[100:103]
    ds_read_b128 v[164:167], v90 offset:1024
    v_fmac_f32 v127, v77, v253
    v_mfma_f32_16x16x32_bf16 v[108:111], v[192:195], a[220:223], v[108:111]
    s_add_u32 m0, s57, 126976
    v_fmac_f32 v140, v228, v255
    v_mfma_f32_16x16x32_bf16 v[112:115], v[196:199], a[216:219], v[112:115]
    ds_read_b128 v[168:171], v90 offset:2048
    s_add_u32 s76, s56, 0
    v_mfma_f32_16x16x32_bf16 v[120:123], v[196:199], a[220:223], v[120:123]
    buffer_load_dwordx4 v80, s[12:15], s76 offen lds
    s_waitcnt lgkmcnt(3)
    v_mfma_f32_16x16x32_bf16 v[116:119], v[200:203], a[216:219], v[116:119]
    ds_read_b128 v[172:175], v90 offset:3072
    v_fmac_f32 v141, v229, v255
    v_mfma_f32_16x16x32_bf16 v[124:127], v[200:203], a[220:223], v[124:127]
    v_fmac_f32 v142, v230, v255
    v_fmac_f32 v143, v231, v255
    v_mfma_f32_16x16x32_bf16 v[128:131], a[216:219], v[204:207], v[128:131]
    ds_read_b128 v[176:179], v90 offset:4096
    v_mfma_f32_16x16x32_bf16 v[136:139], a[220:223], v[204:207], v[136:139]
    buffer_load_dwordx4 v81, s[12:15], s76 offen offset:1024 lds
    v_mfma_f32_16x16x32_bf16 v[132:135], a[216:219], v[208:211], v[132:135]
    ds_read_b128 v[180:183], v90 offset:5120
    v_mfma_f32_16x16x32_bf16 v[140:143], a[220:223], v[208:211], v[140:143]
    v_fmac_f32 v124, v77, v250
    s_waitcnt vmcnt(13) lgkmcnt(3)
    v_mfma_f32_16x16x32_bf16 v[96:99], v[160:163], a[224:227], v[96:99]
    ds_read_b128 v[188:191], v90 offset:6144
    v_mfma_f32_16x16x32_bf16 v[104:107], v[160:163], a[228:231], v[104:107]
    buffer_load_dwordx4 v82, s[12:15], s76 offen offset:2048 lds
    v_mfma_f32_16x16x32_bf16 v[100:103], v[164:167], a[224:227], v[100:103]
    ds_read_b128 v[192:195], v90 offset:7168
    v_mfma_f32_16x16x32_bf16 v[108:111], v[164:167], a[228:231], v[108:111]
    v_mfma_f32_16x16x32_bf16 v[112:115], v[168:171], a[224:227], v[112:115]
    ds_read_b128 v[196:199], v90 offset:8192
    v_mfma_f32_16x16x32_bf16 v[120:123], v[168:171], a[228:231], v[120:123]
    buffer_load_dwordx4 v83, s[12:15], s76 offen offset:3072 lds
    s_waitcnt lgkmcnt(3)
    v_mfma_f32_16x16x32_bf16 v[116:119], v[172:175], a[224:227], v[116:119]
    ds_read_b128 v[200:203], v90 offset:9216
    v_mfma_f32_16x16x32_bf16 v[124:127], v[172:175], a[228:231], v[124:127]
    s_add_u32 m0, s57, 143360
    v_mfma_f32_16x16x32_bf16 v[128:131], a[224:227], v[176:179], v[128:131]
    ds_read_b128 v[204:207], v90 offset:10240
    s_add_u32 s76, s56, 65536
    v_mfma_f32_16x16x32_bf16 v[136:139], a[228:231], v[176:179], v[136:139]
    buffer_load_dwordx4 v80, s[12:15], s76 offen lds
    v_mfma_f32_16x16x32_bf16 v[132:135], a[224:227], v[180:183], v[132:135]
    ds_read_b128 v[208:211], v90 offset:11264
    v_mfma_f32_16x16x32_bf16 v[140:143], a[228:231], v[180:183], v[140:143]
    s_waitcnt vmcnt(14)
    v_mfma_f32_16x16x32_bf16 v[144:147], v[168:171], a[112:115], 0
    v_mfma_f32_16x16x32_bf16 v[148:151], v[172:175], a[112:115], 0
    buffer_load_dwordx4 v81, s[12:15], s76 offen offset:1024 lds
    v_mfma_f32_16x16x32_bf16 v[152:155], a[112:115], v[176:179], 0
    v_mfma_f32_16x16x32_bf16 v[156:159], a[112:115], v[180:183], 0
    s_waitcnt vmcnt(10) lgkmcnt(3)
    v_mfma_f32_16x16x32_bf16 v[96:99], v[188:191], a[232:235], v[96:99]
    ds_read_b128 v[160:163], v90 offset:12288
    v_add_f32 v232, v232, v234
    v_mfma_f32_16x16x32_bf16 v[104:107], v[188:191], a[236:239], v[104:107]
    buffer_load_dwordx4 v82, s[12:15], s76 offen offset:2048 lds
    v_add_f32 v233, v233, v235
    v_mfma_f32_16x16x32_bf16 v[100:103], v[192:195], a[232:235], v[100:103]
    ds_read_b128 v[164:167], v90 offset:13312
    v_permlane16_swap_b32 v232, v233
    v_mfma_f32_16x16x32_bf16 v[108:111], v[192:195], a[236:239], v[108:111]
    v_add_f32 v232, v232, v233
    v_mov_b32 v233, v232
    v_mfma_f32_16x16x32_bf16 v[112:115], v[196:199], a[232:235], v[112:115]
    ds_read_b128 v[168:171], v90 offset:14336
    v_permlane32_swap_b32 v232, v233
    v_mfma_f32_16x16x32_bf16 v[120:123], v[196:199], a[236:239], v[120:123]
    buffer_load_dwordx4 v83, s[12:15], s76 offen offset:3072 lds
    s_waitcnt lgkmcnt(3)
    v_mfma_f32_16x16x32_bf16 v[116:119], v[200:203], a[232:235], v[116:119]
    ds_read_b128 v[172:175], v90 offset:15360
    v_add_f32 v232, v232, v233
    v_mfma_f32_16x16x32_bf16 v[124:127], v[200:203], a[236:239], v[124:127]
    v_mov_b32 v233, v232
    s_nop 1
    v_permlane16_swap_b32 v232, v233
    v_mfma_f32_16x16x32_bf16 v[128:131], a[232:235], v[204:207], v[128:131]
    ds_read_b128 v[176:179], v90 offset:16384
    v_mul_f32 v236, 0xbb000000, v232
    v_mfma_f32_16x16x32_bf16 v[136:139], a[236:239], v[204:207], v[136:139]
    v_mul_f32 v233, s89, v233
    v_fma_f32 v233, -v236, v236, v233
    v_mfma_f32_16x16x32_bf16 v[132:135], a[232:235], v[208:211], v[132:135]
    ds_read_b128 v[180:183], v90 offset:17408
    v_max_f32 v233, 0, v233
    v_mfma_f32_16x16x32_bf16 v[140:143], a[236:239], v[208:211], v[140:143]
    v_add_f32 v233, s88, v233
    v_rsq_f32 v237, v233
    v_mfma_f32_16x16x32_bf16 v[144:147], v[196:199], a[116:119], v[144:147]
    ds_write_b32 v75, v236
    ds_write_b32 v75, v237 offset:64
    v_mfma_f32_16x16x32_bf16 v[148:151], v[200:203], a[116:119], v[148:151]
    v_mov_b32 v232, v237
    v_mov_b32 v233, v237
    v_mfma_f32_16x16x32_bf16 v[152:155], a[116:119], v[204:207], v[152:155]
    v_mov_b32 v234, v237
    v_mov_b32 v235, v237
    v_mfma_f32_16x16x32_bf16 v[156:159], a[116:119], v[208:211], v[156:159]
    ds_write_b128 v0, v[232:235]
    s_waitcnt vmcnt(10) lgkmcnt(6)
    v_mfma_f32_16x16x32_bf16 v[96:99], v[160:163], a[240:243], v[96:99]
    ds_read_b128 v[188:191], v90 offset:18432
    v_mfma_f32_16x16x32_bf16 v[104:107], v[160:163], a[244:247], v[104:107]
    v_mfma_f32_16x16x32_bf16 v[100:103], v[164:167], a[240:243], v[100:103]
    ds_read_b128 v[192:195], v90 offset:19456
    v_mfma_f32_16x16x32_bf16 v[108:111], v[164:167], a[244:247], v[108:111]
    v_mfma_f32_16x16x32_bf16 v[112:115], v[168:171], a[240:243], v[112:115]
    ds_read_b128 v[196:199], v90 offset:20480
    v_mfma_f32_16x16x32_bf16 v[120:123], v[168:171], a[244:247], v[120:123]
    s_waitcnt lgkmcnt(6)
    v_mfma_f32_16x16x32_bf16 v[116:119], v[172:175], a[240:243], v[116:119]
    ds_read_b128 v[200:203], v90 offset:21504
    v_mfma_f32_16x16x32_bf16 v[124:127], v[172:175], a[244:247], v[124:127]
    v_mfma_f32_16x16x32_bf16 v[128:131], a[240:243], v[176:179], v[128:131]
    ds_read_b128 v[204:207], v90 offset:22528
    v_mfma_f32_16x16x32_bf16 v[136:139], a[244:247], v[176:179], v[136:139]
    v_mfma_f32_16x16x32_bf16 v[132:135], a[240:243], v[180:183], v[132:135]
    ds_read_b128 v[208:211], v90 offset:23552
    v_mfma_f32_16x16x32_bf16 v[140:143], a[244:247], v[180:183], v[140:143]
    v_mfma_f32_16x16x32_bf16 v[144:147], v[168:171], a[120:123], v[144:147]
    v_mfma_f32_16x16x32_bf16 v[148:151], v[172:175], a[120:123], v[148:151]
    v_mfma_f32_16x16x32_bf16 v[152:155], a[120:123], v[176:179], v[152:155]
    v_mfma_f32_16x16x32_bf16 v[156:159], a[120:123], v[180:183], v[156:159]
    s_waitcnt vmcnt(8) lgkmcnt(0)
    v_mfma_f32_16x16x32_bf16 v[144:147], v[196:199], a[124:127], v[144:147]
    v_mfma_f32_16x16x32_bf16 v[148:151], v[200:203], a[124:127], v[148:151]
    v_mfma_f32_16x16x32_bf16 v[152:155], a[124:127], v[204:207], v[152:155]
    v_mfma_f32_16x16x32_bf16 v[156:159], a[124:127], v[208:211], v[156:159]
    v_mfma_f32_16x16x32_bf16 v[96:99], v[188:191], a[248:251], v[96:99]
    v_mfma_f32_16x16x32_bf16 v[104:107], v[188:191], a[252:255], v[104:107]
    v_mfma_f32_16x16x32_bf16 v[100:103], v[192:195], a[248:251], v[100:103]
    s_nop 1
    ds_write_b128 v61, v[144:147] offset:0
    v_mfma_f32_16x16x32_bf16 v[108:111], v[192:195], a[252:255], v[108:111]
    v_mfma_f32_16x16x32_bf16 v[112:115], v[196:199], a[248:251], v[112:115]
    v_mfma_f32_16x16x32_bf16 v[120:123], v[196:199], a[252:255], v[120:123]
    ds_write_b128 v61, v[148:151] offset:1024
    v_mfma_f32_16x16x32_bf16 v[116:119], v[200:203], a[248:251], v[116:119]
    v_mfma_f32_16x16x32_bf16 v[124:127], v[200:203], a[252:255], v[124:127]
    v_mfma_f32_16x16x32_bf16 v[128:131], a[248:251], v[204:207], v[128:131]
    ds_write_b128 v61, v[152:155] offset:2048
    v_mfma_f32_16x16x32_bf16 v[136:139], a[252:255], v[204:207], v[136:139]
    v_mfma_f32_16x16x32_bf16 v[132:135], a[248:251], v[208:211], v[132:135]
    v_mfma_f32_16x16x32_bf16 v[140:143], a[252:255], v[208:211], v[140:143]
    ds_write_b128 v61, v[156:159] offset:3072
    s_waitcnt lgkmcnt(0)
    s_barrier
    ds_read_b128 v[144:147], v73 offset:0
    ds_read_b128 v[148:151], v73 offset:4096
    ds_read_b128 v[152:155], v73 offset:8192
    ds_read_b128 v[156:159], v73 offset:12288
    ds_read_b128 v[200:203], v63 offset:64
    ds_read_b128 v[204:207], v63 offset:192
    ds_read_b128 v[208:211], v92
    ds_read_b32 v232, v93
    ds_read_b128 v[212:215], v94
    v_pk_mul_f32 v[112:113], v[112:113], v[78:79] op_sel_hi:[1,0]
    s_waitcnt lgkmcnt(4)
    v_pk_mul_f32 v[128:129], v[128:129], v[200:201]
    v_pk_mul_f32 v[114:115], v[114:115], v[78:79] op_sel_hi:[1,0]
    v_pk_mul_f32 v[130:131], v[130:131], v[202:203]
    v_cvt_pk_bf16_f32 v168, v112, v113
    v_cvt_pk_bf16_f32 v178, v128, v129
    v_cvt_pk_bf16_f32 v169, v114, v115
    v_cvt_pk_bf16_f32 v179, v130, v131
    ds_write2_b64 v34, v[168:169], v[178:179] offset0:0 offset1:1
    v_pk_mul_f32 v[116:117], v[116:117], v[78:79] op_sel_hi:[1,0]
    v_pk_mul_f32 v[132:133], v[132:133], v[200:201]
    v_pk_mul_f32 v[118:119], v[118:119], v[78:79] op_sel_hi:[1,0]
    v_pk_mul_f32 v[134:135], v[134:135], v[202:203]
    v_cvt_pk_bf16_f32 v170, v116, v117
    v_cvt_pk_bf16_f32 v182, v132, v133
    v_cvt_pk_bf16_f32 v171, v118, v119
    v_cvt_pk_bf16_f32 v183, v134, v135
    ds_write2_b64 v34, v[170:171], v[182:183] offset0:128 offset1:129
    v_pk_add_f32 v[144:145], v[144:145], v[148:149]
    v_pk_add_f32 v[152:153], v[152:153], v[156:157]
    v_pk_add_f32 v[146:147], v[146:147], v[150:151]
    v_pk_add_f32 v[154:155], v[154:155], v[158:159]
    v_pk_add_f32 v[144:145], v[144:145], v[152:153]
    v_pk_add_f32 v[146:147], v[146:147], v[154:155]
    s_waitcnt lgkmcnt(3)
    v_pk_fma_f32 v[144:145], v[208:209], v[232:233], v[144:145] op_sel_hi:[1,0,1]
    v_pk_fma_f32 v[146:147], v[210:211], v[232:233], v[146:147] op_sel_hi:[1,0,1]
    s_waitcnt lgkmcnt(2)
    v_pk_mul_f32 v[144:145], v[144:145], v[212:213]
    v_pk_mul_f32 v[146:147], v[146:147], v[214:215]
    v_cvt_pk_bf16_f32 v144, v144, v145
    v_cvt_pk_bf16_f32 v145, v146, v147
    ds_write_b64 v35, v[144:145]
    v_pk_mul_f32 v[120:121], v[120:121], v[78:79] op_sel:[0,1]
    v_pk_mul_f32 v[136:137], v[136:137], v[204:205]
    v_pk_mul_f32 v[122:123], v[122:123], v[78:79] op_sel:[0,1]
    v_pk_mul_f32 v[138:139], v[138:139], v[206:207]
    v_cvt_pk_bf16_f32 v172, v120, v121
    v_cvt_pk_bf16_f32 v186, v136, v137
    v_cvt_pk_bf16_f32 v173, v122, v123
    v_cvt_pk_bf16_f32 v187, v138, v139
    ds_write_b64 v34, v[172:173] offset:2048
    ds_write_b64 v34, v[186:187] offset:2056
    v_pk_mul_f32 v[124:125], v[124:125], v[78:79] op_sel:[0,1]
    v_pk_mul_f32 v[140:141], v[140:141], v[204:205]
    v_pk_mul_f32 v[126:127], v[126:127], v[78:79] op_sel:[0,1]
    v_pk_mul_f32 v[142:143], v[142:143], v[206:207]
    v_cvt_pk_bf16_f32 v174, v124, v125
    v_cvt_pk_bf16_f32 v190, v140, v141
    v_cvt_pk_bf16_f32 v175, v126, v127
    v_cvt_pk_bf16_f32 v191, v142, v143
    ds_write_b64 v34, v[174:175] offset:3072
    ds_write_b64 v34, v[190:191] offset:3080
    v_cvt_pk_bf16_f32 v160, v96, v97
    v_cvt_pk_bf16_f32 v161, v98, v99
    v_cvt_pk_bf16_f32 v162, v100, v101
    v_cvt_pk_bf16_f32 v163, v102, v103
    v_cvt_pk_bf16_f32 v164, v104, v105
    v_cvt_pk_bf16_f32 v165, v106, v107
    v_cvt_pk_bf16_f32 v166, v108, v109
    v_cvt_pk_bf16_f32 v167, v110, v111
    v_mfma_f32_16x16x16_bf16 v[116:119], v[168:169], v[160:161], v[36:39]
    v_mfma_f32_16x16x16_bf16 v[124:127], v[170:171], v[162:163], v[36:39]
    v_mfma_f32_16x16x16_bf16 v[132:135], v[172:173], v[164:165], v[36:39]
    v_mfma_f32_16x16x16_bf16 v[140:143], v[174:175], v[166:167], v[36:39]
    v_mul_f32 v218, 0x3eb8aa3b, v78
    v_mul_f32 v219, 0x3eb8aa3b, v79
    s_waitcnt lgkmcnt(0)
    s_barrier
    s_add_u32 m0, s57, 94208
    s_add_u32 s76, s56, 131072
    buffer_load_dwordx4 v80, s[12:15], s76 offen lds
    ds_read_b64 v[192:193], v30 offset:0
    ds_read_b64 v[194:195], v30 offset:1024
    ds_read_b64 v[196:197], v31 offset:0
    ds_read_b64 v[198:199], v31 offset:1024
    ds_read_b64 v[176:177], v32 offset:0
    ds_read_b64 v[180:181], v32 offset:1024
    ds_read_b64 v[184:185], v33 offset:0
    ds_read_b64 v[188:189], v33 offset:1024
    v_max3_f32 v228, v116, v117, v118
    v_max3_f32 v229, v124, v125, v126
    v_max3_f32 v230, v132, v133, v134
    v_max3_f32 v231, v140, v141, v142
    s_waitcnt lgkmcnt(7)
    v_mfma_f32_16x16x16_bf16 v[112:115], v[192:193], v[160:161], v[40:43]
    buffer_load_dwordx4 v81, s[12:15], s76 offen offset:1024 lds
    s_waitcnt lgkmcnt(6)
    v_mfma_f32_16x16x16_bf16 v[120:123], v[194:195], v[162:163], v[40:43]
    s_waitcnt lgkmcnt(5)
    v_mfma_f32_16x16x16_bf16 v[128:131], v[196:197], v[164:165], v[40:43]
    s_waitcnt lgkmcnt(4)
    v_mfma_f32_16x16x16_bf16 v[136:139], v[198:199], v[166:167], v[40:43]
    v_max_f32 v228, v228, v119
    v_max_f32 v229, v229, v127
    v_max_f32 v230, v230, v135
    v_max_f32 v231, v231, v143
    s_lshl_b32 s100, s36, 15
    s_lshl_b32 s69, s33, 10
    s_add_u32 s100, s100, s69
    s_add_u32 s100, s100, s48
    v_max3_f32 v224, v112, v113, v114
    buffer_load_dwordx4 v82, s[12:15], s76 offen offset:2048 lds
    v_max3_f32 v225, v120, v121, v122
    v_max3_f32 v226, v128, v129, v130
    v_max3_f32 v227, v136, v137, v138
    v_max3_f32 v224, v224, v115, v228
    v_max3_f32 v225, v225, v123, v229
    v_max3_f32 v226, v226, v131, v230
    v_max3_f32 v227, v227, v139, v231
    v_permlane16_swap_b32 v224, v225
    s_nop 0
    v_permlane16_swap_b32 v226, v227
    v_max_f32 v224, v224, v225
    v_max_f32 v226, v226, v227
    s_nop 1
    v_permlane32_swap_b32 v224, v226
    v_max_f32 v224, v224, v226
    v_mov_b32 v226, v224
    s_nop 1
    v_permlane32_swap_b32 v224, v226
    buffer_load_dwordx4 v83, s[12:15], s76 offen offset:3072 lds
    v_mov_b32 v225, v224
    v_mov_b32 v227, v226
    s_nop 0
    v_permlane16_swap_b32 v224, v225
    v_permlane16_swap_b32 v226, v227
    v_mul_f32 v224, v224, v218
    v_mul_f32 v225, v225, v218
    v_mul_f32 v226, v226, v219
    v_mul_f32 v227, v227, v219
    v_pk_fma_f32 v[112:113], v[112:113], v[218:219], v[224:225] op_sel_hi:[1,0,0] neg_lo:[0,0,1] neg_hi:[0,0,1]
    v_pk_fma_f32 v[114:115], v[114:115], v[218:219], v[224:225] op_sel_hi:[1,0,0] neg_lo:[0,0,1] neg_hi:[0,0,1]
    v_pk_fma_f32 v[116:117], v[116:117], v[218:219], v[224:225] op_sel_hi:[1,0,0] neg_lo:[0,0,1] neg_hi:[0,0,1]
    v_pk_fma_f32 v[118:119], v[118:119], v[218:219], v[224:225] op_sel_hi:[1,0,0] neg_lo:[0,0,1] neg_hi:[0,0,1]
    v_pk_fma_f32 v[120:121], v[120:121], v[218:219], v[224:225] op_sel:[0,0,1] op_sel_hi:[1,0,1] neg_lo:[0,0,1] neg_hi:[0,0,1]
    v_pk_fma_f32 v[122:123], v[122:123], v[218:219], v[224:225] op_sel:[0,0,1] op_sel_hi:[1,0,1] neg_lo:[0,0,1] neg_hi:[0,0,1]
    v_pk_fma_f32 v[124:125], v[124:125], v[218:219], v[224:225] op_sel:[0,0,1] op_sel_hi:[1,0,1] neg_lo:[0,0,1] neg_hi:[0,0,1]
    s_add_u32 m0, s57, 110592
    s_add_u32 s76, s56, 196608
    buffer_load_dwordx4 v80, s[12:15], s76 offen lds
    v_pk_fma_f32 v[126:127], v[126:127], v[218:219], v[224:225] op_sel:[0,0,1] op_sel_hi:[1,0,1] neg_lo:[0,0,1] neg_hi:[0,0,1]
    v_pk_fma_f32 v[128:129], v[128:129], v[218:219], v[226:227] op_sel:[0,1,0] op_sel_hi:[1,1,0] neg_lo:[0,0,1] neg_hi:[0,0,1]
    v_pk_fma_f32 v[130:131], v[130:131], v[218:219], v[226:227] op_sel:[0,1,0] op_sel_hi:[1,1,0] neg_lo:[0,0,1] neg_hi:[0,0,1]
    v_pk_fma_f32 v[132:133], v[132:133], v[218:219], v[226:227] op_sel:[0,1,0] op_sel_hi:[1,1,0] neg_lo:[0,0,1] neg_hi:[0,0,1]
    v_pk_fma_f32 v[134:135], v[134:135], v[218:219], v[226:227] op_sel:[0,1,0] op_sel_hi:[1,1,0] neg_lo:[0,0,1] neg_hi:[0,0,1]
    v_pk_fma_f32 v[136:137], v[136:137], v[218:219], v[226:227] op_sel:[0,1,1] neg_lo:[0,0,1] neg_hi:[0,0,1]
    v_pk_fma_f32 v[138:139], v[138:139], v[218:219], v[226:227] op_sel:[0,1,1] neg_lo:[0,0,1] neg_hi:[0,0,1]
    v_pk_fma_f32 v[140:141], v[140:141], v[218:219], v[226:227] op_sel:[0,1,1] neg_lo:[0,0,1] neg_hi:[0,0,1]
    v_pk_fma_f32 v[142:143], v[142:143], v[218:219], v[226:227] op_sel:[0,1,1] neg_lo:[0,0,1] neg_hi:[0,0,1]
    v_exp_f32 v112, v112
    v_exp_f32 v113, v113
    buffer_load_dwordx4 v81, s[12:15], s76 offen offset:1024 lds
    v_exp_f32 v114, v114
    v_exp_f32 v115, v115
    v_exp_f32 v116, v116
    v_exp_f32 v117, v117
    v_exp_f32 v118, v118
    v_exp_f32 v119, v119
    v_cvt_pk_bf16_f32 v96, v112, v113
    v_cvt_pk_bf16_f32 v97, v114, v115
    v_cvt_pk_bf16_f32 v98, v116, v117
    v_cvt_pk_bf16_f32 v99, v118, v119
    v_exp_f32 v120, v120
    v_exp_f32 v121, v121
    v_mfma_f32_16x16x32_bf16 v[144:147], v[68:71], v[96:99], 0
    v_exp_f32 v122, v122
    v_exp_f32 v123, v123
    buffer_load_dwordx4 v82, s[12:15], s76 offen offset:2048 lds
    s_waitcnt lgkmcnt(3)
    v_mfma_f32_16x16x32_bf16 v[232:235], v[176:179], v[96:99], 0
    v_exp_f32 v124, v124
    v_exp_f32 v125, v125
    v_exp_f32 v126, v126
    v_exp_f32 v127, v127
    v_cvt_pk_bf16_f32 v100, v120, v121
    v_cvt_pk_bf16_f32 v101, v122, v123
    v_cvt_pk_bf16_f32 v102, v124, v125
    v_cvt_pk_bf16_f32 v103, v126, v127
    v_exp_f32 v128, v128
    buffer_load_dwordx4 v83, s[12:15], s76 offen offset:3072 lds
    v_exp_f32 v129, v129
    v_mfma_f32_16x16x32_bf16 v[148:151], v[68:71], v[100:103], 0
    v_exp_f32 v130, v130
    v_exp_f32 v131, v131
    s_waitcnt lgkmcnt(2)
    v_mfma_f32_16x16x32_bf16 v[236:239], v[180:183], v[100:103], 0
    v_exp_f32 v132, v132
    v_exp_f32 v133, v133
    v_exp_f32 v134, v134
    v_exp_f32 v135, v135
    v_cvt_pk_bf16_f32 v104, v128, v129
    v_cvt_pk_bf16_f32 v105, v130, v131
    v_cvt_pk_bf16_f32 v106, v132, v133
    v_cvt_pk_bf16_f32 v107, v134, v135
    v_exp_f32 v136, v136
    v_exp_f32 v137, v137
    v_mfma_f32_16x16x32_bf16 v[152:155], v[68:71], v[104:107], 0
    v_exp_f32 v138, v138
    v_exp_f32 v139, v139
    s_waitcnt lgkmcnt(1)
    v_mfma_f32_16x16x32_bf16 v[240:243], v[184:187], v[104:107], 0
    v_exp_f32 v140, v140
    v_exp_f32 v141, v141
    v_exp_f32 v142, v142
    v_exp_f32 v143, v143
    v_cvt_pk_bf16_f32 v108, v136, v137
    v_cvt_pk_bf16_f32 v109, v138, v139
    v_cvt_pk_bf16_f32 v110, v140, v141
    v_cvt_pk_bf16_f32 v111, v142, v143
    v_rcp_f32 v144, v144
    v_rcp_f32 v148, v148
    v_mfma_f32_16x16x32_bf16 v[156:159], v[68:71], v[108:111], 0
    s_waitcnt lgkmcnt(0)
    v_mfma_f32_16x16x32_bf16 v[244:247], v[188:191], v[108:111], 0
    v_pk_mul_f32 v[232:233], v[232:233], v[144:145] op_sel_hi:[1,0]
    v_pk_mul_f32 v[234:235], v[234:235], v[144:145] op_sel_hi:[1,0]
    v_cvt_pk_bf16_f32 v248, v232, v233
    v_cvt_pk_bf16_f32 v249, v234, v235
    v_rcp_f32 v152, v152
    v_pk_mul_f32 v[236:237], v[236:237], v[148:149] op_sel_hi:[1,0]
    v_pk_mul_f32 v[238:239], v[238:239], v[148:149] op_sel_hi:[1,0]
    v_cvt_pk_bf16_f32 v250, v236, v237
    v_cvt_pk_bf16_f32 v251, v238, v239
    s_cmp_lg_u32 s38, 0
    s_cbranch_scc1 ELSE_40029
    buffer_store_dwordx4 v[248:251], v1, s[28:31], s100 offen
    s_branch ENDIF_40030
ELSE_40029:
    buffer_store_dwordx4 v[248:251], v1, s[28:31], s100 offen sc1
ENDIF_40030:
    v_pk_mul_f32 v[240:241], v[240:241], v[152:153] op_sel_hi:[1,0]
    v_pk_mul_f32 v[242:243], v[242:243], v[152:153] op_sel_hi:[1,0]
    v_cvt_pk_bf16_f32 v252, v240, v241
    v_cvt_pk_bf16_f32 v253, v242, v243
    v_rcp_f32 v156, v156
    s_nop 0
    v_pk_mul_f32 v[244:245], v[244:245], v[156:157] op_sel_hi:[1,0]
    v_pk_mul_f32 v[246:247], v[246:247], v[156:157] op_sel_hi:[1,0]
    v_cvt_pk_bf16_f32 v254, v244, v245
    v_cvt_pk_bf16_f32 v255, v246, v247
    s_cmp_lg_u32 s38, 0
    s_cbranch_scc1 ELSE_44031
    buffer_store_dwordx4 v[252:255], v95, s[28:31], s100 offen
    s_branch ENDIF_44032
ELSE_44031:
    buffer_store_dwordx4 v[252:255], v95, s[28:31], s100 offen sc1
ENDIF_44032:
    s_add_u32 s68, s39, 40
    v_mov_b32 v216, s68
    v_mov_b32 v217, s40
    ds_write_b128 v84, a[0:3] offset:0
    ds_write_b128 v84, a[4:7] offset:2048
    ds_write_b128 v84, a[8:11] offset:4096
    ds_write_b128 v84, a[12:15] offset:14336
    ds_write_b128 v84, a[16:19] offset:16384
    ds_write_b128 v84, a[20:23] offset:18432
    ds_write_b128 v28, a[24:27] offset:0
    ds_write_b128 v84, a[28:31] offset:28672
    ds_write_b128 v84, a[32:35] offset:30720
    s_waitcnt vmcnt(0)
    s_mov_b64 exec, 1
    s_cmp_lg_u32 s38, 0
    s_cbranch_scc1 ELSE_48033
    buffer_store_dwordx2 v[216:217], off, s[28:31], s41
    s_branch ENDIF_48034
ELSE_48033:
    buffer_store_dwordx2 v[216:217], off, s[28:31], s41 sc1
ENDIF_48034:
    s_mov_b64 exec, -1
    s_waitcnt lgkmcnt(0)
    s_barrier
    s_and_b32 s72, s36, 1
    s_mul_i32 s72, s72, 8192
    s_add_u32 s72, s72, s48
    s_mul_i32 s90, s62, 16384
    s_add_u32 s90, s90, s72
    s_xor_b32 s73, s62, 1
    s_mul_i32 s91, s73, 16384
    s_add_u32 s91, s91, s72
    s_add_u32 s48, s48, s47
    s_add_u32 s44, s44, s47
    s_add_u32 s46, s46, 0x20000
    s_add_u32 s100, s44, s98
    s_add_u32 s101, s46, s99
    v_add_u32 v222, 40, v20
    s_mov_b32 s80, 0
    s_mov_b64 exec, s[0:1]
    buffer_load_dwordx2 v[152:153], v22, s[28:31], 0 offen sc1
    s_mov_b64 exec, -1
    ds_write_b128 v84, a[36:39] offset:32768
    ds_write_b128 v84, a[40:43] offset:43008
    ds_write_b128 v84, a[44:47] offset:45056
    ds_write_b128 v84, a[48:51] offset:47104
    ds_write_b128 v28, a[52:55] offset:28672
    ds_write_b128 v85, a[56:59] offset:0
    ds_write_b128 v85, a[60:63] offset:2048
    s_mov_b64 exec, s[0:1]
    s_waitcnt vmcnt(0)
POLL_48036:
    buffer_load_dwordx2 v[154:155], v22, s[28:31], 0 offen sc1
    s_waitcnt vmcnt(1)
    v_sub_u32 v152, v152, v222
    v_cmp_eq_u32_e64 s[82:83], v153, v21
    v_cmp_gt_u32 vcc, 88, v152
    s_nop 1
    s_and_b64 vcc, vcc, s[82:83]
    s_cmp_eq_u64 vcc, exec
    s_cbranch_scc1 PDONE_48035
    buffer_load_dwordx2 v[152:153], v22, s[28:31], 0 offen sc1
    s_waitcnt vmcnt(1)
    v_sub_u32 v154, v154, v222
    v_cmp_eq_u32_e64 s[82:83], v155, v21
    v_cmp_gt_u32 vcc, 88, v154
    s_nop 1
    s_and_b64 vcc, vcc, s[82:83]
    s_cmp_eq_u64 vcc, exec
    s_cbranch_scc1 PDONE_48035
    s_add_u32 s80, s80, 1
    s_cmp_lt_u32 s80, 0x20000
    s_cbranch_scc1 POLL_48036
    s_branch L_END
PDONE_48035:
    s_mov_b64 exec, -1
    buffer_load_dwordx4 a[132:135], v1, s[28:31], s91 offen offset:0 sc1
    buffer_load_dwordx4 a[128:131], v1, s[28:31], s90 offen offset:0 sc1
    buffer_load_dwordx4 a[140:143], v1, s[28:31], s91 offen offset:1024 sc1
    buffer_load_dwordx4 a[136:139], v1, s[28:31], s90 offen offset:1024 sc1
    s_barrier
    ds_read_b64_tr_b16 v[160:161], v9 offset:61440
    ds_read_b64_tr_b16 v[162:163], v10 offset:4096
    ds_read_b64_tr_b16 v[164:165], v12 offset:61440
    ds_read_b64_tr_b16 v[166:167], v13 offset:4096
    ds_read_b64_tr_b16 v[168:169], v9 offset:62464
    ds_read_b64_tr_b16 v[170:171], v10 offset:5120
    ds_read_b64_tr_b16 v[172:173], v12 offset:62464
    ds_read_b64_tr_b16 v[174:175], v13 offset:5120
    buffer_load_dwordx4 a[148:151], v1, s[28:31], s91 offen offset:2048 sc1
    buffer_load_dwordx4 a[144:147], v1, s[28:31], s90 offen offset:2048 sc1
    ds_read_b64_tr_b16 v[176:177], v9 offset:63488
    ds_read_b64_tr_b16 v[178:179], v10 offset:6144
    ds_read_b64_tr_b16 v[180:181], v12 offset:63488
    ds_read_b64_tr_b16 v[182:183], v13 offset:6144
    ds_read_b64_tr_b16 v[184:185], v9 offset:64512
    ds_read_b64_tr_b16 v[186:187], v10 offset:7168
    ds_read_b64_tr_b16 v[188:189], v12 offset:64512
    ds_read_b64_tr_b16 v[190:191], v13 offset:7168
    buffer_load_dwordx4 a[156:159], v1, s[28:31], s91 offen offset:3072 sc1
    buffer_load_dwordx4 a[152:155], v1, s[28:31], s90 offen offset:3072 sc1
    ds_write_b128 v85, a[64:67] offset:4096
    ds_write_b128 v85, a[68:71] offset:14336
    ds_write_b128 v85, a[72:75] offset:16384
    ds_write_b128 v85, a[76:79] offset:18432
    ds_write_b128 v29, a[80:83] offset:0
    s_waitcnt vmcnt(6) lgkmcnt(13)
    v_mfma_f32_16x16x32_bf16 v[112:115], v[160:163], a[132:135], 0
    ds_read_b64_tr_b16 v[192:193], v10 offset:12288
    s_add_u32 s91, s91, 4096
    buffer_load_dwordx4 a[164:167], v1, s[28:31], s91 offen offset:0 sc1
    v_mfma_f32_16x16x32_bf16 v[116:119], v[164:167], a[132:135], 0
    ds_read_b64_tr_b16 v[194:195], v10 offset:20480
    s_add_u32 s90, s90, 4096
    v_mfma_f32_16x16x32_bf16 v[120:123], v[168:171], a[132:135], 0
    ds_read_b64_tr_b16 v[196:197], v13 offset:12288
    buffer_load_dwordx4 a[160:163], v1, s[28:31], s90 offen offset:0 sc1
    v_mfma_f32_16x16x32_bf16 v[124:127], v[172:175], a[132:135], 0
    ds_read_b64_tr_b16 v[198:199], v13 offset:20480
    v_mfma_f32_16x16x32_bf16 v[96:99], v[160:163], a[128:131], 0
    ds_read_b64_tr_b16 v[200:201], v10 offset:13312
    buffer_load_dwordx4 a[172:175], v1, s[28:31], s91 offen offset:1024 sc1
    v_mfma_f32_16x16x32_bf16 v[100:103], v[164:167], a[128:131], 0
    ds_read_b64_tr_b16 v[202:203], v10 offset:21504
    v_mfma_f32_16x16x32_bf16 v[104:107], v[168:171], a[128:131], 0
    ds_read_b64_tr_b16 v[204:205], v13 offset:13312
    buffer_load_dwordx4 a[180:183], v1, s[28:31], s91 offen offset:2048 sc1
    v_mfma_f32_16x16x32_bf16 v[108:111], v[172:175], a[128:131], 0
    ds_read_b64_tr_b16 v[206:207], v13 offset:21504
    s_waitcnt vmcnt(8) lgkmcnt(13)
    v_mfma_f32_16x16x32_bf16 v[112:115], v[176:179], a[140:143], v[112:115]
    ds_read_b64_tr_b16 v[224:225], v10 offset:14336
    buffer_load_dwordx4 a[188:191], v1, s[28:31], s91 offen offset:3072 sc1
    v_mfma_f32_16x16x32_bf16 v[116:119], v[180:183], a[140:143], v[116:119]
    ds_read_b64_tr_b16 v[226:227], v10 offset:22528
    v_mfma_f32_16x16x32_bf16 v[120:123], v[184:187], a[140:143], v[120:123]
    ds_read_b64_tr_b16 v[228:229], v13 offset:14336
    buffer_load_dwordx4 a[168:171], v1, s[28:31], s90 offen offset:1024 sc1
    v_mfma_f32_16x16x32_bf16 v[124:127], v[188:191], a[140:143], v[124:127]
    ds_read_b64_tr_b16 v[230:231], v13 offset:22528
    v_mfma_f32_16x16x32_bf16 v[96:99], v[176:179], a[136:139], v[96:99]
    ds_read_b64_tr_b16 v[232:233], v10 offset:15360
    buffer_load_dwordx4 a[176:179], v1, s[28:31], s90 offen offset:2048 sc1
    v_mfma_f32_16x16x32_bf16 v[100:103], v[180:183], a[136:139], v[100:103]
    ds_read_b64_tr_b16 v[234:235], v10 offset:23552
    v_mfma_f32_16x16x32_bf16 v[104:107], v[184:187], a[136:139], v[104:107]
    ds_read_b64_tr_b16 v[236:237], v13 offset:15360
    buffer_load_dwordx4 a[184:187], v1, s[28:31], s90 offen offset:3072 sc1
    v_mfma_f32_16x16x32_bf16 v[108:111], v[188:191], a[136:139], v[108:111]
    ds_read_b64_tr_b16 v[238:239], v13 offset:23552
    s_waitcnt vmcnt(10) lgkmcnt(8)
    v_mfma_f32_16x16x32_bf16 v[112:115], v[192:195], a[148:151], v[112:115]
    ds_read_b64_tr_b16 v[160:161], v9 offset:28672
    v_mfma_f32_16x16x32_bf16 v[116:119], v[196:199], a[148:151], v[116:119]
    ds_read_b64_tr_b16 v[162:163], v9 offset:36864
    v_mfma_f32_16x16x32_bf16 v[120:123], v[200:203], a[148:151], v[120:123]
    ds_read_b64_tr_b16 v[164:165], v12 offset:28672
    v_mfma_f32_16x16x32_bf16 v[124:127], v[204:207], a[148:151], v[124:127]
    ds_read_b64_tr_b16 v[166:167], v12 offset:36864
    v_mfma_f32_16x16x32_bf16 v[96:99], v[192:195], a[144:147], v[96:99]
    ds_read_b64_tr_b16 v[168:169], v9 offset:29696
    v_mfma_f32_16x16x32_bf16 v[100:103], v[196:199], a[144:147], v[100:103]
    ds_read_b64_tr_b16 v[170:171], v9 offset:37888
    v_mfma_f32_16x16x32_bf16 v[104:107], v[200:203], a[144:147], v[104:107]
    ds_read_b64_tr_b16 v[172:173], v12 offset:29696
    v_mfma_f32_16x16x32_bf16 v[108:111], v[204:207], a[144:147], v[108:111]
    ds_read_b64_tr_b16 v[174:175], v12 offset:37888
    s_waitcnt vmcnt(8) lgkmcnt(8)
    s_barrier
    v_mfma_f32_16x16x32_bf16 v[112:115], v[224:227], a[156:159], v[112:115]
    ds_read_b64_tr_b16 v[176:177], v9 offset:30720
    s_and_b32 s77, s101, 0xffffff00
    s_bfm_b64 exec, 16, 0
    buffer_load_dword v19, v1, s[28:31], s77 offen sc1
    s_mov_b64 exec, -1
    v_mfma_f32_16x16x32_bf16 v[116:119], v[228:231], a[156:159], v[116:119]
    ds_read_b64_tr_b16 v[178:179], v9 offset:38912
    v_mfma_f32_16x16x32_bf16 v[120:123], v[232:235], a[156:159], v[120:123]
    ds_read_b64_tr_b16 v[180:181], v12 offset:30720
    v_mfma_f32_16x16x32_bf16 v[124:127], v[236:239], a[156:159], v[124:127]
    ds_read_b64_tr_b16 v[182:183], v12 offset:38912
    v_mfma_f32_16x16x32_bf16 v[96:99], v[224:227], a[152:155], v[96:99]
    ds_read_b64_tr_b16 v[184:185], v9 offset:31744
    v_add_u32 v216, 2754487915, v23
    v_add_u32 v217, 3669625727, v24
    v_subrev_u32 v218, 128, v25
    s_or_b32 s68, s33, s36
    s_cmp_eq_u32 s68, 0
    s_cselect_b32 s82, 0xffff, 0
    s_mov_b32 s83, 0
    s_mov_b64 exec, s[82:83]
    buffer_store_dwordx2 v[216:217], v218, s[28:31], 0 offen sc1
    s_mov_b64 exec, -1
    v_mfma_f32_16x16x32_bf16 v[100:103], v[228:231], a[152:155], v[100:103]
    ds_read_b64_tr_b16 v[186:187], v9 offset:39936
    v_mfma_f32_16x16x32_bf16 v[104:107], v[232:235], a[152:155], v[104:107]
    ds_read_b64_tr_b16 v[188:189], v12 offset:31744
    v_mfma_f32_16x16x32_bf16 v[108:111], v[236:239], a[152:155], v[108:111]
    ds_read_b64_tr_b16 v[190:191], v12 offset:39936
    s_waitcnt vmcnt(8) lgkmcnt(8)
    v_mfma_f32_16x16x32_bf16 v[112:115], v[160:163], a[164:167], v[112:115]
    ds_read_b64_tr_b16 v[192:193], v9 offset:45056
    v_mfma_f32_16x16x32_bf16 v[116:119], v[164:167], a[164:167], v[116:119]
    ds_read_b64_tr_b16 v[194:195], v9 offset:53248
    v_mfma_f32_16x16x32_bf16 v[120:123], v[168:171], a[164:167], v[120:123]
    ds_read_b64_tr_b16 v[196:197], v12 offset:45056
    v_mfma_f32_16x16x32_bf16 v[124:127], v[172:175], a[164:167], v[124:127]
    ds_read_b64_tr_b16 v[198:199], v12 offset:53248
    v_mfma_f32_16x16x32_bf16 v[96:99], v[160:163], a[160:163], v[96:99]
    ds_read_b64_tr_b16 v[200:201], v9 offset:46080
    v_mfma_f32_16x16x32_bf16 v[100:103], v[164:167], a[160:163], v[100:103]
    ds_read_b64_tr_b16 v[202:203], v9 offset:54272
    v_mfma_f32_16x16x32_bf16 v[104:107], v[168:171], a[160:163], v[104:107]
    ds_read_b64_tr_b16 v[204:205], v12 offset:46080
    v_mfma_f32_16x16x32_bf16 v[108:111], v[172:175], a[160:163], v[108:111]
    ds_read_b64_tr_b16 v[206:207], v12 offset:54272
    s_waitcnt vmcnt(7) lgkmcnt(8)
    v_mfma_f32_16x16x32_bf16 v[112:115], v[176:179], a[172:175], v[112:115]
    ds_read_b64_tr_b16 v[224:225], v9 offset:47104
    ds_read_b64_tr_b16 v[226:227], v9 offset:55296
    v_mfma_f32_16x16x32_bf16 v[116:119], v[180:183], a[172:175], v[116:119]
    ds_read_b64_tr_b16 v[228:229], v12 offset:47104
    ds_read_b64_tr_b16 v[230:231], v12 offset:55296
    v_mfma_f32_16x16x32_bf16 v[120:123], v[184:187], a[172:175], v[120:123]
    ds_read_b64_tr_b16 v[232:233], v9 offset:48128
    ds_read_b64_tr_b16 v[234:235], v9 offset:56320
    v_mfma_f32_16x16x32_bf16 v[124:127], v[188:191], a[172:175], v[124:127]
    ds_read_b64_tr_b16 v[236:237], v12 offset:48128
    ds_read_b64_tr_b16 v[238:239], v12 offset:56320
    s_waitcnt vmcnt(6) lgkmcnt(8)
    v_mfma_f32_16x16x32_bf16 v[112:115], v[192:195], a[180:183], v[112:115]
    v_mfma_f32_16x16x32_bf16 v[116:119], v[196:199], a[180:183], v[116:119]
    v_mfma_f32_16x16x32_bf16 v[120:123], v[200:203], a[180:183], v[120:123]
    v_mfma_f32_16x16x32_bf16 v[124:127], v[204:207], a[180:183], v[124:127]
    s_waitcnt vmcnt(5) lgkmcnt(0)
    v_mfma_f32_16x16x32_bf16 v[112:115], v[224:227], a[188:191], v[112:115]
    v_mfma_f32_16x16x32_bf16 v[116:119], v[228:231], a[188:191], v[116:119]
    v_mfma_f32_16x16x32_bf16 v[120:123], v[232:235], a[188:191], v[120:123]
    v_mfma_f32_16x16x32_bf16 v[124:127], v[236:239], a[188:191], v[124:127]
    s_waitcnt vmcnt(4)
    v_mfma_f32_16x16x32_bf16 v[96:99], v[176:179], a[168:171], v[96:99]
    v_mfma_f32_16x16x32_bf16 v[100:103], v[180:183], a[168:171], v[100:103]
    s_nop 1
    ds_write_b128 v26, v[112:115] offset:61440
    v_mfma_f32_16x16x32_bf16 v[104:107], v[184:187], a[168:171], v[104:107]
    v_mfma_f32_16x16x32_bf16 v[108:111], v[188:191], a[168:171], v[108:111]
    s_waitcnt vmcnt(3)
    v_mfma_f32_16x16x32_bf16 v[96:99], v[192:195], a[176:179], v[96:99]
    ds_write_b128 v26, v[116:119] offset:62464
    v_mfma_f32_16x16x32_bf16 v[100:103], v[196:199], a[176:179], v[100:103]
    v_mfma_f32_16x16x32_bf16 v[104:107], v[200:203], a[176:179], v[104:107]
    v_mfma_f32_16x16x32_bf16 v[108:111], v[204:207], a[176:179], v[108:111]
    ds_write_b128 v26, v[120:123] offset:63488
    s_waitcnt vmcnt(2)
    v_mfma_f32_16x16x32_bf16 v[96:99], v[224:227], a[184:187], v[96:99]
    v_mfma_f32_16x16x32_bf16 v[100:103], v[228:231], a[184:187], v[100:103]
    v_mfma_f32_16x16x32_bf16 v[104:107], v[232:235], a[184:187], v[104:107]
    ds_write_b128 v26, v[124:127] offset:64512
    v_mfma_f32_16x16x32_bf16 v[108:111], v[236:239], a[184:187], v[108:111]
    s_waitcnt lgkmcnt(0)
    s_barrier
    ds_read_b128 v[160:163], v27 offset:61440
    ds_read_b128 v[164:167], v27 offset:62464
    ds_read_b128 v[168:171], v27 offset:63488
    ds_read_b128 v[172:175], v27 offset:64512
    v_pk_add_f32 v[44:45], v[96:97], v[44:45]
    v_pk_add_f32 v[46:47], v[98:99], v[46:47]
    v_pk_add_f32 v[48:49], v[100:101], v[48:49]
    v_pk_add_f32 v[50:51], v[102:103], v[50:51]
    v_pk_add_f32 v[52:53], v[104:105], v[52:53]
    v_pk_add_f32 v[54:55], v[106:107], v[54:55]
    v_pk_add_f32 v[56:57], v[108:109], v[56:57]
    v_pk_add_f32 v[58:59], v[110:111], v[58:59]
    s_waitcnt lgkmcnt(3)
    v_pk_add_f32 v[44:45], v[160:161], v[44:45]
    v_pk_add_f32 v[46:47], v[162:163], v[46:47]
    s_waitcnt lgkmcnt(2)
    v_pk_add_f32 v[48:49], v[164:165], v[48:49]
    v_pk_add_f32 v[50:51], v[166:167], v[50:51]
    s_waitcnt lgkmcnt(1)
    v_pk_add_f32 v[52:53], v[168:169], v[52:53]
    v_pk_add_f32 v[54:55], v[170:171], v[54:55]
    s_waitcnt lgkmcnt(0)
    v_pk_add_f32 v[56:57], v[172:173], v[56:57]
    v_pk_add_f32 v[58:59], v[174:175], v[58:59]
    v_cvt_pk_bf16_f32 v224, v44, v45
    v_cvt_pk_bf16_f32 v225, v46, v47
    v_cvt_pk_bf16_f32 v226, v48, v49
    v_cvt_pk_bf16_f32 v227, v50, v51
    v_cvt_pk_bf16_f32 v228, v52, v53
    v_cvt_pk_bf16_f32 v229, v54, v55
    v_cvt_pk_bf16_f32 v230, v56, v57
    v_cvt_pk_bf16_f32 v231, v58, v59
    s_cmp_lg_u32 s38, 0
    s_cbranch_scc1 ELSE_52037
    buffer_store_dwordx4 v[224:227], v1, s[28:31], s100 offen
    buffer_store_dwordx4 v[228:231], v1, s[28:31], s100 offen offset:1024
    s_branch ENDIF_52038
ELSE_52037:
    buffer_store_dwordx4 v[224:227], v1, s[28:31], s100 offen sc1
    buffer_store_dwordx4 v[228:231], v1, s[28:31], s100 offen offset:1024 sc1
ENDIF_52038:
    v_pk_add_f32 v[232:233], v[44:45], v[46:47]
    v_pk_mul_f32 v[234:235], v[44:45], v[44:45]
    v_pk_add_f32 v[236:237], v[48:49], v[50:51]
    v_pk_mul_f32 v[238:239], v[46:47], v[46:47]
    v_pk_fma_f32 v[234:235], v[48:49], v[48:49], v[234:235]
    v_pk_fma_f32 v[238:239], v[50:51], v[50:51], v[238:239]
    v_pk_add_f32 v[232:233], v[232:233], v[52:53]
    v_pk_fma_f32 v[234:235], v[52:53], v[52:53], v[234:235]
    v_pk_add_f32 v[236:237], v[236:237], v[54:55]
    v_pk_fma_f32 v[238:239], v[54:55], v[54:55], v[238:239]
    v_pk_add_f32 v[232:233], v[232:233], v[56:57]
    v_pk_fma_f32 v[234:235], v[56:57], v[56:57], v[234:235]
    v_pk_add_f32 v[236:237], v[236:237], v[58:59]
    v_pk_fma_f32 v[238:239], v[58:59], v[58:59], v[238:239]
    v_pk_add_f32 v[232:233], v[232:233], v[236:237]
    v_pk_add_f32 v[234:235], v[234:235], v[238:239]
    v_add_f32 v232, v232, v233
    v_add_f32 v233, v234, v235
    s_nop 1
    v_permlane16_swap_b32 v232, v233
    v_add_f32 v232, v232, v233
    v_mov_b32 v233, v232
    s_nop 1
    v_permlane32_swap_b32 v232, v233
    v_add_f32 v232, v232, v233
    s_cmp_lg_u32 s38, 0
    s_cbranch_scc1 ELSE_58039
    buffer_store_dword v232, v60, s[28:31], s101 offen
    s_branch ENDIF_58040
ELSE_58039:
    buffer_store_dword v232, v60, s[28:31], s101 offen sc1
ENDIF_58040:
    s_add_u32 s68, s39, 48
    v_mov_b32 v216, s68
    v_mov_b32 v217, s40
    v_lshlrev_b32 v44, 16, v224
    v_and_b32 v45, 0xffff0000, v224
    v_lshlrev_b32 v46, 16, v225
    v_and_b32 v47, 0xffff0000, v225
    v_lshlrev_b32 v48, 16, v226
    v_and_b32 v49, 0xffff0000, v226
    v_lshlrev_b32 v50, 16, v227
    v_and_b32 v51, 0xffff0000, v227
    v_lshlrev_b32 v52, 16, v228
    v_and_b32 v53, 0xffff0000, v228
    v_lshlrev_b32 v54, 16, v229
    v_and_b32 v55, 0xffff0000, v229
    v_lshlrev_b32 v56, 16, v230
    v_and_b32 v57, 0xffff0000, v230
    v_lshlrev_b32 v58, 16, v231
    v_and_b32 v59, 0xffff0000, v231
    ds_write_b128 v85, a[84:87] offset:28672
    ds_write_b128 v85, a[88:91] offset:30720
    ds_write_b128 v85, a[92:95] offset:32768
    ds_write_b128 v85, a[96:99] offset:43008
    ds_write_b128 v85, a[100:103] offset:45056
    ds_write_b128 v85, a[104:107] offset:47104
    ds_write_b128 v29, a[108:111] offset:28672
    s_waitcnt vmcnt(0)
    s_mov_b64 exec, 1
    s_cmp_lg_u32 s38, 0
    s_cbranch_scc1 ELSE_62041
    buffer_store_dwordx2 v[216:217], off, s[28:31], s41
    s_branch ENDIF_62042
ELSE_62041:
    buffer_store_dwordx2 v[216:217], off, s[28:31], s41 sc1
ENDIF_62042:
    s_mov_b64 exec, -1
    s_lshl_b32 s68, s36, 15
    s_add_u32 s68, s68, s44
    s_lshl_b32 s100, s36, 11
    s_add_u32 s100, s100, s46
    s_add_u32 s90, s68, 0
    s_add_u32 s91, s68, 4096
    s_add_u32 s92, s68, 8192
    s_add_u32 s93, s68, 12288
    s_lshl_b32 s101, s62, 10
    s_add_u32 s101, s101, s46
    v_add_u32 v222, 48, v20
    s_mov_b32 s80, 0
    s_mov_b64 exec, s[2:3]
    buffer_load_dwordx2 v[152:153], v22, s[28:31], 0 offen sc1
    s_mov_b64 exec, -1
    s_waitcnt lgkmcnt(0)
    s_barrier
    s_mov_b64 exec, s[2:3]
    s_waitcnt vmcnt(0)
POLL_62044:
    buffer_load_dwordx2 v[154:155], v22, s[28:31], 0 offen sc1
    s_waitcnt vmcnt(1)
    v_sub_u32 v152, v152, v222
    v_cmp_eq_u32_e64 s[82:83], v153, v21
    v_cmp_gt_u32 vcc, 80, v152
    s_nop 1
    s_and_b64 vcc, vcc, s[82:83]
    s_cmp_eq_u64 vcc, exec
    s_cbranch_scc1 PDONE_62043
    buffer_load_dwordx2 v[152:153], v22, s[28:31], 0 offen sc1
    s_waitcnt vmcnt(1)
    v_sub_u32 v154, v154, v222
    v_cmp_eq_u32_e64 s[82:83], v155, v21
    v_cmp_gt_u32 vcc, 80, v154
    s_nop 1
    s_and_b64 vcc, vcc, s[82:83]
    s_cmp_eq_u64 vcc, exec
    s_cbranch_scc1 PDONE_62043
    s_add_u32 s80, s80, 1
    s_cmp_lt_u32 s80, 0x20000
    s_cbranch_scc1 POLL_62044
    s_branch L_END
PDONE_62043:
    s_mov_b64 exec, -1
    buffer_load_dwordx4 a[128:131], v1, s[28:31], s90 offen offset:0 sc1
    buffer_load_dwordx4 a[132:135], v95, s[28:31], s90 offen offset:0 sc1
    buffer_load_dwordx4 a[136:139], v1, s[28:31], s90 offen offset:1024 sc1
    buffer_load_dwordx4 a[140:143], v95, s[28:31], s90 offen offset:1024 sc1
    ds_read_b128 v[160:163], v6 offset:0
    ds_read_b128 v[164:167], v6 offset:1024
    ds_read_b128 v[168:171], v6 offset:2048
    ds_read_b128 v[172:175], v6 offset:3072
    ds_read_b128 v[176:179], v6 offset:4096
    ds_read_b128 v[180:183], v6 offset:5120
    ds_read_b128 v[184:187], v6 offset:6144
    buffer_load_dwordx4 a[144:147], v1, s[28:31], s90 offen offset:2048 sc1
    buffer_load_dwordx4 a[148:151], v95, s[28:31], s90 offen offset:2048 sc1
    s_waitcnt vmcnt(4) lgkmcnt(3)
    v_mfma_f32_16x16x32_bf16 v[96:99], v[160:163], a[128:131], 0
    ds_read_b128 v[188:191], v6 offset:7168
    ds_read_b128 v[228:231], v64 offset:512
    v_mfma_f32_16x16x32_bf16 v[124:127], v[160:163], a[132:135], 0
    buffer_load_dwordx4 a[152:155], v1, s[28:31], s90 offen offset:3072 sc1
    ds_read_b128 v[232:235], v64 offset:576
    v_mfma_f32_16x16x32_bf16 v[100:103], v[164:167], a[128:131], 0
    ds_read_b128 v[192:195], v6 offset:8192
    ds_read_b128 v[236:239], v64 offset:640
    v_mfma_f32_16x16x32_bf16 v[128:131], v[164:167], a[132:135], 0
    ds_read_b128 v[240:243], v64 offset:704
    ds_read_b128 v[244:247], v64 offset:768
    v_mfma_f32_16x16x32_bf16 v[104:107], v[168:171], a[128:131], 0
    ds_read_b128 v[196:199], v6 offset:9216
    buffer_load_dwordx4 a[156:159], v95, s[28:31], s90 offen offset:3072 sc1
    v_mfma_f32_16x16x32_bf16 v[132:135], v[168:171], a[132:135], 0
    ds_read_b128 v[248:251], v64 offset:832
    ds_read_b128 v[252:255], v64 offset:896
    v_mfma_f32_16x16x32_bf16 v[108:111], v[172:175], a[128:131], 0
    ds_read_b128 v[200:203], v6 offset:10240
    v_mfma_f32_16x16x32_bf16 v[136:139], v[172:175], a[132:135], 0
    s_waitcnt lgkmcnt(11)
    v_mfma_f32_16x16x32_bf16 v[112:115], v[176:179], a[128:131], 0
    ds_read_b128 v[204:207], v6 offset:11264
    buffer_load_dwordx4 a[160:163], v1, s[28:31], s91 offen offset:0 sc1
    v_mfma_f32_16x16x32_bf16 v[140:143], v[176:179], a[132:135], 0
    v_mfma_f32_16x16x32_bf16 v[116:119], v[180:183], a[128:131], 0
    ds_read_b128 v[208:211], v6 offset:12288
    v_mfma_f32_16x16x32_bf16 v[144:147], v[180:183], a[132:135], 0
    buffer_load_dwordx4 a[164:167], v95, s[28:31], s91 offen offset:0 sc1
    v_mfma_f32_16x16x32_bf16 v[120:123], v[184:187], a[128:131], 0
    ds_read_b128 v[212:215], v6 offset:13312
    v_mfma_f32_16x16x32_bf16 v[148:151], v[184:187], a[132:135], 0
    s_waitcnt vmcnt(6) lgkmcnt(3)
    v_mfma_f32_16x16x32_bf16 v[96:99], v[188:191], a[136:139], v[96:99]
    ds_read_b128 v[160:163], v6 offset:14336
    v_mfma_f32_16x16x32_bf16 v[124:127], v[188:191], a[140:143], v[124:127]
    buffer_load_dwordx4 v[216:219], v1, s[28:31], s100 offen sc1
    v_mfma_f32_16x16x32_bf16 v[100:103], v[192:195], a[136:139], v[100:103]
    ds_read_b128 v[164:167], v6 offset:15360
    v_mfma_f32_16x16x32_bf16 v[128:131], v[192:195], a[140:143], v[128:131]
    v_mfma_f32_16x16x32_bf16 v[104:107], v[196:199], a[136:139], v[104:107]
    ds_read_b128 v[168:171], v6 offset:16384
    buffer_load_dwordx4 v[220:223], v1, s[28:31], s100 offen offset:1024 sc1
    v_mfma_f32_16x16x32_bf16 v[132:135], v[196:199], a[140:143], v[132:135]
    v_mfma_f32_16x16x32_bf16 v[108:111], v[200:203], a[136:139], v[108:111]
    ds_read_b128 v[172:175], v6 offset:17408
    v_mfma_f32_16x16x32_bf16 v[136:139], v[200:203], a[140:143], v[136:139]
    s_waitcnt lgkmcnt(4)
    v_mfma_f32_16x16x32_bf16 v[112:115], v[204:207], a[136:139], v[112:115]
    ds_read_b128 v[176:179], v6 offset:18432
    buffer_load_dwordx4 a[168:171], v1, s[28:31], s91 offen offset:1024 sc1
    v_mfma_f32_16x16x32_bf16 v[140:143], v[204:207], a[140:143], v[140:143]
    v_mfma_f32_16x16x32_bf16 v[116:119], v[208:211], a[136:139], v[116:119]
    ds_read_b128 v[180:183], v6 offset:19456
    v_mfma_f32_16x16x32_bf16 v[144:147], v[208:211], a[140:143], v[144:147]
    buffer_load_dwordx4 a[172:175], v95, s[28:31], s91 offen offset:1024 sc1
    v_mfma_f32_16x16x32_bf16 v[120:123], v[212:215], a[136:139], v[120:123]
    ds_read_b128 v[184:187], v6 offset:20480
    v_mfma_f32_16x16x32_bf16 v[148:151], v[212:215], a[140:143], v[148:151]
    s_waitcnt vmcnt(8) lgkmcnt(3)
    v_mfma_f32_16x16x32_bf16 v[96:99], v[160:163], a[144:147], v[96:99]
    ds_read_b128 v[188:191], v6 offset:21504
    v_mfma_f32_16x16x32_bf16 v[124:127], v[160:163], a[148:151], v[124:127]
    buffer_load_dwordx4 a[176:179], v1, s[28:31], s91 offen offset:2048 sc1
    v_mfma_f32_16x16x32_bf16 v[100:103], v[164:167], a[144:147], v[100:103]
    ds_read_b128 v[192:195], v6 offset:22528
    v_mfma_f32_16x16x32_bf16 v[128:131], v[164:167], a[148:151], v[128:131]
    v_mfma_f32_16x16x32_bf16 v[104:107], v[168:171], a[144:147], v[104:107]
    ds_read_b128 v[196:199], v6 offset:23552
    buffer_load_dwordx4 a[180:183], v95, s[28:31], s91 offen offset:2048 sc1
    v_mfma_f32_16x16x32_bf16 v[132:135], v[168:171], a[148:151], v[132:135]
    v_mfma_f32_16x16x32_bf16 v[108:111], v[172:175], a[144:147], v[108:111]
    ds_read_b128 v[200:203], v6 offset:24576
    v_mfma_f32_16x16x32_bf16 v[136:139], v[172:175], a[148:151], v[136:139]
    s_waitcnt lgkmcnt(4)
    v_mfma_f32_16x16x32_bf16 v[112:115], v[176:179], a[144:147], v[112:115]
    ds_read_b128 v[204:207], v6 offset:25600
    buffer_load_dwordx4 a[184:187], v1, s[28:31], s91 offen offset:3072 sc1
    v_mfma_f32_16x16x32_bf16 v[140:143], v[176:179], a[148:151], v[140:143]
    v_mfma_f32_16x16x32_bf16 v[116:119], v[180:183], a[144:147], v[116:119]
    ds_read_b128 v[208:211], v6 offset:26624
    v_mfma_f32_16x16x32_bf16 v[144:147], v[180:183], a[148:151], v[144:147]
    buffer_load_dwordx4 a[188:191], v95, s[28:31], s91 offen offset:3072 sc1
    v_mfma_f32_16x16x32_bf16 v[120:123], v[184:187], a[144:147], v[120:123]
    ds_read_b128 v[212:215], v6 offset:27648
    v_mfma_f32_16x16x32_bf16 v[148:151], v[184:187], a[148:151], v[148:151]
    s_waitcnt vmcnt(10) lgkmcnt(3)
    v_mfma_f32_16x16x32_bf16 v[96:99], v[188:191], a[152:155], v[96:99]
    ds_read_b128 v[160:163], v6 offset:28672
    s_waitcnt vmcnt(7)
    v_add_f32 v216, v216, v218
    v_mfma_f32_16x16x32_bf16 v[124:127], v[188:191], a[156:159], v[124:127]
    buffer_load_dwordx4 a[192:195], v1, s[28:31], s92 offen offset:0 sc1
    s_waitcnt vmcnt(7)
    v_add_f32 v220, v220, v222
    v_mfma_f32_16x16x32_bf16 v[100:103], v[192:195], a[152:155], v[100:103]
    ds_read_b128 v[164:167], v6 offset:29696
    v_permlane16_swap_b32 v216, v220
    v_mfma_f32_16x16x32_bf16 v[128:131], v[192:195], a[156:159], v[128:131]
    v_add_f32 v216, v216, v220
    v_mov_b32 v220, v216
    v_mfma_f32_16x16x32_bf16 v[104:107], v[196:199], a[152:155], v[104:107]
    ds_read_b128 v[168:171], v6 offset:30720
    v_permlane32_swap_b32 v216, v220
    v_mfma_f32_16x16x32_bf16 v[132:135], v[196:199], a[156:159], v[132:135]
    buffer_load_dwordx4 a[196:199], v95, s[28:31], s92 offen offset:0 sc1
    v_add_f32 v216, v216, v220
    v_mfma_f32_16x16x32_bf16 v[108:111], v[200:203], a[152:155], v[108:111]
    ds_read_b128 v[172:175], v6 offset:31744
    v_mov_b32 v220, v216
    v_mfma_f32_16x16x32_bf16 v[136:139], v[200:203], a[156:159], v[136:139]
    s_nop 0
    v_permlane16_swap_b32 v216, v220
    s_waitcnt lgkmcnt(4)
    v_mfma_f32_16x16x32_bf16 v[112:115], v[204:207], a[152:155], v[112:115]
    ds_read_b128 v[176:179], v6 offset:32768
    v_mul_f32 v76, 0xbb000000, v216
    v_mfma_f32_16x16x32_bf16 v[140:143], v[204:207], a[156:159], v[140:143]
    v_mul_f32 v77, 0xbb000000, v220
    v_mfma_f32_16x16x32_bf16 v[116:119], v[208:211], a[152:155], v[116:119]
    ds_read_b128 v[180:183], v6 offset:33792
    buffer_load_dwordx4 a[200:203], v1, s[28:31], s92 offen offset:1024 sc1
    v_mfma_f32_16x16x32_bf16 v[144:147], v[208:211], a[156:159], v[144:147]
    v_mfma_f32_16x16x32_bf16 v[120:123], v[212:215], a[152:155], v[120:123]
    ds_read_b128 v[184:187], v6 offset:34816
    v_mfma_f32_16x16x32_bf16 v[148:151], v[212:215], a[156:159], v[148:151]
    s_waitcnt lgkmcnt(3)
    v_mfma_f32_16x16x32_bf16 v[96:99], v[160:163], a[160:163], v[96:99]
    ds_read_b128 v[188:191], v6 offset:35840
    v_mfma_f32_16x16x32_bf16 v[124:127], v[160:163], a[164:167], v[124:127]
    buffer_load_dwordx4 a[204:207], v95, s[28:31], s92 offen offset:1024 sc1
    v_mfma_f32_16x16x32_bf16 v[100:103], v[164:167], a[160:163], v[100:103]
    ds_read_b128 v[192:195], v6 offset:36864
    v_mfma_f32_16x16x32_bf16 v[128:131], v[164:167], a[164:167], v[128:131]
    v_mfma_f32_16x16x32_bf16 v[104:107], v[168:171], a[160:163], v[104:107]
    ds_read_b128 v[196:199], v6 offset:37888
    v_fmac_f32 v96, v76, v228
    v_mfma_f32_16x16x32_bf16 v[132:135], v[168:171], a[164:167], v[132:135]
    buffer_load_dwordx4 a[208:211], v1, s[28:31], s92 offen offset:2048 sc1
    v_fmac_f32 v97, v76, v229
    v_mfma_f32_16x16x32_bf16 v[108:111], v[172:175], a[160:163], v[108:111]
    ds_read_b128 v[200:203], v6 offset:38912
    v_fmac_f32 v98, v76, v230
    v_mfma_f32_16x16x32_bf16 v[136:139], v[172:175], a[164:167], v[136:139]
    v_fmac_f32 v99, v76, v231
    s_waitcnt lgkmcnt(4)
    v_mfma_f32_16x16x32_bf16 v[112:115], v[176:179], a[160:163], v[112:115]
    ds_read_b128 v[204:207], v6 offset:39936
    v_fmac_f32 v124, v77, v228
    v_mfma_f32_16x16x32_bf16 v[140:143], v[176:179], a[164:167], v[140:143]
    v_fmac_f32 v125, v77, v229
    v_fmac_f32 v126, v77, v230
    v_mfma_f32_16x16x32_bf16 v[116:119], v[180:183], a[160:163], v[116:119]
    ds_read_b128 v[208:211], v6 offset:40960
    buffer_load_dwordx4 a[212:215], v95, s[28:31], s92 offen offset:2048 sc1
    v_mfma_f32_16x16x32_bf16 v[144:147], v[180:183], a[164:167], v[144:147]
    v_fmac_f32 v127, v77, v231
    v_fmac_f32 v100, v76, v232
    v_mfma_f32_16x16x32_bf16 v[120:123], v[184:187], a[160:163], v[120:123]
    ds_read_b128 v[212:215], v6 offset:41984
    v_fmac_f32 v101, v76, v233
    v_mfma_f32_16x16x32_bf16 v[148:151], v[184:187], a[164:167], v[148:151]
    s_waitcnt vmcnt(10) lgkmcnt(3)
    v_mfma_f32_16x16x32_bf16 v[96:99], v[188:191], a[168:171], v[96:99]
    ds_read_b128 v[160:163], v6 offset:43008
    v_fmac_f32 v107, v76, v239
    v_mfma_f32_16x16x32_bf16 v[124:127], v[188:191], a[172:175], v[124:127]
    buffer_load_dwordx4 a[216:219], v1, s[28:31], s92 offen offset:3072 sc1
    v_mfma_f32_16x16x32_bf16 v[100:103], v[192:195], a[168:171], v[100:103]
    ds_read_b128 v[164:167], v6 offset:44032
    v_mfma_f32_16x16x32_bf16 v[128:131], v[192:195], a[172:175], v[128:131]
    v_mfma_f32_16x16x32_bf16 v[104:107], v[196:199], a[168:171], v[104:107]
    ds_read_b128 v[168:171], v6 offset:45056
    v_mfma_f32_16x16x32_bf16 v[132:135], v[196:199], a[172:175], v[132:135]
    buffer_load_dwordx4 a[220:223], v95, s[28:31], s92 offen offset:3072 sc1
    v_mfma_f32_16x16x32_bf16 v[108:111], v[200:203], a[168:171], v[108:111]
    ds_read_b128 v[172:175], v6 offset:46080
    v_fmac_f32 v102, v76, v234
    v_mfma_f32_16x16x32_bf16 v[136:139], v[200:203], a[172:175], v[136:139]
    v_fmac_f32 v103, v76, v235
    s_waitcnt lgkmcnt(4)
    v_mfma_f32_16x16x32_bf16 v[112:115], v[204:207], a[168:171], v[112:115]
    ds_read_b128 v[176:179], v6 offset:47104
    v_fmac_f32 v128, v77, v232
    v_mfma_f32_16x16x32_bf16 v[140:143], v[204:207], a[172:175], v[140:143]
    v_fmac_f32 v129, v77, v233
    v_fmac_f32 v130, v77, v234
    v_mfma_f32_16x16x32_bf16 v[116:119], v[208:211], a[168:171], v[116:119]
    ds_read_b128 v[180:183], v6 offset:48128
    buffer_load_dwordx4 a[224:227], v1, s[28:31], s93 offen offset:0 sc1
    v_mfma_f32_16x16x32_bf16 v[144:147], v[208:211], a[172:175], v[144:147]
    v_fmac_f32 v131, v77, v235
    v_fmac_f32 v104, v76, v236
    v_mfma_f32_16x16x32_bf16 v[120:123], v[212:215], a[168:171], v[120:123]
    ds_read_b128 v[184:187], v6 offset:49152
    v_fmac_f32 v105, v76, v237
    v_mfma_f32_16x16x32_bf16 v[148:151], v[212:215], a[172:175], v[148:151]
    v_fmac_f32 v106, v76, v238
    s_waitcnt vmcnt(11) lgkmcnt(3)
    v_mfma_f32_16x16x32_bf16 v[96:99], v[160:163], a[176:179], v[96:99]
    ds_read_b128 v[188:191], v6 offset:50176
    v_fmac_f32 v110, v76, v242
    v_mfma_f32_16x16x32_bf16 v[124:127], v[160:163], a[180:183], v[124:127]
    buffer_load_dwordx4 a[228:231], v95, s[28:31], s93 offen offset:0 sc1
    v_fmac_f32 v111, v76, v243
    v_mfma_f32_16x16x32_bf16 v[100:103], v[164:167], a[176:179], v[100:103]
    ds_read_b128 v[192:195], v6 offset:51200
    v_fmac_f32 v136, v77, v240
    v_mfma_f32_16x16x32_bf16 v[128:131], v[164:167], a[180:183], v[128:131]
    v_fmac_f32 v137, v77, v241
    v_mfma_f32_16x16x32_bf16 v[104:107], v[168:171], a[176:179], v[104:107]
    ds_read_b128 v[196:199], v6 offset:52224
    v_mfma_f32_16x16x32_bf16 v[132:135], v[168:171], a[180:183], v[132:135]
    buffer_load_dwordx4 a[232:235], v1, s[28:31], s93 offen offset:1024 sc1
    v_mfma_f32_16x16x32_bf16 v[108:111], v[172:175], a[176:179], v[108:111]
    ds_read_b128 v[200:203], v6 offset:53248
    v_mfma_f32_16x16x32_bf16 v[136:139], v[172:175], a[180:183], v[136:139]
    s_waitcnt lgkmcnt(4)
    v_mfma_f32_16x16x32_bf16 v[112:115], v[176:179], a[176:179], v[112:115]
    ds_read_b128 v[204:207], v6 offset:54272
    v_mfma_f32_16x16x32_bf16 v[140:143], v[176:179], a[180:183], v[140:143]
    v_fmac_f32 v132, v77, v236
    v_fmac_f32 v133, v77, v237
    v_mfma_f32_16x16x32_bf16 v[116:119], v[180:183], a[176:179], v[116:119]
    ds_read_b128 v[208:211], v6 offset:55296
    buffer_load_dwordx4 a[236:239], v95, s[28:31], s93 offen offset:1024 sc1
    v_mfma_f32_16x16x32_bf16 v[144:147], v[180:183], a[180:183], v[144:147]
    v_fmac_f32 v134, v77, v238
    v_fmac_f32 v135, v77, v239
    v_mfma_f32_16x16x32_bf16 v[120:123], v[184:187], a[176:179], v[120:123]
    ds_read_b128 v[212:215], v6 offset:56320
    v_fmac_f32 v108, v76, v240
    v_mfma_f32_16x16x32_bf16 v[148:151], v[184:187], a[180:183], v[148:151]
    v_fmac_f32 v109, v76, v241
    s_waitcnt vmcnt(12) lgkmcnt(3)
    v_mfma_f32_16x16x32_bf16 v[96:99], v[188:191], a[184:187], v[96:99]
    ds_read_b128 v[160:163], v6 offset:57344
    v_fmac_f32 v114, v76, v246
    v_mfma_f32_16x16x32_bf16 v[124:127], v[188:191], a[188:191], v[124:127]
    buffer_load_dwordx4 a[240:243], v1, s[28:31], s93 offen offset:2048 sc1
    v_fmac_f32 v115, v76, v247
    v_mfma_f32_16x16x32_bf16 v[100:103], v[192:195], a[184:187], v[100:103]
    ds_read_b128 v[164:167], v6 offset:58368
    v_fmac_f32 v140, v77, v244
    v_mfma_f32_16x16x32_bf16 v[128:131], v[192:195], a[188:191], v[128:131]
    v_fmac_f32 v141, v77, v245
    v_fmac_f32 v142, v77, v246
    v_mfma_f32_16x16x32_bf16 v[104:107], v[196:199], a[184:187], v[104:107]
    ds_read_b128 v[168:171], v6 offset:59392
    v_fmac_f32 v143, v77, v247
    v_mfma_f32_16x16x32_bf16 v[132:135], v[196:199], a[188:191], v[132:135]
    buffer_load_dwordx4 a[244:247], v95, s[28:31], s93 offen offset:2048 sc1
    v_mfma_f32_16x16x32_bf16 v[108:111], v[200:203], a[184:187], v[108:111]
    ds_read_b128 v[172:175], v6 offset:60416
    v_mfma_f32_16x16x32_bf16 v[136:139], v[200:203], a[188:191], v[136:139]
    s_waitcnt lgkmcnt(4)
    v_mfma_f32_16x16x32_bf16 v[112:115], v[204:207], a[184:187], v[112:115]
    ds_read_b128 v[176:179], v6 offset:61440
    v_mfma_f32_16x16x32_bf16 v[140:143], v[204:207], a[188:191], v[140:143]
    v_mfma_f32_16x16x32_bf16 v[116:119], v[208:211], a[184:187], v[116:119]
    ds_read_b128 v[180:183], v6 offset:62464
    buffer_load_dwordx4 a[248:251], v1, s[28:31], s93 offen offset:3072 sc1
    v_mfma_f32_16x16x32_bf16 v[144:147], v[208:211], a[188:191], v[144:147]
    v_fmac_f32 v138, v77, v242
    v_fmac_f32 v139, v77, v243
    v_mfma_f32_16x16x32_bf16 v[120:123], v[212:215], a[184:187], v[120:123]
    ds_read_b128 v[184:187], v6 offset:63488
    v_fmac_f32 v112, v76, v244
    v_mfma_f32_16x16x32_bf16 v[148:151], v[212:215], a[188:191], v[148:151]
    v_fmac_f32 v113, v76, v245
    s_waitcnt vmcnt(13) lgkmcnt(3)
    v_mfma_f32_16x16x32_bf16 v[96:99], v[160:163], a[192:195], v[96:99]
    ds_read_b128 v[188:191], v6 offset:64512
    s_barrier
    v_mfma_f32_16x16x32_bf16 v[124:127], v[160:163], a[196:199], v[124:127]
    buffer_load_dwordx4 a[252:255], v95, s[28:31], s93 offen offset:3072 sc1
    v_fmac_f32 v116, v76, v248
    v_mfma_f32_16x16x32_bf16 v[100:103], v[164:167], a[192:195], v[100:103]
    ds_read_b128 v[192:195], v7 offset:0
    v_fmac_f32 v117, v76, v249
    v_mfma_f32_16x16x32_bf16 v[128:131], v[164:167], a[196:199], v[128:131]
    v_fmac_f32 v118, v76, v250
    v_fmac_f32 v119, v76, v251
    v_mfma_f32_16x16x32_bf16 v[104:107], v[168:171], a[192:195], v[104:107]
    ds_read_b128 v[196:199], v7 offset:1024
    v_fmac_f32 v144, v77, v248
    v_mfma_f32_16x16x32_bf16 v[132:135], v[168:171], a[196:199], v[132:135]
    buffer_load_dwordx4 v[224:227], v1, s[28:31], s101 offen sc1
    v_fmac_f32 v145, v77, v249
    v_mfma_f32_16x16x32_bf16 v[108:111], v[172:175], a[192:195], v[108:111]
    ds_read_b128 v[200:203], v7 offset:2048
    v_fmac_f32 v146, v77, v250
    v_mfma_f32_16x16x32_bf16 v[136:139], v[172:175], a[196:199], v[136:139]
    v_fmac_f32 v147, v77, v251
    s_waitcnt lgkmcnt(4)
    v_mfma_f32_16x16x32_bf16 v[112:115], v[176:179], a[192:195], v[112:115]
    ds_read_b128 v[204:207], v7 offset:3072
    v_mfma_f32_16x16x32_bf16 v[140:143], v[176:179], a[196:199], v[140:143]
    s_add_u32 m0, s57, 114688
    s_add_u32 s76, s55, 0
    v_mfma_f32_16x16x32_bf16 v[116:119], v[180:183], a[192:195], v[116:119]
    ds_read_b128 v[208:211], v7 offset:4096
    buffer_load_dwordx4 v80, s[20:23], s76 offen lds
    v_mfma_f32_16x16x32_bf16 v[144:147], v[180:183], a[196:199], v[144:147]
    v_mfma_f32_16x16x32_bf16 v[120:123], v[184:187], a[192:195], v[120:123]
    ds_read_b128 v[212:215], v7 offset:5120
    v_mfma_f32_16x16x32_bf16 v[148:151], v[184:187], a[196:199], v[148:151]
    s_waitcnt vmcnt(14) lgkmcnt(3)
    v_mfma_f32_16x16x32_bf16 v[96:99], v[188:191], a[200:203], v[96:99]
    ds_read_b128 v[160:163], v7 offset:6144
    v_mfma_f32_16x16x32_bf16 v[124:127], v[188:191], a[204:207], v[124:127]
    buffer_load_dwordx4 v81, s[20:23], s76 offen offset:1024 lds
    v_mfma_f32_16x16x32_bf16 v[100:103], v[192:195], a[200:203], v[100:103]
    ds_read_b128 v[164:167], v7 offset:7168
    v_fmac_f32 v120, v76, v252
    v_mfma_f32_16x16x32_bf16 v[128:131], v[192:195], a[204:207], v[128:131]
    v_fmac_f32 v121, v76, v253
    v_fmac_f32 v122, v76, v254
    v_mfma_f32_16x16x32_bf16 v[104:107], v[196:199], a[200:203], v[104:107]
    ds_read_b128 v[168:171], v7 offset:8192
    v_fmac_f32 v123, v76, v255
    v_mfma_f32_16x16x32_bf16 v[132:135], v[196:199], a[204:207], v[132:135]
    buffer_load_dwordx4 v82, s[20:23], s76 offen offset:2048 lds
    v_fmac_f32 v148, v77, v252
    v_mfma_f32_16x16x32_bf16 v[108:111], v[200:203], a[200:203], v[108:111]
    ds_read_b128 v[172:175], v7 offset:9216
    v_fmac_f32 v149, v77, v253
    v_mfma_f32_16x16x32_bf16 v[136:139], v[200:203], a[204:207], v[136:139]
    v_fmac_f32 v150, v77, v254
    s_waitcnt lgkmcnt(4)
    v_mfma_f32_16x16x32_bf16 v[112:115], v[204:207], a[200:203], v[112:115]
    ds_read_b128 v[176:179], v7 offset:10240
    v_fmac_f32 v151, v77, v255
    v_mfma_f32_16x16x32_bf16 v[140:143], v[204:207], a[204:207], v[140:143]
    v_mfma_f32_16x16x32_bf16 v[116:119], v[208:211], a[200:203], v[116:119]
    ds_read_b128 v[180:183], v7 offset:11264
    buffer_load_dwordx4 v83, s[20:23], s76 offen offset:3072 lds
    v_mfma_f32_16x16x32_bf16 v[144:147], v[208:211], a[204:207], v[144:147]
    v_mfma_f32_16x16x32_bf16 v[120:123], v[212:215], a[200:203], v[120:123]
    ds_read_b128 v[184:187], v7 offset:12288
    v_mfma_f32_16x16x32_bf16 v[148:151], v[212:215], a[204:207], v[148:151]
    s_waitcnt vmcnt(15) lgkmcnt(3)
    v_mfma_f32_16x16x32_bf16 v[96:99], v[160:163], a[208:211], v[96:99]
    ds_read_b128 v[188:191], v7 offset:13312
    s_add_u32 m0, s57, 131072
    v_mfma_f32_16x16x32_bf16 v[124:127], v[160:163], a[212:215], v[124:127]
    s_add_u32 s76, s55, 65536
    buffer_load_dwordx4 v80, s[20:23], s76 offen lds
    v_mfma_f32_16x16x32_bf16 v[100:103], v[164:167], a[208:211], v[100:103]
    ds_read_b128 v[192:195], v7 offset:14336
    v_mfma_f32_16x16x32_bf16 v[128:131], v[164:167], a[212:215], v[128:131]
    v_mfma_f32_16x16x32_bf16 v[104:107], v[168:171], a[208:211], v[104:107]
    ds_read_b128 v[196:199], v7 offset:15360
    buffer_load_dwordx4 v81, s[20:23], s76 offen offset:1024 lds
    v_mfma_f32_16x16x32_bf16 v[132:135], v[168:171], a[212:215], v[132:135]
    v_mfma_f32_16x16x32_bf16 v[108:111], v[172:175], a[208:211], v[108:111]
    ds_read_b128 v[200:203], v7 offset:16384
    v_mfma_f32_16x16x32_bf16 v[136:139], v[172:175], a[212:215], v[136:139]
    s_waitcnt lgkmcnt(4)
    v_mfma_f32_16x16x32_bf16 v[112:115], v[176:179], a[208:211], v[112:115]
    ds_read_b128 v[204:207], v7 offset:17408
    buffer_load_dwordx4 v82, s[20:23], s76 offen offset:2048 lds
    v_mfma_f32_16x16x32_bf16 v[140:143], v[176:179], a[212:215], v[140:143]
    v_mfma_f32_16x16x32_bf16 v[116:119], v[180:183], a[208:211], v[116:119]
    ds_read_b128 v[208:211], v7 offset:18432
    v_mfma_f32_16x16x32_bf16 v[144:147], v[180:183], a[212:215], v[144:147]
    buffer_load_dwordx4 v83, s[20:23], s76 offen offset:3072 lds
    v_mfma_f32_16x16x32_bf16 v[120:123], v[184:187], a[208:211], v[120:123]
    ds_read_b128 v[212:215], v7 offset:19456
    v_mfma_f32_16x16x32_bf16 v[148:151], v[184:187], a[212:215], v[148:151]
    s_waitcnt vmcnt(17) lgkmcnt(3)
    v_mfma_f32_16x16x32_bf16 v[96:99], v[188:191], a[216:219], v[96:99]
    ds_read_b128 v[160:163], v7 offset:20480
    s_add_u32 m0, s57, 0
    v_mfma_f32_16x16x32_bf16 v[124:127], v[188:191], a[220:223], v[124:127]
    s_add_u32 s76, s55, 131072
    buffer_load_dwordx4 v80, s[20:23], s76 offen lds
    v_mfma_f32_16x16x32_bf16 v[100:103], v[192:195], a[216:219], v[100:103]
    ds_read_b128 v[164:167], v7 offset:21504
    s_waitcnt vmcnt(9)
    v_add_f32 v224, v224, v226
    v_mfma_f32_16x16x32_bf16 v[128:131], v[192:195], a[220:223], v[128:131]
    v_add_f32 v225, v225, v227
    s_nop 1
    v_permlane16_swap_b32 v224, v225
    v_mfma_f32_16x16x32_bf16 v[104:107], v[196:199], a[216:219], v[104:107]
    ds_read_b128 v[168:171], v7 offset:22528
    buffer_load_dwordx4 v81, s[20:23], s76 offen offset:1024 lds
    v_mfma_f32_16x16x32_bf16 v[132:135], v[196:199], a[220:223], v[132:135]
    v_add_f32 v224, v224, v225
    v_mov_b32 v225, v224
    v_mfma_f32_16x16x32_bf16 v[108:111], v[200:203], a[216:219], v[108:111]
    ds_read_b128 v[172:175], v7 offset:23552
    v_permlane32_swap_b32 v224, v225
    v_mfma_f32_16x16x32_bf16 v[136:139], v[200:203], a[220:223], v[136:139]
    v_add_f32 v224, v224, v225
    s_waitcnt lgkmcnt(4)
    v_mfma_f32_16x16x32_bf16 v[112:115], v[204:207], a[216:219], v[112:115]
    ds_read_b128 v[176:179], v7 offset:27648
    buffer_load_dwordx4 v82, s[20:23], s76 offen offset:2048 lds
    v_mfma_f32_16x16x32_bf16 v[140:143], v[204:207], a[220:223], v[140:143]
    v_mov_b32 v225, v224
    s_nop 1
    v_permlane16_swap_b32 v224, v225
    v_mfma_f32_16x16x32_bf16 v[116:119], v[208:211], a[216:219], v[116:119]
    ds_read_b128 v[180:183], v7 offset:28672
    v_mul_f32 v226, 0xbb000000, v224
    v_mfma_f32_16x16x32_bf16 v[144:147], v[208:211], a[220:223], v[144:147]
    buffer_load_dwordx4 v83, s[20:23], s76 offen offset:3072 lds
    v_mul_f32 v225, s89, v225
    v_mfma_f32_16x16x32_bf16 v[120:123], v[212:215], a[216:219], v[120:123]
    ds_read_b128 v[184:187], v7 offset:29696
    v_fma_f32 v225, -v226, v226, v225
    v_mfma_f32_16x16x32_bf16 v[148:151], v[212:215], a[220:223], v[148:151]
    ds_read_b128 v[152:155], v7 offset:30720
    s_waitcnt lgkmcnt(4)
    v_mfma_f32_16x16x32_bf16 v[96:99], v[160:163], a[224:227], v[96:99]
    ds_read_b128 v[188:191], v7 offset:34816
    s_barrier
    v_mfma_f32_16x16x32_bf16 v[124:127], v[160:163], a[228:231], v[124:127]
    s_add_u32 m0, s57, 16384
    s_add_u32 s76, s55, 196608
    buffer_load_dwordx4 v80, s[20:23], s76 offen lds
    v_mfma_f32_16x16x32_bf16 v[100:103], v[164:167], a[224:227], v[100:103]
    ds_read_b128 v[192:195], v7 offset:35840
    v_max_f32 v225, 0, v225
    v_mfma_f32_16x16x32_bf16 v[128:131], v[164:167], a[228:231], v[128:131]
    v_add_f32 v225, s88, v225
    v_rsq_f32 v72, v225
    v_mfma_f32_16x16x32_bf16 v[104:107], v[168:171], a[224:227], v[104:107]
    ds_read_b128 v[196:199], v7 offset:36864
    buffer_load_dwordx4 v81, s[20:23], s76 offen offset:1024 lds
    v_mfma_f32_16x16x32_bf16 v[132:135], v[168:171], a[228:231], v[132:135]
    v_mfma_f32_16x16x32_bf16 v[108:111], v[172:175], a[224:227], v[108:111]
    ds_read_b128 v[200:203], v7 offset:37888
    v_mfma_f32_16x16x32_bf16 v[136:139], v[172:175], a[228:231], v[136:139]
    s_waitcnt lgkmcnt(4)
    v_mfma_f32_16x16x32_bf16 v[96:99], v[176:179], a[232:235], v[96:99]
    ds_read_b128 v[204:207], v7 offset:41984
    buffer_load_dwordx4 v82, s[20:23], s76 offen offset:2048 lds
    v_mfma_f32_16x16x32_bf16 v[124:127], v[176:179], a[236:239], v[124:127]
    v_mfma_f32_16x16x32_bf16 v[100:103], v[180:183], a[232:235], v[100:103]
    ds_read_b128 v[208:211], v7 offset:43008
    v_mfma_f32_16x16x32_bf16 v[128:131], v[180:183], a[236:239], v[128:131]
    buffer_load_dwordx4 v83, s[20:23], s76 offen offset:3072 lds
    v_mfma_f32_16x16x32_bf16 v[104:107], v[184:187], a[232:235], v[104:107]
    ds_read_b128 v[212:215], v7 offset:44032
    v_mfma_f32_16x16x32_bf16 v[132:135], v[184:187], a[236:239], v[132:135]
    v_mfma_f32_16x16x32_bf16 v[108:111], v[152:155], a[232:235], v[108:111]
    ds_read_b128 v[156:159], v7 offset:45056
    v_mfma_f32_16x16x32_bf16 v[136:139], v[152:155], a[236:239], v[136:139]
    s_waitcnt lgkmcnt(4)
    v_mfma_f32_16x16x32_bf16 v[96:99], v[188:191], a[240:243], v[96:99]
    ds_read_b128 v[160:163], v7 offset:24576
    s_add_u32 m0, s57, 32768
    v_mfma_f32_16x16x32_bf16 v[124:127], v[188:191], a[244:247], v[124:127]
    s_add_u32 s76, s55, 262144
    buffer_load_dwordx4 v80, s[20:23], s76 offen lds
    v_mfma_f32_16x16x32_bf16 v[100:103], v[192:195], a[240:243], v[100:103]
    ds_read_b128 v[164:167], v7 offset:25600
    v_mfma_f32_16x16x32_bf16 v[128:131], v[192:195], a[244:247], v[128:131]
    v_mfma_f32_16x16x32_bf16 v[104:107], v[196:199], a[240:243], v[104:107]
    ds_read_b128 v[168:171], v7 offset:26624
    buffer_load_dwordx4 v81, s[20:23], s76 offen offset:1024 lds
    v_mfma_f32_16x16x32_bf16 v[132:135], v[196:199], a[244:247], v[132:135]
    v_mfma_f32_16x16x32_bf16 v[108:111], v[200:203], a[240:243], v[108:111]
    ds_read_b128 v[172:175], v7 offset:31744
    v_mfma_f32_16x16x32_bf16 v[136:139], v[200:203], a[244:247], v[136:139]
    s_waitcnt lgkmcnt(4)
    v_mfma_f32_16x16x32_bf16 v[96:99], v[204:207], a[248:251], v[96:99]
    ds_read_b128 v[176:179], v7 offset:32768
    buffer_load_dwordx4 v82, s[20:23], s76 offen offset:2048 lds
    v_mfma_f32_16x16x32_bf16 v[124:127], v[204:207], a[252:255], v[124:127]
    v_mfma_f32_16x16x32_bf16 v[100:103], v[208:211], a[248:251], v[100:103]
    ds_read_b128 v[180:183], v7 offset:33792
    v_mfma_f32_16x16x32_bf16 v[128:131], v[208:211], a[252:255], v[128:131]
    buffer_load_dwordx4 v83, s[20:23], s76 offen offset:3072 lds
    v_mfma_f32_16x16x32_bf16 v[104:107], v[212:215], a[248:251], v[104:107]
    v_mfma_f32_16x16x32_bf16 v[132:135], v[212:215], a[252:255], v[132:135]
    v_mfma_f32_16x16x32_bf16 v[108:111], v[156:159], a[248:251], v[108:111]
    v_mfma_f32_16x16x32_bf16 v[136:139], v[156:159], a[252:255], v[136:139]
    s_add_u32 s100, s45, s60
    s_add_u32 s101, s100, 57344
    s_waitcnt lgkmcnt(3)
    v_mfma_f32_16x16x32_bf16 v[112:115], v[160:163], a[224:227], v[112:115]
    ds_read_b128 v[188:191], v7 offset:38912
    s_add_u32 m0, s57, 49152
    v_mfma_f32_16x16x32_bf16 v[140:143], v[160:163], a[228:231], v[140:143]
    s_add_u32 s76, s55, 327680
    buffer_load_dwordx4 v80, s[20:23], s76 offen lds
    v_mfma_f32_16x16x32_bf16 v[116:119], v[164:167], a[224:227], v[116:119]
    ds_read_b128 v[192:195], v7 offset:39936
    v_cvt_pk_bf16_f32 v228, v96, v97
    v_mfma_f32_16x16x32_bf16 v[144:147], v[164:167], a[228:231], v[144:147]
    v_cvt_pk_bf16_f32 v229, v98, v99
    v_pk_max_i16 v228, v228, 0
    v_mfma_f32_16x16x32_bf16 v[120:123], v[168:171], a[224:227], v[120:123]
    ds_read_b128 v[196:199], v7 offset:40960
    buffer_load_dwordx4 v81, s[20:23], s76 offen offset:1024 lds
    v_mfma_f32_16x16x32_bf16 v[148:151], v[168:171], a[228:231], v[148:151]
    v_pk_max_i16 v229, v229, 0
    s_waitcnt lgkmcnt(3)
    v_mfma_f32_16x16x32_bf16 v[112:115], v[172:175], a[232:235], v[112:115]
    ds_read_b128 v[200:203], v7 offset:46080
    v_cvt_pk_bf16_f32 v230, v100, v101
    v_mfma_f32_16x16x32_bf16 v[140:143], v[172:175], a[236:239], v[140:143]
    v_cvt_pk_bf16_f32 v231, v102, v103
    v_pk_max_i16 v230, v230, 0
    v_mfma_f32_16x16x32_bf16 v[116:119], v[176:179], a[232:235], v[116:119]
    ds_read_b128 v[204:207], v7 offset:47104
    buffer_load_dwordx4 v82, s[20:23], s76 offen offset:2048 lds
    v_mfma_f32_16x16x32_bf16 v[144:147], v[176:179], a[236:239], v[144:147]
    v_pk_max_i16 v231, v231, 0
    v_cvt_pk_bf16_f32 v232, v104, v105
    v_mfma_f32_16x16x32_bf16 v[120:123], v[180:183], a[232:235], v[120:123]
    ds_read_b128 v[208:211], v7 offset:48128
    v_cvt_pk_bf16_f32 v233, v106, v107
    v_mfma_f32_16x16x32_bf16 v[148:151], v[180:183], a[236:239], v[148:151]
    buffer_load_dwordx4 v83, s[20:23], s76 offen offset:3072 lds
    s_waitcnt lgkmcnt(3)
    v_mfma_f32_16x16x32_bf16 v[112:115], v[188:191], a[240:243], v[112:115]
    s_add_u32 m0, s57, 65536
    s_add_u32 s76, s55, 393216
    v_mfma_f32_16x16x32_bf16 v[140:143], v[188:191], a[244:247], v[140:143]
    buffer_load_dwordx4 v80, s[20:23], s76 offen lds
    v_pk_max_i16 v232, v232, 0
    v_mfma_f32_16x16x32_bf16 v[116:119], v[192:195], a[240:243], v[116:119]
    v_pk_max_i16 v233, v233, 0
    v_cvt_pk_bf16_f32 v234, v108, v109
    v_mfma_f32_16x16x32_bf16 v[144:147], v[192:195], a[244:247], v[144:147]
    v_cvt_pk_bf16_f32 v235, v110, v111
    v_pk_max_i16 v234, v234, 0
    v_mfma_f32_16x16x32_bf16 v[120:123], v[196:199], a[240:243], v[120:123]
    buffer_load_dwordx4 v81, s[20:23], s76 offen offset:1024 lds
    v_pk_max_i16 v235, v235, 0
    v_mfma_f32_16x16x32_bf16 v[148:151], v[196:199], a[244:247], v[148:151]
    v_cvt_pk_bf16_f32 v236, v124, v125
    s_waitcnt lgkmcnt(0)
    v_mfma_f32_16x16x32_bf16 v[112:115], v[200:203], a[248:251], v[112:115]
    v_cvt_pk_bf16_f32 v237, v126, v127
    v_pk_max_i16 v236, v236, 0
    v_mfma_f32_16x16x32_bf16 v[140:143], v[200:203], a[252:255], v[140:143]
    v_pk_max_i16 v237, v237, 0
    v_cvt_pk_bf16_f32 v238, v128, v129
    v_mfma_f32_16x16x32_bf16 v[116:119], v[204:207], a[248:251], v[116:119]
    buffer_load_dwordx4 v82, s[20:23], s76 offen offset:2048 lds
    v_cvt_pk_bf16_f32 v239, v130, v131
    v_mfma_f32_16x16x32_bf16 v[144:147], v[204:207], a[252:255], v[144:147]
    v_pk_max_i16 v238, v238, 0
    v_pk_max_i16 v239, v239, 0
    v_mfma_f32_16x16x32_bf16 v[120:123], v[208:211], a[248:251], v[120:123]
    v_cvt_pk_bf16_f32 v240, v132, v133
    v_cvt_pk_bf16_f32 v241, v134, v135
    v_mfma_f32_16x16x32_bf16 v[148:151], v[208:211], a[252:255], v[148:151]
    buffer_load_dwordx4 v83, s[20:23], s76 offen offset:3072 lds
    v_pk_max_i16 v240, v240, 0
    v_pk_max_i16 v241, v241, 0
    v_cvt_pk_bf16_f32 v242, v136, v137
    v_cvt_pk_bf16_f32 v243, v138, v139
    v_pk_max_i16 v242, v242, 0
    v_pk_max_i16 v243, v243, 0
    s_cmp_lg_u32 s38, 0
    s_cbranch_scc1 ELSE_66045
    buffer_store_dwordx4 v[228:231], v1, s[28:31], s100 offen offset:0
    buffer_store_dwordx4 v[232:235], v1, s[28:31], s100 offen offset:1024
    buffer_store_dwordx4 v[236:239], v1, s[28:31], s101 offen offset:0
    buffer_store_dwordx4 v[240:243], v1, s[28:31], s101 offen offset:1024
    s_branch ENDIF_66046
ELSE_66045:
    buffer_store_dwordx4 v[228:231], v1, s[28:31], s100 offen offset:0 sc1
    buffer_store_dwordx4 v[232:235], v1, s[28:31], s100 offen offset:1024 sc1
    buffer_store_dwordx4 v[236:239], v1, s[28:31], s101 offen offset:0 sc1
    buffer_store_dwordx4 v[240:243], v1, s[28:31], s101 offen offset:1024 sc1
ENDIF_66046:
    s_barrier
    s_add_u32 m0, s57, 81920
    s_add_u32 s76, s55, 458752
    buffer_load_dwordx4 v80, s[20:23], s76 offen lds
    s_add_u32 s70, s45, s61
    s_add_u32 s71, s70, 57344
    v_cvt_pk_bf16_f32 v192, v112, v113
    v_cvt_pk_bf16_f32 v193, v114, v115
    v_pk_max_i16 v192, v192, 0
    v_pk_max_i16 v193, v193, 0
    v_cvt_pk_bf16_f32 v194, v116, v117
    v_cvt_pk_bf16_f32 v195, v118, v119
    v_pk_max_i16 v194, v194, 0
    v_pk_max_i16 v195, v195, 0
    v_cvt_pk_bf16_f32 v196, v120, v121
    v_cvt_pk_bf16_f32 v197, v122, v123
    v_pk_max_i16 v196, v196, 0
    v_pk_max_i16 v197, v197, 0
    s_cmp_lg_u32 s38, 0
    s_cbranch_scc1 ELSE_70047
    buffer_store_dwordx4 v[192:195], v1, s[28:31], s100 offen offset:2048
    buffer_store_dwordx2 v[196:197], v1, s[28:31], s70 offen
    s_branch ENDIF_70048
ELSE_70047:
    buffer_store_dwordx4 v[192:195], v1, s[28:31], s100 offen offset:2048 sc1
    buffer_store_dwordx2 v[196:197], v1, s[28:31], s70 offen sc1
ENDIF_70048:
    buffer_load_dwordx4 v81, s[20:23], s76 offen offset:1024 lds
    v_cvt_pk_bf16_f32 v208, v140, v141
    v_cvt_pk_bf16_f32 v209, v142, v143
    v_pk_max_i16 v208, v208, 0
    v_pk_max_i16 v209, v209, 0
    v_cvt_pk_bf16_f32 v210, v144, v145
    v_cvt_pk_bf16_f32 v211, v146, v147
    v_pk_max_i16 v210, v210, 0
    v_pk_max_i16 v211, v211, 0
    v_cvt_pk_bf16_f32 v212, v148, v149
    v_cvt_pk_bf16_f32 v213, v150, v151
    v_pk_max_i16 v212, v212, 0
    v_pk_max_i16 v213, v213, 0
    s_cmp_lg_u32 s38, 0
    s_cbranch_scc1 ELSE_74049
    buffer_store_dwordx4 v[208:211], v1, s[28:31], s101 offen offset:2048
    buffer_store_dwordx2 v[212:213], v1, s[28:31], s71 offen
    s_branch ENDIF_74050
ELSE_74049:
    buffer_store_dwordx4 v[208:211], v1, s[28:31], s101 offen offset:2048 sc1
    buffer_store_dwordx2 v[212:213], v1, s[28:31], s71 offen sc1
ENDIF_74050:
    buffer_load_dwordx4 v82, s[20:23], s76 offen offset:2048 lds
    buffer_load_dwordx4 v83, s[20:23], s76 offen offset:3072 lds
    s_add_u32 m0, s57, 98304
    s_add_u32 s76, s55, 524288
    buffer_load_dwordx4 v80, s[20:23], s76 offen lds
    buffer_load_dwordx4 v81, s[20:23], s76 offen offset:1024 lds
    buffer_load_dwordx4 v82, s[20:23], s76 offen offset:2048 lds
    buffer_load_dwordx4 v83, s[20:23], s76 offen offset:3072 lds
    s_add_u32 s68, s39, 56
    v_mov_b32 v216, s68
    v_mov_b32 v217, s40
    s_waitcnt vmcnt(6)
    s_mov_b64 exec, 1
    s_cmp_lg_u32 s38, 0
    s_cbranch_scc1 ELSE_78051
    buffer_store_dwordx2 v[216:217], off, s[28:31], s41
    s_branch ENDIF_78052
ELSE_78051:
    buffer_store_dwordx2 v[216:217], off, s[28:31], s41 sc1
ENDIF_78052:
    s_mov_b64 exec, -1
    s_and_b32 s72, s36, 1
    s_mul_i32 s72, s72, 28672
    s_add_u32 s72, s72, s45
    s_mul_i32 s90, s62, 57344
    s_add_u32 s90, s90, s72
    s_xor_b32 s73, s62, 1
    s_mul_i32 s91, s73, 57344
    s_add_u32 s91, s91, s72
    s_add_u32 s45, s45, s47
    v_add_u32 v222, 56, v20
    s_mov_b32 s80, 0
    s_mov_b64 exec, s[0:1]
    buffer_load_dwordx2 v[152:153], v22, s[28:31], 0 offen sc1
    s_waitcnt vmcnt(0)
    s_nop 0
POLL_78054:
    buffer_load_dwordx2 v[154:155], v22, s[28:31], 0 offen sc1
    s_waitcnt vmcnt(1)
    v_sub_u32 v152, v152, v222
    v_cmp_eq_u32_e64 s[82:83], v153, v21
    v_cmp_gt_u32 vcc, 72, v152
    s_nop 1
    s_and_b64 vcc, vcc, s[82:83]
    s_cmp_eq_u64 vcc, exec
    s_cbranch_scc1 PDONE_78053
    buffer_load_dwordx2 v[152:153], v22, s[28:31], 0 offen sc1
    s_waitcnt vmcnt(1)
    v_sub_u32 v154, v154, v222
    v_cmp_eq_u32_e64 s[82:83], v155, v21
    v_cmp_gt_u32 vcc, 72, v154
    s_nop 1
    s_and_b64 vcc, vcc, s[82:83]
    s_cmp_eq_u64 vcc, exec
    s_cbranch_scc1 PDONE_78053
    s_add_u32 s80, s80, 1
    s_cmp_lt_u32 s80, 0x20000
    s_cbranch_scc1 POLL_78054
    s_branch L_END
PDONE_78053:
    s_mov_b64 exec, -1
    buffer_load_dwordx4 a[4:7], v1, s[28:31], s91 offen offset:0 sc1
    buffer_load_dwordx4 a[0:3], v1, s[28:31], s90 offen offset:0 sc1
    buffer_load_dwordx4 a[12:15], v1, s[28:31], s91 offen offset:1024 sc1
    buffer_load_dwordx4 a[8:11], v1, s[28:31], s90 offen offset:1024 sc1
    s_barrier
    ds_read_b64_tr_b16 v[160:161], v9 offset:49152
    ds_read_b64_tr_b16 v[162:163], v9 offset:57344
    ds_read_b64_tr_b16 v[164:165], v12 offset:49152
    ds_read_b64_tr_b16 v[166:167], v12 offset:57344
    ds_read_b64_tr_b16 v[168:169], v9 offset:50176
    ds_read_b64_tr_b16 v[170:171], v9 offset:58368
    ds_read_b64_tr_b16 v[172:173], v12 offset:50176
    ds_read_b64_tr_b16 v[174:175], v12 offset:58368
    buffer_load_dwordx4 a[20:23], v1, s[28:31], s91 offen offset:2048 sc1
    buffer_load_dwordx4 a[16:19], v1, s[28:31], s90 offen offset:2048 sc1
    ds_read_b64_tr_b16 v[176:177], v9 offset:51200
    ds_read_b64_tr_b16 v[178:179], v9 offset:59392
    ds_read_b64_tr_b16 v[180:181], v12 offset:51200
    ds_read_b64_tr_b16 v[182:183], v12 offset:59392
    ds_read_b64_tr_b16 v[184:185], v9 offset:52224
    ds_read_b64_tr_b16 v[186:187], v9 offset:60416
    ds_read_b64_tr_b16 v[188:189], v12 offset:52224
    ds_read_b64_tr_b16 v[190:191], v12 offset:60416
    buffer_load_dwordx4 a[28:31], v1, s[28:31], s91 offen offset:3072 sc1
    buffer_load_dwordx4 a[24:27], v1, s[28:31], s90 offen offset:3072 sc1
    s_waitcnt vmcnt(6) lgkmcnt(8)
    v_mfma_f32_16x16x32_bf16 v[112:115], v[160:163], a[4:7], 0
    ds_read_b64_tr_b16 v[192:193], v10 offset:0
    s_add_u32 s91, s91, 4096
    buffer_load_dwordx4 a[36:39], v1, s[28:31], s91 offen offset:0 sc1
    v_mfma_f32_16x16x32_bf16 v[116:119], v[164:167], a[4:7], 0
    ds_read_b64_tr_b16 v[194:195], v10 offset:8192
    s_add_u32 s90, s90, 4096
    v_mfma_f32_16x16x32_bf16 v[120:123], v[168:171], a[4:7], 0
    ds_read_b64_tr_b16 v[196:197], v13 offset:0
    buffer_load_dwordx4 a[32:35], v1, s[28:31], s90 offen offset:0 sc1
    v_mfma_f32_16x16x32_bf16 v[124:127], v[172:175], a[4:7], 0
    ds_read_b64_tr_b16 v[198:199], v13 offset:8192
    v_mfma_f32_16x16x32_bf16 v[96:99], v[160:163], a[0:3], 0
    ds_read_b64_tr_b16 v[200:201], v10 offset:1024
    buffer_load_dwordx4 a[44:47], v1, s[28:31], s91 offen offset:1024 sc1
    v_mfma_f32_16x16x32_bf16 v[100:103], v[164:167], a[0:3], 0
    ds_read_b64_tr_b16 v[202:203], v10 offset:9216
    v_mfma_f32_16x16x32_bf16 v[104:107], v[168:171], a[0:3], 0
    ds_read_b64_tr_b16 v[204:205], v13 offset:1024
    buffer_load_dwordx4 a[40:43], v1, s[28:31], s90 offen offset:1024 sc1
    v_mfma_f32_16x16x32_bf16 v[108:111], v[172:175], a[0:3], 0
    ds_read_b64_tr_b16 v[206:207], v13 offset:9216
    s_waitcnt vmcnt(8) lgkmcnt(8)
    v_mfma_f32_16x16x32_bf16 v[112:115], v[176:179], a[12:15], v[112:115]
    ds_read_b64_tr_b16 v[224:225], v10 offset:2048
    buffer_load_dwordx4 a[52:55], v1, s[28:31], s91 offen offset:2048 sc1
    v_mfma_f32_16x16x32_bf16 v[116:119], v[180:183], a[12:15], v[116:119]
    ds_read_b64_tr_b16 v[226:227], v10 offset:10240
    v_mfma_f32_16x16x32_bf16 v[120:123], v[184:187], a[12:15], v[120:123]
    ds_read_b64_tr_b16 v[228:229], v13 offset:2048
    buffer_load_dwordx4 a[48:51], v1, s[28:31], s90 offen offset:2048 sc1
    v_mfma_f32_16x16x32_bf16 v[124:127], v[188:191], a[12:15], v[124:127]
    ds_read_b64_tr_b16 v[230:231], v13 offset:10240
    v_mfma_f32_16x16x32_bf16 v[96:99], v[176:179], a[8:11], v[96:99]
    ds_read_b64_tr_b16 v[232:233], v10 offset:3072
    buffer_load_dwordx4 a[60:63], v1, s[28:31], s91 offen offset:3072 sc1
    v_mfma_f32_16x16x32_bf16 v[100:103], v[180:183], a[8:11], v[100:103]
    ds_read_b64_tr_b16 v[234:235], v10 offset:11264
    v_mfma_f32_16x16x32_bf16 v[104:107], v[184:187], a[8:11], v[104:107]
    ds_read_b64_tr_b16 v[236:237], v13 offset:3072
    buffer_load_dwordx4 a[56:59], v1, s[28:31], s90 offen offset:3072 sc1
    v_mfma_f32_16x16x32_bf16 v[108:111], v[188:191], a[8:11], v[108:111]
    ds_read_b64_tr_b16 v[238:239], v13 offset:11264
    s_waitcnt vmcnt(10) lgkmcnt(8)
    v_mfma_f32_16x16x32_bf16 v[112:115], v[192:195], a[20:23], v[112:115]
    ds_read_b64_tr_b16 v[160:161], v8 offset:0
    s_add_u32 s91, s91, 4096
    buffer_load_dwordx4 a[68:71], v1, s[28:31], s91 offen offset:0 sc1
    v_mfma_f32_16x16x32_bf16 v[116:119], v[196:199], a[20:23], v[116:119]
    ds_read_b64_tr_b16 v[162:163], v8 offset:8192
    s_add_u32 s90, s90, 4096
    v_mfma_f32_16x16x32_bf16 v[120:123], v[200:203], a[20:23], v[120:123]
    ds_read_b64_tr_b16 v[164:165], v11 offset:0
    buffer_load_dwordx4 a[64:67], v1, s[28:31], s90 offen offset:0 sc1
    v_mfma_f32_16x16x32_bf16 v[124:127], v[204:207], a[20:23], v[124:127]
    ds_read_b64_tr_b16 v[166:167], v11 offset:8192
    v_mfma_f32_16x16x32_bf16 v[96:99], v[192:195], a[16:19], v[96:99]
    ds_read_b64_tr_b16 v[168:169], v8 offset:1024
    buffer_load_dwordx4 a[76:79], v1, s[28:31], s91 offen offset:1024 sc1
    v_mfma_f32_16x16x32_bf16 v[100:103], v[196:199], a[16:19], v[100:103]
    ds_read_b64_tr_b16 v[170:171], v8 offset:9216
    v_mfma_f32_16x16x32_bf16 v[104:107], v[200:203], a[16:19], v[104:107]
    ds_read_b64_tr_b16 v[172:173], v11 offset:1024
    buffer_load_dwordx4 a[72:75], v1, s[28:31], s90 offen offset:1024 sc1
    v_mfma_f32_16x16x32_bf16 v[108:111], v[204:207], a[16:19], v[108:111]
    ds_read_b64_tr_b16 v[174:175], v11 offset:9216
    s_waitcnt vmcnt(12) lgkmcnt(8)
    v_mfma_f32_16x16x32_bf16 v[112:115], v[224:227], a[28:31], v[112:115]
    ds_read_b64_tr_b16 v[176:177], v8 offset:2048
    buffer_load_dwordx4 a[84:87], v1, s[28:31], s91 offen offset:2048 sc1
    v_mfma_f32_16x16x32_bf16 v[116:119], v[228:231], a[28:31], v[116:119]
    ds_read_b64_tr_b16 v[178:179], v8 offset:10240
    v_mfma_f32_16x16x32_bf16 v[120:123], v[232:235], a[28:31], v[120:123]
    ds_read_b64_tr_b16 v[180:181], v11 offset:2048
    v_mfma_f32_16x16x32_bf16 v[124:127], v[236:239], a[28:31], v[124:127]
    ds_read_b64_tr_b16 v[182:183], v11 offset:10240
    v_mfma_f32_16x16x32_bf16 v[96:99], v[224:227], a[24:27], v[96:99]
    ds_read_b64_tr_b16 v[184:185], v8 offset:3072
    buffer_load_dwordx4 a[80:83], v1, s[28:31], s90 offen offset:2048 sc1
    v_mfma_f32_16x16x32_bf16 v[100:103], v[228:231], a[24:27], v[100:103]
    ds_read_b64_tr_b16 v[186:187], v8 offset:11264
    v_mfma_f32_16x16x32_bf16 v[104:107], v[232:235], a[24:27], v[104:107]
    ds_read_b64_tr_b16 v[188:189], v11 offset:3072
    v_mfma_f32_16x16x32_bf16 v[108:111], v[236:239], a[24:27], v[108:111]
    ds_read_b64_tr_b16 v[190:191], v11 offset:11264
    s_waitcnt vmcnt(12) lgkmcnt(8)
    v_mfma_f32_16x16x32_bf16 v[112:115], v[160:163], a[36:39], v[112:115]
    ds_read_b64_tr_b16 v[192:193], v8 offset:16384
    buffer_load_dwordx4 a[92:95], v1, s[28:31], s91 offen offset:3072 sc1
    v_mfma_f32_16x16x32_bf16 v[116:119], v[164:167], a[36:39], v[116:119]
    ds_read_b64_tr_b16 v[194:195], v8 offset:24576
    v_mfma_f32_16x16x32_bf16 v[120:123], v[168:171], a[36:39], v[120:123]
    ds_read_b64_tr_b16 v[196:197], v11 offset:16384
    v_mfma_f32_16x16x32_bf16 v[124:127], v[172:175], a[36:39], v[124:127]
    ds_read_b64_tr_b16 v[198:199], v11 offset:24576
    v_mfma_f32_16x16x32_bf16 v[96:99], v[160:163], a[32:35], v[96:99]
    ds_read_b64_tr_b16 v[200:201], v8 offset:17408
    buffer_load_dwordx4 a[88:91], v1, s[28:31], s90 offen offset:3072 sc1
    v_mfma_f32_16x16x32_bf16 v[100:103], v[164:167], a[32:35], v[100:103]
    ds_read_b64_tr_b16 v[202:203], v8 offset:25600
    v_mfma_f32_16x16x32_bf16 v[104:107], v[168:171], a[32:35], v[104:107]
    ds_read_b64_tr_b16 v[204:205], v11 offset:17408
    v_mfma_f32_16x16x32_bf16 v[108:111], v[172:175], a[32:35], v[108:111]
    ds_read_b64_tr_b16 v[206:207], v11 offset:25600
    s_waitcnt vmcnt(12) lgkmcnt(8)
    s_barrier
    v_mfma_f32_16x16x32_bf16 v[112:115], v[176:179], a[44:47], v[112:115]
    ds_read_b64_tr_b16 v[224:225], v8 offset:18432
    s_add_u32 s91, s91, 4096
    buffer_load_dwordx4 a[100:103], v1, s[28:31], s91 offen offset:0 sc1
    v_mfma_f32_16x16x32_bf16 v[116:119], v[180:183], a[44:47], v[116:119]
    ds_read_b64_tr_b16 v[226:227], v8 offset:26624
    s_add_u32 s90, s90, 4096
    v_mfma_f32_16x16x32_bf16 v[120:123], v[184:187], a[44:47], v[120:123]
    ds_read_b64_tr_b16 v[228:229], v11 offset:18432
    buffer_load_dwordx4 a[96:99], v1, s[28:31], s90 offen offset:0 sc1
    v_mfma_f32_16x16x32_bf16 v[124:127], v[188:191], a[44:47], v[124:127]
    ds_read_b64_tr_b16 v[230:231], v11 offset:26624
    s_add_u32 m0, s57, 114688
    v_mfma_f32_16x16x32_bf16 v[96:99], v[176:179], a[40:43], v[96:99]
    ds_read_b64_tr_b16 v[232:233], v8 offset:19456
    s_add_u32 s76, s55, 589824
    buffer_load_dwordx4 v80, s[20:23], s76 offen lds
    v_mfma_f32_16x16x32_bf16 v[100:103], v[180:183], a[40:43], v[100:103]
    ds_read_b64_tr_b16 v[234:235], v8 offset:27648
    v_mfma_f32_16x16x32_bf16 v[104:107], v[184:187], a[40:43], v[104:107]
    ds_read_b64_tr_b16 v[236:237], v11 offset:19456
    buffer_load_dwordx4 v81, s[20:23], s76 offen offset:1024 lds
    v_mfma_f32_16x16x32_bf16 v[108:111], v[188:191], a[40:43], v[108:111]
    ds_read_b64_tr_b16 v[238:239], v11 offset:27648
    s_waitcnt vmcnt(14) lgkmcnt(8)
    v_mfma_f32_16x16x32_bf16 v[112:115], v[192:195], a[52:55], v[112:115]
    ds_read_b64_tr_b16 v[160:161], v8 offset:32768
    buffer_load_dwordx4 a[108:111], v1, s[28:31], s91 offen offset:1024 sc1
    v_mfma_f32_16x16x32_bf16 v[116:119], v[196:199], a[52:55], v[116:119]
    ds_read_b64_tr_b16 v[162:163], v8 offset:40960
    v_mfma_f32_16x16x32_bf16 v[120:123], v[200:203], a[52:55], v[120:123]
    ds_read_b64_tr_b16 v[164:165], v11 offset:32768
    buffer_load_dwordx4 a[104:107], v1, s[28:31], s90 offen offset:1024 sc1
    v_mfma_f32_16x16x32_bf16 v[124:127], v[204:207], a[52:55], v[124:127]
    ds_read_b64_tr_b16 v[166:167], v11 offset:40960
    v_mfma_f32_16x16x32_bf16 v[96:99], v[192:195], a[48:51], v[96:99]
    ds_read_b64_tr_b16 v[168:169], v8 offset:33792
    buffer_load_dwordx4 v82, s[20:23], s76 offen offset:2048 lds
    v_mfma_f32_16x16x32_bf16 v[100:103], v[196:199], a[48:51], v[100:103]
    ds_read_b64_tr_b16 v[170:171], v8 offset:41984
    v_mfma_f32_16x16x32_bf16 v[104:107], v[200:203], a[48:51], v[104:107]
    ds_read_b64_tr_b16 v[172:173], v11 offset:33792
    buffer_load_dwordx4 v83, s[20:23], s76 offen offset:3072 lds
    v_mfma_f32_16x16x32_bf16 v[108:111], v[204:207], a[48:51], v[108:111]
    ds_read_b64_tr_b16 v[174:175], v11 offset:41984
    s_waitcnt vmcnt(16) lgkmcnt(8)
    v_mfma_f32_16x16x32_bf16 v[112:115], v[224:227], a[60:63], v[112:115]
    ds_read_b64_tr_b16 v[176:177], v8 offset:34816
    buffer_load_dwordx4 a[116:119], v1, s[28:31], s91 offen offset:2048 sc1
    v_mfma_f32_16x16x32_bf16 v[116:119], v[228:231], a[60:63], v[116:119]
    ds_read_b64_tr_b16 v[178:179], v8 offset:43008
    v_mfma_f32_16x16x32_bf16 v[120:123], v[232:235], a[60:63], v[120:123]
    ds_read_b64_tr_b16 v[180:181], v11 offset:34816
    buffer_load_dwordx4 a[112:115], v1, s[28:31], s90 offen offset:2048 sc1
    v_mfma_f32_16x16x32_bf16 v[124:127], v[236:239], a[60:63], v[124:127]
    ds_read_b64_tr_b16 v[182:183], v11 offset:43008
    s_add_u32 m0, s57, 131072
    v_mfma_f32_16x16x32_bf16 v[96:99], v[224:227], a[56:59], v[96:99]
    ds_read_b64_tr_b16 v[184:185], v8 offset:35840
    s_add_u32 s76, s55, 655360
    buffer_load_dwordx4 v80, s[20:23], s76 offen lds
    v_mfma_f32_16x16x32_bf16 v[100:103], v[228:231], a[56:59], v[100:103]
    ds_read_b64_tr_b16 v[186:187], v8 offset:44032
    v_mfma_f32_16x16x32_bf16 v[104:107], v[232:235], a[56:59], v[104:107]
    ds_read_b64_tr_b16 v[188:189], v11 offset:35840
    buffer_load_dwordx4 v81, s[20:23], s76 offen offset:1024 lds
    v_mfma_f32_16x16x32_bf16 v[108:111], v[236:239], a[56:59], v[108:111]
    ds_read_b64_tr_b16 v[190:191], v11 offset:44032
    s_waitcnt vmcnt(18) lgkmcnt(8)
    v_mfma_f32_16x16x32_bf16 v[112:115], v[160:163], a[68:71], v[112:115]
    ds_read_b64_tr_b16 v[192:193], v8 offset:49152
    buffer_load_dwordx4 a[124:127], v1, s[28:31], s91 offen offset:3072 sc1
    v_mfma_f32_16x16x32_bf16 v[116:119], v[164:167], a[68:71], v[116:119]
    ds_read_b64_tr_b16 v[194:195], v8 offset:57344
    v_mfma_f32_16x16x32_bf16 v[120:123], v[168:171], a[68:71], v[120:123]
    ds_read_b64_tr_b16 v[196:197], v11 offset:49152
    buffer_load_dwordx4 a[120:123], v1, s[28:31], s90 offen offset:3072 sc1
    v_mfma_f32_16x16x32_bf16 v[124:127], v[172:175], a[68:71], v[124:127]
    ds_read_b64_tr_b16 v[198:199], v11 offset:57344
    v_mfma_f32_16x16x32_bf16 v[96:99], v[160:163], a[64:67], v[96:99]
    ds_read_b64_tr_b16 v[200:201], v8 offset:50176
    buffer_load_dwordx4 v82, s[20:23], s76 offen offset:2048 lds
    v_mfma_f32_16x16x32_bf16 v[100:103], v[164:167], a[64:67], v[100:103]
    ds_read_b64_tr_b16 v[202:203], v8 offset:58368
    v_mfma_f32_16x16x32_bf16 v[104:107], v[168:171], a[64:67], v[104:107]
    ds_read_b64_tr_b16 v[204:205], v11 offset:50176
    buffer_load_dwordx4 v83, s[20:23], s76 offen offset:3072 lds
    v_mfma_f32_16x16x32_bf16 v[108:111], v[172:175], a[64:67], v[108:111]
    ds_read_b64_tr_b16 v[206:207], v11 offset:58368
    s_waitcnt vmcnt(20) lgkmcnt(8)
    v_mfma_f32_16x16x32_bf16 v[112:115], v[176:179], a[76:79], v[112:115]
    ds_read_b64_tr_b16 v[224:225], v8 offset:51200
    s_add_u32 s91, s91, 4096
    buffer_load_dwordx4 a[132:135], v1, s[28:31], s91 offen offset:0 sc1
    v_mfma_f32_16x16x32_bf16 v[116:119], v[180:183], a[76:79], v[116:119]
    ds_read_b64_tr_b16 v[226:227], v8 offset:59392
    v_mfma_f32_16x16x32_bf16 v[120:123], v[184:187], a[76:79], v[120:123]
    ds_read_b64_tr_b16 v[228:229], v11 offset:51200
    v_mfma_f32_16x16x32_bf16 v[124:127], v[188:191], a[76:79], v[124:127]
    ds_read_b64_tr_b16 v[230:231], v11 offset:59392
    s_add_u32 s90, s90, 4096
    v_mfma_f32_16x16x32_bf16 v[96:99], v[176:179], a[72:75], v[96:99]
    ds_read_b64_tr_b16 v[232:233], v8 offset:52224
    buffer_load_dwordx4 a[128:131], v1, s[28:31], s90 offen offset:0 sc1
    v_mfma_f32_16x16x32_bf16 v[100:103], v[180:183], a[72:75], v[100:103]
    ds_read_b64_tr_b16 v[234:235], v8 offset:60416
    v_mfma_f32_16x16x32_bf16 v[104:107], v[184:187], a[72:75], v[104:107]
    ds_read_b64_tr_b16 v[236:237], v11 offset:52224
    v_mfma_f32_16x16x32_bf16 v[108:111], v[188:191], a[72:75], v[108:111]
    ds_read_b64_tr_b16 v[238:239], v11 offset:60416
    s_waitcnt vmcnt(20) lgkmcnt(8)
    v_mfma_f32_16x16x32_bf16 v[112:115], v[192:195], a[84:87], v[112:115]
    ds_read_b64_tr_b16 v[160:161], v9 offset:0
    buffer_load_dwordx4 a[140:143], v1, s[28:31], s91 offen offset:1024 sc1
    v_mfma_f32_16x16x32_bf16 v[116:119], v[196:199], a[84:87], v[116:119]
    ds_read_b64_tr_b16 v[162:163], v9 offset:8192
    v_mfma_f32_16x16x32_bf16 v[120:123], v[200:203], a[84:87], v[120:123]
    ds_read_b64_tr_b16 v[164:165], v12 offset:0
    v_mfma_f32_16x16x32_bf16 v[124:127], v[204:207], a[84:87], v[124:127]
    ds_read_b64_tr_b16 v[166:167], v12 offset:8192
    v_mfma_f32_16x16x32_bf16 v[96:99], v[192:195], a[80:83], v[96:99]
    ds_read_b64_tr_b16 v[168:169], v9 offset:1024
    buffer_load_dwordx4 a[136:139], v1, s[28:31], s90 offen offset:1024 sc1
    v_mfma_f32_16x16x32_bf16 v[100:103], v[196:199], a[80:83], v[100:103]
    ds_read_b64_tr_b16 v[170:171], v9 offset:9216
    v_mfma_f32_16x16x32_bf16 v[104:107], v[200:203], a[80:83], v[104:107]
    ds_read_b64_tr_b16 v[172:173], v12 offset:1024
    v_mfma_f32_16x16x32_bf16 v[108:111], v[204:207], a[80:83], v[108:111]
    ds_read_b64_tr_b16 v[174:175], v12 offset:9216
    s_waitcnt vmcnt(20) lgkmcnt(8)
    s_barrier
    v_mfma_f32_16x16x32_bf16 v[112:115], v[224:227], a[92:95], v[112:115]
    ds_read_b64_tr_b16 v[176:177], v9 offset:2048
    buffer_load_dwordx4 a[148:151], v1, s[28:31], s91 offen offset:2048 sc1
    v_mfma_f32_16x16x32_bf16 v[116:119], v[228:231], a[92:95], v[116:119]
    ds_read_b64_tr_b16 v[178:179], v9 offset:10240
    v_mfma_f32_16x16x32_bf16 v[120:123], v[232:235], a[92:95], v[120:123]
    ds_read_b64_tr_b16 v[180:181], v12 offset:2048
    buffer_load_dwordx4 a[144:147], v1, s[28:31], s90 offen offset:2048 sc1
    v_mfma_f32_16x16x32_bf16 v[124:127], v[236:239], a[92:95], v[124:127]
    ds_read_b64_tr_b16 v[182:183], v12 offset:10240
    s_add_u32 m0, s57, 0
    v_mfma_f32_16x16x32_bf16 v[96:99], v[224:227], a[88:91], v[96:99]
    ds_read_b64_tr_b16 v[184:185], v9 offset:3072
    s_add_u32 s76, s55, 720896
    buffer_load_dwordx4 v80, s[20:23], s76 offen lds
    v_mfma_f32_16x16x32_bf16 v[100:103], v[228:231], a[88:91], v[100:103]
    ds_read_b64_tr_b16 v[186:187], v9 offset:11264
    v_mfma_f32_16x16x32_bf16 v[104:107], v[232:235], a[88:91], v[104:107]
    ds_read_b64_tr_b16 v[188:189], v12 offset:3072
    buffer_load_dwordx4 v81, s[20:23], s76 offen offset:1024 lds
    v_mfma_f32_16x16x32_bf16 v[108:111], v[236:239], a[88:91], v[108:111]
    ds_read_b64_tr_b16 v[190:191], v12 offset:11264
    s_waitcnt vmcnt(22) lgkmcnt(8)
    v_mfma_f32_16x16x32_bf16 v[112:115], v[160:163], a[100:103], v[112:115]
    ds_read_b64_tr_b16 v[192:193], v9 offset:16384
    buffer_load_dwordx4 a[156:159], v1, s[28:31], s91 offen offset:3072 sc1
    v_mfma_f32_16x16x32_bf16 v[116:119], v[164:167], a[100:103], v[116:119]
    ds_read_b64_tr_b16 v[194:195], v9 offset:24576
    v_mfma_f32_16x16x32_bf16 v[120:123], v[168:171], a[100:103], v[120:123]
    ds_read_b64_tr_b16 v[196:197], v12 offset:16384
    buffer_load_dwordx4 a[152:155], v1, s[28:31], s90 offen offset:3072 sc1
    v_mfma_f32_16x16x32_bf16 v[124:127], v[172:175], a[100:103], v[124:127]
    ds_read_b64_tr_b16 v[198:199], v12 offset:24576
    v_mfma_f32_16x16x32_bf16 v[96:99], v[160:163], a[96:99], v[96:99]
    ds_read_b64_tr_b16 v[200:201], v9 offset:17408
    buffer_load_dwordx4 v82, s[20:23], s76 offen offset:2048 lds
    v_mfma_f32_16x16x32_bf16 v[100:103], v[164:167], a[96:99], v[100:103]
    ds_read_b64_tr_b16 v[202:203], v9 offset:25600
    v_mfma_f32_16x16x32_bf16 v[104:107], v[168:171], a[96:99], v[104:107]
    ds_read_b64_tr_b16 v[204:205], v12 offset:17408
    buffer_load_dwordx4 v83, s[20:23], s76 offen offset:3072 lds
    v_mfma_f32_16x16x32_bf16 v[108:111], v[172:175], a[96:99], v[108:111]
    ds_read_b64_tr_b16 v[206:207], v12 offset:25600
    s_waitcnt vmcnt(22) lgkmcnt(8)
    v_mfma_f32_16x16x32_bf16 v[112:115], v[176:179], a[108:111], v[112:115]
    ds_read_b64_tr_b16 v[224:225], v9 offset:18432
    s_add_u32 s91, s91, 4096
    buffer_load_dwordx4 a[164:167], v1, s[28:31], s91 offen offset:0 sc1
    v_mfma_f32_16x16x32_bf16 v[116:119], v[180:183], a[108:111], v[116:119]
    ds_read_b64_tr_b16 v[226:227], v9 offset:26624
    s_add_u32 s90, s90, 4096
    v_mfma_f32_16x16x32_bf16 v[120:123], v[184:187], a[108:111], v[120:123]
    ds_read_b64_tr_b16 v[228:229], v12 offset:18432
    buffer_load_dwordx4 a[160:163], v1, s[28:31], s90 offen offset:0 sc1
    v_mfma_f32_16x16x32_bf16 v[124:127], v[188:191], a[108:111], v[124:127]
    ds_read_b64_tr_b16 v[230:231], v12 offset:26624
    s_add_u32 m0, s57, 16384
    v_mfma_f32_16x16x32_bf16 v[96:99], v[176:179], a[104:107], v[96:99]
    ds_read_b64_tr_b16 v[232:233], v9 offset:19456
    s_add_u32 s76, s55, 786432
    buffer_load_dwordx4 v80, s[20:23], s76 offen lds
    v_mfma_f32_16x16x32_bf16 v[100:103], v[180:183], a[104:107], v[100:103]
    ds_read_b64_tr_b16 v[234:235], v9 offset:27648
    v_mfma_f32_16x16x32_bf16 v[104:107], v[184:187], a[104:107], v[104:107]
    ds_read_b64_tr_b16 v[236:237], v12 offset:19456
    buffer_load_dwordx4 v81, s[20:23], s76 offen offset:1024 lds
    v_mfma_f32_16x16x32_bf16 v[108:111], v[188:191], a[104:107], v[108:111]
    ds_read_b64_tr_b16 v[238:239], v12 offset:27648
    s_waitcnt vmcnt(22) lgkmcnt(8)
    v_mfma_f32_16x16x32_bf16 v[112:115], v[192:195], a[116:119], v[112:115]
    ds_read_b64_tr_b16 v[160:161], v9 offset:32768
    buffer_load_dwordx4 a[172:175], v1, s[28:31], s91 offen offset:1024 sc1
    v_mfma_f32_16x16x32_bf16 v[116:119], v[196:199], a[116:119], v[116:119]
    ds_read_b64_tr_b16 v[162:163], v9 offset:40960
    v_mfma_f32_16x16x32_bf16 v[120:123], v[200:203], a[116:119], v[120:123]
    ds_read_b64_tr_b16 v[164:165], v12 offset:32768
    buffer_load_dwordx4 a[168:171], v1, s[28:31], s90 offen offset:1024 sc1
    v_mfma_f32_16x16x32_bf16 v[124:127], v[204:207], a[116:119], v[124:127]
    ds_read_b64_tr_b16 v[166:167], v12 offset:40960
    v_mfma_f32_16x16x32_bf16 v[96:99], v[192:195], a[112:115], v[96:99]
    ds_read_b64_tr_b16 v[168:169], v9 offset:33792
    buffer_load_dwordx4 v82, s[20:23], s76 offen offset:2048 lds
    v_mfma_f32_16x16x32_bf16 v[100:103], v[196:199], a[112:115], v[100:103]
    ds_read_b64_tr_b16 v[170:171], v9 offset:41984
    v_mfma_f32_16x16x32_bf16 v[104:107], v[200:203], a[112:115], v[104:107]
    ds_read_b64_tr_b16 v[172:173], v12 offset:33792
    buffer_load_dwordx4 v83, s[20:23], s76 offen offset:3072 lds
    v_mfma_f32_16x16x32_bf16 v[108:111], v[204:207], a[112:115], v[108:111]
    ds_read_b64_tr_b16 v[174:175], v12 offset:41984
    s_waitcnt vmcnt(22) lgkmcnt(8)
    v_mfma_f32_16x16x32_bf16 v[112:115], v[224:227], a[124:127], v[112:115]
    ds_read_b64_tr_b16 v[176:177], v9 offset:34816
    buffer_load_dwordx4 a[180:183], v1, s[28:31], s91 offen offset:2048 sc1
    v_mfma_f32_16x16x32_bf16 v[116:119], v[228:231], a[124:127], v[116:119]
    ds_read_b64_tr_b16 v[178:179], v9 offset:43008
    v_mfma_f32_16x16x32_bf16 v[120:123], v[232:235], a[124:127], v[120:123]
    ds_read_b64_tr_b16 v[180:181], v12 offset:34816
    buffer_load_dwordx4 a[176:179], v1, s[28:31], s90 offen offset:2048 sc1
    v_mfma_f32_16x16x32_bf16 v[124:127], v[236:239], a[124:127], v[124:127]
    ds_read_b64_tr_b16 v[182:183], v12 offset:43008
    s_add_u32 m0, s57, 32768
    v_mfma_f32_16x16x32_bf16 v[96:99], v[224:227], a[120:123], v[96:99]
    ds_read_b64_tr_b16 v[184:185], v9 offset:35840
    s_add_u32 s76, s55, 851968
    buffer_load_dwordx4 v80, s[20:23], s76 offen lds
    v_mfma_f32_16x16x32_bf16 v[100:103], v[228:231], a[120:123], v[100:103]
    ds_read_b64_tr_b16 v[186:187], v9 offset:44032
    v_mfma_f32_16x16x32_bf16 v[104:107], v[232:235], a[120:123], v[104:107]
    ds_read_b64_tr_b16 v[188:189], v12 offset:35840
    buffer_load_dwordx4 v81, s[20:23], s76 offen offset:1024 lds
    v_mfma_f32_16x16x32_bf16 v[108:111], v[236:239], a[120:123], v[108:111]
    ds_read_b64_tr_b16 v[190:191], v12 offset:44032
    s_waitcnt vmcnt(22) lgkmcnt(8)
    s_barrier
    v_mfma_f32_16x16x32_bf16 v[112:115], v[160:163], a[132:135], v[112:115]
    ds_read_b64_tr_b16 v[192:193], v9 offset:49152
    buffer_load_dwordx4 a[188:191], v1, s[28:31], s91 offen offset:3072 sc1
    v_mfma_f32_16x16x32_bf16 v[116:119], v[164:167], a[132:135], v[116:119]
    ds_read_b64_tr_b16 v[194:195], v9 offset:57344
    v_mfma_f32_16x16x32_bf16 v[120:123], v[168:171], a[132:135], v[120:123]
    ds_read_b64_tr_b16 v[196:197], v12 offset:49152
    buffer_load_dwordx4 a[184:187], v1, s[28:31], s90 offen offset:3072 sc1
    v_mfma_f32_16x16x32_bf16 v[124:127], v[172:175], a[132:135], v[124:127]
    ds_read_b64_tr_b16 v[198:199], v12 offset:57344
    v_mfma_f32_16x16x32_bf16 v[96:99], v[160:163], a[128:131], v[96:99]
    ds_read_b64_tr_b16 v[200:201], v9 offset:50176
    buffer_load_dwordx4 v82, s[20:23], s76 offen offset:2048 lds
    v_mfma_f32_16x16x32_bf16 v[100:103], v[164:167], a[128:131], v[100:103]
    ds_read_b64_tr_b16 v[202:203], v9 offset:58368
    v_mfma_f32_16x16x32_bf16 v[104:107], v[168:171], a[128:131], v[104:107]
    ds_read_b64_tr_b16 v[204:205], v12 offset:50176
    buffer_load_dwordx4 v83, s[20:23], s76 offen offset:3072 lds
    v_mfma_f32_16x16x32_bf16 v[108:111], v[172:175], a[128:131], v[108:111]
    ds_read_b64_tr_b16 v[206:207], v12 offset:58368
    s_waitcnt vmcnt(24) lgkmcnt(8)
    v_mfma_f32_16x16x32_bf16 v[112:115], v[176:179], a[140:143], v[112:115]
    ds_read_b64_tr_b16 v[224:225], v9 offset:51200
    s_add_u32 s91, s91, 4096
    buffer_load_dwordx4 a[196:199], v1, s[28:31], s91 offen offset:0 sc1
    v_mfma_f32_16x16x32_bf16 v[116:119], v[180:183], a[140:143], v[116:119]
    ds_read_b64_tr_b16 v[226:227], v9 offset:59392
    v_mfma_f32_16x16x32_bf16 v[120:123], v[184:187], a[140:143], v[120:123]
    ds_read_b64_tr_b16 v[228:229], v12 offset:51200
    v_mfma_f32_16x16x32_bf16 v[124:127], v[188:191], a[140:143], v[124:127]
    ds_read_b64_tr_b16 v[230:231], v12 offset:59392
    s_add_u32 s90, s90, 4096
    v_mfma_f32_16x16x32_bf16 v[96:99], v[176:179], a[136:139], v[96:99]
    ds_read_b64_tr_b16 v[232:233], v9 offset:52224
    buffer_load_dwordx4 a[192:195], v1, s[28:31], s90 offen offset:0 sc1
    v_mfma_f32_16x16x32_bf16 v[100:103], v[180:183], a[136:139], v[100:103]
    ds_read_b64_tr_b16 v[234:235], v9 offset:60416
    v_mfma_f32_16x16x32_bf16 v[104:107], v[184:187], a[136:139], v[104:107]
    ds_read_b64_tr_b16 v[236:237], v12 offset:52224
    v_mfma_f32_16x16x32_bf16 v[108:111], v[188:191], a[136:139], v[108:111]
    ds_read_b64_tr_b16 v[238:239], v12 offset:60416
    s_waitcnt vmcnt(24) lgkmcnt(8)
    v_mfma_f32_16x16x32_bf16 v[112:115], v[192:195], a[148:151], v[112:115]
    ds_read_b64_tr_b16 v[160:161], v10 offset:0
    buffer_load_dwordx4 a[204:207], v1, s[28:31], s91 offen offset:1024 sc1
    v_mfma_f32_16x16x32_bf16 v[116:119], v[196:199], a[148:151], v[116:119]
    ds_read_b64_tr_b16 v[162:163], v10 offset:8192
    v_mfma_f32_16x16x32_bf16 v[120:123], v[200:203], a[148:151], v[120:123]
    ds_read_b64_tr_b16 v[164:165], v13 offset:0
    v_mfma_f32_16x16x32_bf16 v[124:127], v[204:207], a[148:151], v[124:127]
    ds_read_b64_tr_b16 v[166:167], v13 offset:8192
    v_mfma_f32_16x16x32_bf16 v[96:99], v[192:195], a[144:147], v[96:99]
    ds_read_b64_tr_b16 v[168:169], v10 offset:1024
    buffer_load_dwordx4 a[212:215], v1, s[28:31], s91 offen offset:2048 sc1
    v_mfma_f32_16x16x32_bf16 v[100:103], v[196:199], a[144:147], v[100:103]
    ds_read_b64_tr_b16 v[170:171], v10 offset:9216
    v_mfma_f32_16x16x32_bf16 v[104:107], v[200:203], a[144:147], v[104:107]
    ds_read_b64_tr_b16 v[172:173], v13 offset:1024
    v_mfma_f32_16x16x32_bf16 v[108:111], v[204:207], a[144:147], v[108:111]
    ds_read_b64_tr_b16 v[174:175], v13 offset:9216
    s_waitcnt vmcnt(22) lgkmcnt(8)
    v_mfma_f32_16x16x32_bf16 v[112:115], v[224:227], a[156:159], v[112:115]
    ds_read_b64_tr_b16 v[176:177], v10 offset:2048
    buffer_load_dwordx4 a[220:223], v1, s[28:31], s91 offen offset:3072 sc1
    v_mfma_f32_16x16x32_bf16 v[116:119], v[228:231], a[156:159], v[116:119]
    ds_read_b64_tr_b16 v[178:179], v10 offset:10240
    v_mfma_f32_16x16x32_bf16 v[120:123], v[232:235], a[156:159], v[120:123]
    ds_read_b64_tr_b16 v[180:181], v13 offset:2048
    buffer_load_dwordx4 a[200:203], v1, s[28:31], s90 offen offset:1024 sc1
    v_mfma_f32_16x16x32_bf16 v[124:127], v[236:239], a[156:159], v[124:127]
    ds_read_b64_tr_b16 v[182:183], v13 offset:10240
    v_mfma_f32_16x16x32_bf16 v[96:99], v[224:227], a[152:155], v[96:99]
    ds_read_b64_tr_b16 v[184:185], v10 offset:3072
    buffer_load_dwordx4 a[208:211], v1, s[28:31], s90 offen offset:2048 sc1
    v_mfma_f32_16x16x32_bf16 v[100:103], v[228:231], a[152:155], v[100:103]
    ds_read_b64_tr_b16 v[186:187], v10 offset:11264
    v_mfma_f32_16x16x32_bf16 v[104:107], v[232:235], a[152:155], v[104:107]
    ds_read_b64_tr_b16 v[188:189], v13 offset:3072
    buffer_load_dwordx4 a[216:219], v1, s[28:31], s90 offen offset:3072 sc1
    v_mfma_f32_16x16x32_bf16 v[108:111], v[236:239], a[152:155], v[108:111]
    ds_read_b64_tr_b16 v[190:191], v13 offset:11264
    s_waitcnt vmcnt(22) lgkmcnt(8)
    s_waitcnt vmcnt(8)
    s_barrier
    v_mfma_f32_16x16x32_bf16 v[112:115], v[160:163], a[164:167], v[112:115]
    ds_read_b64_tr_b16 v[192:193], v8 offset:0
    v_mfma_f32_16x16x32_bf16 v[116:119], v[164:167], a[164:167], v[116:119]
    ds_read_b64_tr_b16 v[194:195], v8 offset:8192
    v_mfma_f32_16x16x32_bf16 v[120:123], v[168:171], a[164:167], v[120:123]
    ds_read_b64_tr_b16 v[196:197], v11 offset:0
    v_mfma_f32_16x16x32_bf16 v[124:127], v[172:175], a[164:167], v[124:127]
    ds_read_b64_tr_b16 v[198:199], v11 offset:8192
    v_mfma_f32_16x16x32_bf16 v[96:99], v[160:163], a[160:163], v[96:99]
    ds_read_b64_tr_b16 v[200:201], v8 offset:1024
    v_mfma_f32_16x16x32_bf16 v[100:103], v[164:167], a[160:163], v[100:103]
    ds_read_b64_tr_b16 v[202:203], v8 offset:9216
    v_mfma_f32_16x16x32_bf16 v[104:107], v[168:171], a[160:163], v[104:107]
    ds_read_b64_tr_b16 v[204:205], v11 offset:1024
    v_mfma_f32_16x16x32_bf16 v[108:111], v[172:175], a[160:163], v[108:111]
    ds_read_b64_tr_b16 v[206:207], v11 offset:9216
    s_waitcnt lgkmcnt(8)
    v_mfma_f32_16x16x32_bf16 v[112:115], v[176:179], a[172:175], v[112:115]
    ds_read_b64_tr_b16 v[224:225], v8 offset:2048
    v_mfma_f32_16x16x32_bf16 v[116:119], v[180:183], a[172:175], v[116:119]
    ds_read_b64_tr_b16 v[226:227], v8 offset:10240
    v_mfma_f32_16x16x32_bf16 v[120:123], v[184:187], a[172:175], v[120:123]
    ds_read_b64_tr_b16 v[228:229], v11 offset:2048
    v_mfma_f32_16x16x32_bf16 v[124:127], v[188:191], a[172:175], v[124:127]
    ds_read_b64_tr_b16 v[230:231], v11 offset:10240
    v_mfma_f32_16x16x32_bf16 v[96:99], v[176:179], a[168:171], v[96:99]
    ds_read_b64_tr_b16 v[232:233], v8 offset:3072
    v_mfma_f32_16x16x32_bf16 v[100:103], v[180:183], a[168:171], v[100:103]
    ds_read_b64_tr_b16 v[234:235], v8 offset:11264
    v_mfma_f32_16x16x32_bf16 v[104:107], v[184:187], a[168:171], v[104:107]
    ds_read_b64_tr_b16 v[236:237], v11 offset:3072
    v_mfma_f32_16x16x32_bf16 v[108:111], v[188:191], a[168:171], v[108:111]
    ds_read_b64_tr_b16 v[238:239], v11 offset:11264
    s_waitcnt lgkmcnt(8)
    v_mfma_f32_16x16x32_bf16 v[112:115], v[192:195], a[180:183], v[112:115]
    ds_read_b64_tr_b16 v[160:161], v8 offset:16384
    v_mfma_f32_16x16x32_bf16 v[116:119], v[196:199], a[180:183], v[116:119]
    ds_read_b64_tr_b16 v[162:163], v8 offset:24576
    v_mfma_f32_16x16x32_bf16 v[120:123], v[200:203], a[180:183], v[120:123]
    ds_read_b64_tr_b16 v[164:165], v11 offset:16384
    v_mfma_f32_16x16x32_bf16 v[124:127], v[204:207], a[180:183], v[124:127]
    ds_read_b64_tr_b16 v[166:167], v11 offset:24576
    v_mfma_f32_16x16x32_bf16 v[96:99], v[192:195], a[176:179], v[96:99]
    ds_read_b64_tr_b16 v[168:169], v8 offset:17408
    v_mfma_f32_16x16x32_bf16 v[100:103], v[196:199], a[176:179], v[100:103]
    ds_read_b64_tr_b16 v[170:171], v8 offset:25600
    v_mfma_f32_16x16x32_bf16 v[104:107], v[200:203], a[176:179], v[104:107]
    ds_read_b64_tr_b16 v[172:173], v11 offset:17408
    v_mfma_f32_16x16x32_bf16 v[108:111], v[204:207], a[176:179], v[108:111]
    ds_read_b64_tr_b16 v[174:175], v11 offset:25600
    s_waitcnt lgkmcnt(8)
    v_mfma_f32_16x16x32_bf16 v[112:115], v[224:227], a[188:191], v[112:115]
    ds_read_b64_tr_b16 v[176:177], v8 offset:18432
    v_mfma_f32_16x16x32_bf16 v[116:119], v[228:231], a[188:191], v[116:119]
    ds_read_b64_tr_b16 v[178:179], v8 offset:26624
    v_mfma_f32_16x16x32_bf16 v[120:123], v[232:235], a[188:191], v[120:123]
    ds_read_b64_tr_b16 v[180:181], v11 offset:18432
    v_mfma_f32_16x16x32_bf16 v[124:127], v[236:239], a[188:191], v[124:127]
    ds_read_b64_tr_b16 v[182:183], v11 offset:26624
    v_mfma_f32_16x16x32_bf16 v[96:99], v[224:227], a[184:187], v[96:99]
    ds_read_b64_tr_b16 v[184:185], v8 offset:19456
    v_mfma_f32_16x16x32_bf16 v[100:103], v[228:231], a[184:187], v[100:103]
    ds_read_b64_tr_b16 v[186:187], v8 offset:27648
    v_mfma_f32_16x16x32_bf16 v[104:107], v[232:235], a[184:187], v[104:107]
    ds_read_b64_tr_b16 v[188:189], v11 offset:19456
    v_mfma_f32_16x16x32_bf16 v[108:111], v[236:239], a[184:187], v[108:111]
    ds_read_b64_tr_b16 v[190:191], v11 offset:27648
    s_waitcnt vmcnt(6) lgkmcnt(8)
    v_mfma_f32_16x16x32_bf16 v[112:115], v[160:163], a[196:199], v[112:115]
    ds_read_b64_tr_b16 v[192:193], v8 offset:32768
    v_mfma_f32_16x16x32_bf16 v[116:119], v[164:167], a[196:199], v[116:119]
    ds_read_b64_tr_b16 v[194:195], v8 offset:40960
    v_mfma_f32_16x16x32_bf16 v[120:123], v[168:171], a[196:199], v[120:123]
    ds_read_b64_tr_b16 v[196:197], v11 offset:32768
    v_mfma_f32_16x16x32_bf16 v[124:127], v[172:175], a[196:199], v[124:127]
    ds_read_b64_tr_b16 v[198:199], v11 offset:40960
    v_mfma_f32_16x16x32_bf16 v[96:99], v[160:163], a[192:195], v[96:99]
    ds_read_b64_tr_b16 v[200:201], v8 offset:33792
    v_mfma_f32_16x16x32_bf16 v[100:103], v[164:167], a[192:195], v[100:103]
    ds_read_b64_tr_b16 v[202:203], v8 offset:41984
    v_mfma_f32_16x16x32_bf16 v[104:107], v[168:171], a[192:195], v[104:107]
    ds_read_b64_tr_b16 v[204:205], v11 offset:33792
    v_mfma_f32_16x16x32_bf16 v[108:111], v[172:175], a[192:195], v[108:111]
    ds_read_b64_tr_b16 v[206:207], v11 offset:41984
    s_waitcnt vmcnt(5) lgkmcnt(8)
    v_mfma_f32_16x16x32_bf16 v[112:115], v[176:179], a[204:207], v[112:115]
    ds_read_b64_tr_b16 v[224:225], v8 offset:34816
    ds_read_b64_tr_b16 v[226:227], v8 offset:43008
    v_mfma_f32_16x16x32_bf16 v[116:119], v[180:183], a[204:207], v[116:119]
    ds_read_b64_tr_b16 v[228:229], v11 offset:34816
    ds_read_b64_tr_b16 v[230:231], v11 offset:43008
    v_mfma_f32_16x16x32_bf16 v[120:123], v[184:187], a[204:207], v[120:123]
    ds_read_b64_tr_b16 v[232:233], v8 offset:35840
    ds_read_b64_tr_b16 v[234:235], v8 offset:44032
    v_mfma_f32_16x16x32_bf16 v[124:127], v[188:191], a[204:207], v[124:127]
    ds_read_b64_tr_b16 v[236:237], v11 offset:35840
    ds_read_b64_tr_b16 v[238:239], v11 offset:44032
    s_waitcnt vmcnt(4) lgkmcnt(8)
    v_mfma_f32_16x16x32_bf16 v[112:115], v[192:195], a[212:215], v[112:115]
    v_mfma_f32_16x16x32_bf16 v[116:119], v[196:199], a[212:215], v[116:119]
    v_mfma_f32_16x16x32_bf16 v[120:123], v[200:203], a[212:215], v[120:123]
    v_mfma_f32_16x16x32_bf16 v[124:127], v[204:207], a[212:215], v[124:127]
    s_waitcnt vmcnt(3) lgkmcnt(0)
    v_mfma_f32_16x16x32_bf16 v[112:115], v[224:227], a[220:223], v[112:115]
    v_mfma_f32_16x16x32_bf16 v[116:119], v[228:231], a[220:223], v[116:119]
    v_mfma_f32_16x16x32_bf16 v[120:123], v[232:235], a[220:223], v[120:123]
    v_mfma_f32_16x16x32_bf16 v[124:127], v[236:239], a[220:223], v[124:127]
    s_waitcnt vmcnt(2)
    v_mfma_f32_16x16x32_bf16 v[96:99], v[176:179], a[200:203], v[96:99]
    v_mfma_f32_16x16x32_bf16 v[100:103], v[180:183], a[200:203], v[100:103]
    s_nop 1
    ds_write_b128 v26, v[112:115] offset:32768
    v_mfma_f32_16x16x32_bf16 v[104:107], v[184:187], a[200:203], v[104:107]
    v_mfma_f32_16x16x32_bf16 v[108:111], v[188:191], a[200:203], v[108:111]
    s_waitcnt vmcnt(1)
    v_mfma_f32_16x16x32_bf16 v[96:99], v[192:195], a[208:211], v[96:99]
    ds_write_b128 v26, v[116:119] offset:33792
    v_mfma_f32_16x16x32_bf16 v[100:103], v[196:199], a[208:211], v[100:103]
    v_mfma_f32_16x16x32_bf16 v[104:107], v[200:203], a[208:211], v[104:107]
    v_mfma_f32_16x16x32_bf16 v[108:111], v[204:207], a[208:211], v[108:111]
    ds_write_b128 v26, v[120:123] offset:34816
    s_waitcnt vmcnt(0)
    v_mfma_f32_16x16x32_bf16 v[96:99], v[224:227], a[216:219], v[96:99]
    v_mfma_f32_16x16x32_bf16 v[100:103], v[228:231], a[216:219], v[100:103]
    v_mfma_f32_16x16x32_bf16 v[104:107], v[232:235], a[216:219], v[104:107]
    ds_write_b128 v26, v[124:127] offset:35840
    v_mfma_f32_16x16x32_bf16 v[108:111], v[236:239], a[216:219], v[108:111]
    s_waitcnt lgkmcnt(0)
    s_barrier
    ds_read_b128 v[160:163], v27 offset:32768
    ds_read_b128 v[164:167], v27 offset:33792
    ds_read_b128 v[168:171], v27 offset:34816
    ds_read_b128 v[172:175], v27 offset:35840
    v_pk_fma_f32 v[44:45], v[96:97], v[72:73], v[44:45] op_sel_hi:[1,0,1]
    v_pk_fma_f32 v[46:47], v[98:99], v[72:73], v[46:47] op_sel_hi:[1,0,1]
    v_pk_fma_f32 v[48:49], v[100:101], v[72:73], v[48:49] op_sel_hi:[1,0,1]
    v_pk_fma_f32 v[50:51], v[102:103], v[72:73], v[50:51] op_sel_hi:[1,0,1]
    v_pk_fma_f32 v[52:53], v[104:105], v[72:73], v[52:53] op_sel_hi:[1,0,1]
    v_pk_fma_f32 v[54:55], v[106:107], v[72:73], v[54:55] op_sel_hi:[1,0,1]
    v_pk_fma_f32 v[56:57], v[108:109], v[72:73], v[56:57] op_sel_hi:[1,0,1]
    v_pk_fma_f32 v[58:59], v[110:111], v[72:73], v[58:59] op_sel_hi:[1,0,1]
    s_waitcnt lgkmcnt(3)
    v_pk_fma_f32 v[44:45], v[160:161], v[72:73], v[44:45] op_sel_hi:[1,0,1]
    v_pk_fma_f32 v[46:47], v[162:163], v[72:73], v[46:47] op_sel_hi:[1,0,1]
    s_waitcnt lgkmcnt(2)
    v_pk_fma_f32 v[48:49], v[164:165], v[72:73], v[48:49] op_sel_hi:[1,0,1]
    v_pk_fma_f32 v[50:51], v[166:167], v[72:73], v[50:51] op_sel_hi:[1,0,1]
    s_waitcnt lgkmcnt(1)
    v_pk_fma_f32 v[52:53], v[168:169], v[72:73], v[52:53] op_sel_hi:[1,0,1]
    v_pk_fma_f32 v[54:55], v[170:171], v[72:73], v[54:55] op_sel_hi:[1,0,1]
    s_waitcnt lgkmcnt(0)
    v_pk_fma_f32 v[56:57], v[172:173], v[72:73], v[56:57] op_sel_hi:[1,0,1]
    v_pk_fma_f32 v[58:59], v[174:175], v[72:73], v[58:59] op_sel_hi:[1,0,1]
    v_cvt_pk_bf16_f32 v224, v44, v45
    v_cvt_pk_bf16_f32 v225, v46, v47
    v_cvt_pk_bf16_f32 v226, v48, v49
    v_cvt_pk_bf16_f32 v227, v50, v51
    v_cvt_pk_bf16_f32 v228, v52, v53
    v_cvt_pk_bf16_f32 v229, v54, v55
    v_cvt_pk_bf16_f32 v230, v56, v57
    v_cvt_pk_bf16_f32 v231, v58, v59
    v_permlane16_swap_b32 v224, v226
    v_permlane16_swap_b32 v225, v227
    v_permlane16_swap_b32 v228, v230
    v_permlane16_swap_b32 v229, v231
    buffer_store_dwordx4 v[224:227], v66, s[24:27], 0 offen
    buffer_store_dwordx4 v[228:231], v66, s[24:27], 0 offen offset:64
L_END:
    s_endpgm
.section .rodata,"a"
.p2align 6
.amdhsa_kernel interleave_layers__sliding_local_dilated__dense_activation_relu__prompt_kernel
  .amdhsa_next_free_vgpr 512
  .amdhsa_next_free_sgpr 102
  .amdhsa_accum_offset 256
  .amdhsa_group_segment_fixed_size 0
  .amdhsa_kernarg_size 72
  .amdhsa_user_sgpr_count 2
  .amdhsa_user_sgpr_kernarg_segment_ptr 1
  .amdhsa_system_sgpr_workgroup_id_x 1
  .amdhsa_float_denorm_mode_32 3
  .amdhsa_float_denorm_mode_16_64 3
.end_amdhsa_kernel
```
